```python
import torch

def _softmax(x, axis=-1):
    return torch.softmax(x, dim=axis)

def _gelu(x):
    return torch.nn.functional.gelu(x, approximate='tanh')

def _silu(x):
    return torch.nn.functional.silu(x)

def _sigmoid(x):
    return torch.sigmoid(x)

def _layernorm(x, axis=-1, eps=1e-05):
    m = x.mean(dim=axis, keepdim=True)
    v = x.var(dim=axis, keepdim=True, unbiased=False)
    return (x - m) / torch.sqrt(v + eps)

def _scatter_add(tgt, idx, src, axis=0):
    return tgt.clone().index_add_(axis, idx, src)

def _segment_sum(src, seg, n):
    out = torch.zeros((n,) + src.shape[1:], dtype=src.dtype)
    return out.index_add_(0, seg, src)

def _pad(x, pw):
    flat = tuple((v for pair in reversed(pw) for v in pair))
    return torch.nn.functional.pad(x, flat)
kernel_name = 'adaLN_cond__memory_aug_recurrent_mem_tr__dense_activation_gelu__prompt'

def setup_inputs():

    _w = lambda a: (lambda t: t.to(torch.bfloat16) if t.is_floating_point() else t)(torch.as_tensor(a))

    def _A_setup():
        B, S, Dm = (1, 2048, 512)
        H, Dh = (32, 128)
        M, seg = (8, 32)
        seg = min(seg, S)
        S = S // seg * seg
        return {'x': _w((lambda *s: torch.randn(*s, dtype=torch.bfloat16) * 0.05)(B, S, Dm)), 'mem0': _w((lambda *s: torch.randn(*s, dtype=torch.bfloat16) * 0.8)(B, M, Dm)), 'Wq': _w((lambda *s: torch.randn(*s, dtype=torch.bfloat16) * 0.8)(Dm, H, Dh) * Dm ** (-0.5)), 'Wk': _w((lambda *s: torch.randn(*s, dtype=torch.bfloat16) * 0.8)(Dm, H, Dh) * Dm ** (-0.5)), 'Wv': _w((lambda *s: torch.randn(*s, dtype=torch.bfloat16) * 0.8)(Dm, H, Dh) * Dm ** (-0.5)), 'Wo': _w((lambda *s: torch.randn(*s, dtype=torch.bfloat16) * 0.8)(H, Dh, Dm) * (H * Dh) ** (-0.5)), 'seg_len': seg}
    _A_in = _A_setup()

    def _B_setup():
        B, S, D, F = (1, 2048, 512, 1792)
        return {'x': _w((lambda *s: torch.randn(*s, dtype=torch.bfloat16) * 0.05)(B, S, D)), 'w1': _w((lambda *s: torch.randn(*s, dtype=torch.bfloat16) * 0.8)(D, F) * D ** (-0.5)), 'b1': _w((lambda *s: torch.randn(*s, dtype=torch.bfloat16) * 12.8)(F) * 0.01), 'w2': _w((lambda *s: torch.randn(*s, dtype=torch.bfloat16) * 0.4)(F, D) * F ** (-0.5)), 'b2': _w((lambda *s: torch.randn(*s, dtype=torch.bfloat16) * 6.4)(D) * 0.01)}
    _B_in = _B_setup()
    return {'A_x': _A_in['x'], 'A_mem0': _A_in['mem0'], 'A_Wq': _A_in['Wq'], 'A_Wk': _A_in['Wk'], 'A_Wv': _A_in['Wv'], 'A_Wo': _A_in['Wo'], 'A_seg_len': _A_in['seg_len'], 'B_x': _B_in['x'], 'B_w1': _B_in['w1'], 'B_b1': _B_in['b1'], 'B_w2': _B_in['w2'], 'B_b2': _B_in['b2'], 'c': _w((lambda *s: torch.randn(*s, dtype=torch.bfloat16) * 0.1)(1, 512) * 8.0), 'w_mod': _w((lambda *s: torch.randn(*s, dtype=torch.bfloat16) * 0.1)(512, 6 * 512) * 512 ** (-0.5) * 8.0)}

def reference(A_x, A_mem0, A_Wq, A_Wk, A_Wv, A_Wo, A_seg_len, B_x, B_w1, B_b1, B_w2, B_b2, c, w_mod):

    def _A_ref(x, mem0, Wq, Wk, Wv, Wo, seg_len):
        B, S, Dm = x.shape
        H, Dh = (Wq.shape[1], Wq.shape[2])
        M = mem0.shape[1]
        scale = Dh ** (-0.5)
        n_seg = S // seg_len
        L = M + seg_len
        idx = torch.arange(L)
        mask = (idx[:, None] < M) | (idx[:, None] >= idx[None, :])
        mem = mem0
        outs = []
        for s in range(n_seg):
            xs = x[:, s * seg_len:(s + 1) * seg_len, :].clone()
            h = torch.concatenate([mem, xs], axis=1)
            q = torch.einsum('btd,dhe->bhte', h, Wq)
            k = torch.einsum('btd,dhe->bhte', h, Wk)
            v = torch.einsum('btd,dhe->bhte', h, Wv)
            scores = torch.einsum('bhqe,bhke->bhqk', q, k) * scale
            scores = torch.where(mask[None, None], scores, -1000000000.0)
            p = _softmax(scores, axis=-1)
            o = torch.einsum('bhqk,bhke->bhqe', p, v)
            o = torch.einsum('bhte,hed->btd', o, Wo)
            mem = o[:, :M, :].clone()
            outs.append(o[:, M:, :])
        return torch.concatenate(outs, axis=1)

    def _B_ref(x, w1, b1, w2, b2):
        h = torch.einsum('bsd,df->bsf', x, w1) + b1
        h = _gelu(h)
        return torch.einsum('bsf,fd->bsd', h, w2) + b2
    x = A_x
    mod = (_silu(c) @ w_mod).reshape(c.shape[0], 6, 1, -1)
    sa, ca, ga, sb, cb, gb = (mod[:, 0].clone(), mod[:, 1].clone(), mod[:, 2].clone(), mod[:, 3].clone(), mod[:, 4].clone(), mod[:, 5].clone())
    h = _layernorm(x, axis=-1) * (1 + ca) + sa
    x = x + ga * _A_ref(h, A_mem0, A_Wq, A_Wk, A_Wv, A_Wo, A_seg_len)
    h = _layernorm(x, axis=-1) * (1 + cb) + sb
    x = x + gb * _B_ref(h, B_w1, B_b1, B_w2, B_b2)
    return x
```

```asm
; @launch grid=(256,1,1) block=(256,1,1) lds=163840
.amdgcn_target "amdgcn-amd-amdhsa--gfx950"
.text
.globl adaLN_cond__memory_aug_recurrent_mem_tr__dense_activation_gelu__prompt_kernel
.p2align 8
.type adaLN_cond__memory_aug_recurrent_mem_tr__dense_activation_gelu__prompt_kernel,@function
adaLN_cond__memory_aug_recurrent_mem_tr__dense_activation_gelu__prompt_kernel:
  s_cmp_ge_u32 s2, 256
  s_cbranch_scc1 k_exit

  s_load_dwordx2 s[4:5], s[0:1], 128
  s_load_dwordx2 s[12:13], s[0:1], 120
  s_load_dword s84, s[0:1], 0
  s_load_dword s85, s[0:1], 64
  s_getreg_b32 s16, hwreg(HW_REG_XCC_ID)
  s_mov_b32 s6, 0x10000000
  s_mov_b32 s7, 0x00020000
  s_mov_b32 s14, 256
  s_mov_b32 s15, 0x00020000
  s_and_b32 s16, s16, 15

  v_lshrrev_b32 v1, 6, v0
  s_lshr_b32 s17, s2, 3
  v_readfirstlane_b32 s18, v1
  s_and_b32 s17, s17, 31

  s_and_b32 s19, s16, 7

  s_mov_b32 s3, 0
  s_lshl_b32 s22, s16, 2
  s_lshl_b32 s23, 1, s17
  v_mov_b32 v254, s22
  v_mov_b32 v255, s23
  s_waitcnt lgkmcnt(0)
  s_cmp_lg_u32 s18, 0
  s_cbranch_scc1 r_dispatch
  s_mov_b64 exec, 1
  buffer_atomic_or v255, v254, s[12:15], 0 offen sc0
  s_mov_b64 exec, -1
r_dispatch:
  s_cmp_lg_u32 s19, 0
  s_cbranch_scc1 role_worker
  v_and_b32 v88, 63, v0
  s_lshl_b32 s39, s18, 20
  s_lshl_b32 s40, s18, 15
  s_add_u32 s40, s40, 32768
  s_load_dwordx4 s[52:55], s[0:1], 16
  s_load_dwordx4 s[56:59], s[0:1], 32
  v_lshrrev_b32 v96, 2, v88
  v_bfe_u32 v97, v88, 4, 1
  v_lshlrev_b32 v97, 1, v97
  v_xor_b32 v96, v96, v97
  v_and_b32 v97, 3, v88
  v_lshlrev_b32 v97, 4, v97
  s_lshl_b32 s23, s18, 6
  v_add_u32 v97, s23, v97
  v_lshlrev_b32 v89, 13, v96
  v_add_u32 v89, v89, v97
  s_lshl_b32 s23, s17, 8
  v_add_u32 v89, s23, v89
  v_lshlrev_b32 v90, 10, v96
  v_add_u32 v90, v90, v97
  s_lshl_b32 s23, s17, 17
  v_add_u32 v90, s23, v90
  v_bfe_u32 v96, v88, 4, 1
  v_lshlrev_b32 v92, 8, v96
  v_lshl_add_u32 v92, v96, 7, v92
  v_bfe_u32 v96, v88, 5, 1
  v_lshl_add_u32 v92, v96, 9, v92
  v_bfe_u32 v96, v88, 3, 1
  v_lshl_add_u32 v92, v96, 5, v92
  v_bfe_u32 v96, v88, 2, 1
  v_lshl_add_u32 v92, v96, 6, v92
  v_and_b32 v96, 3, v88
  v_lshl_add_u32 v92, v96, 3, v92
  v_add_u32 v92, s40, v92
  v_xor_b32 v93, 128, v92
  s_mov_b32 s10, 0x400000
  s_mov_b32 s11, 0x00020000
  s_waitcnt lgkmcnt(0)
  s_mov_b32 s8, s52
  s_mov_b32 s9, s53
  s_mov_b32 s24, 0
  s_add_u32 m0, s40, 0
  s_add_u32 s23, s24, 0
  buffer_load_dwordx4 v89, s[8:11], s23 offen  lds
  s_add_u32 m0, s40, 1024
  s_add_u32 s23, s24, 131072
  buffer_load_dwordx4 v89, s[8:11], s23 offen  lds
  s_mov_b32 s8, s54
  s_mov_b32 s9, s55
  s_mov_b32 s24, 0
  s_add_u32 m0, s40, 2048
  s_add_u32 s23, s24, 0
  buffer_load_dwordx4 v89, s[8:11], s23 offen  lds
  s_add_u32 m0, s40, 3072
  s_add_u32 s23, s24, 131072
  buffer_load_dwordx4 v89, s[8:11], s23 offen  lds
  s_mov_b32 s8, s58
  s_mov_b32 s9, s59
  s_add_u32 m0, s40, 4096
  s_mov_b32 s23, 0
  buffer_load_dwordx4 v90, s[8:11], s23 offen  lds
  s_add_u32 m0, s40, 5120
  s_mov_b32 s23, 16384
  buffer_load_dwordx4 v90, s[8:11], s23 offen  lds
  s_mov_b32 s8, s52
  s_mov_b32 s9, s53
  s_mov_b32 s24, 262144
  s_add_u32 m0, s40, 6144
  s_add_u32 s23, s24, 0
  buffer_load_dwordx4 v89, s[8:11], s23 offen  lds
  s_add_u32 m0, s40, 7168
  s_add_u32 s23, s24, 131072
  buffer_load_dwordx4 v89, s[8:11], s23 offen  lds
  s_mov_b32 s8, s54
  s_mov_b32 s9, s55
  s_mov_b32 s24, 262144
  s_add_u32 m0, s40, 8192
  s_add_u32 s23, s24, 0
  buffer_load_dwordx4 v89, s[8:11], s23 offen  lds
  s_add_u32 m0, s40, 9216
  s_add_u32 s23, s24, 131072
  buffer_load_dwordx4 v89, s[8:11], s23 offen  lds
  s_mov_b32 s8, s58
  s_mov_b32 s9, s59
  s_add_u32 m0, s40, 10240
  s_mov_b32 s23, 32768
  buffer_load_dwordx4 v90, s[8:11], s23 offen  lds
  s_add_u32 m0, s40, 11264
  s_mov_b32 s23, 49152
  buffer_load_dwordx4 v90, s[8:11], s23 offen  lds
  s_mov_b32 s8, s52
  s_mov_b32 s9, s53
  s_mov_b32 s24, 524288
  s_add_u32 m0, s40, 12288
  s_add_u32 s23, s24, 0
  buffer_load_dwordx4 v89, s[8:11], s23 offen  lds
  s_add_u32 m0, s40, 13312
  s_add_u32 s23, s24, 131072
  buffer_load_dwordx4 v89, s[8:11], s23 offen  lds
  s_mov_b32 s8, s54
  s_mov_b32 s9, s55
  s_mov_b32 s24, 524288
  s_add_u32 m0, s40, 14336
  s_add_u32 s23, s24, 0
  buffer_load_dwordx4 v89, s[8:11], s23 offen  lds
  s_add_u32 m0, s40, 15360
  s_add_u32 s23, s24, 131072
  buffer_load_dwordx4 v89, s[8:11], s23 offen  lds
  s_mov_b32 s8, s58
  s_mov_b32 s9, s59
  s_add_u32 m0, s40, 16384
  s_mov_b32 s23, 65536
  buffer_load_dwordx4 v90, s[8:11], s23 offen  lds
  s_add_u32 m0, s40, 17408
  s_mov_b32 s23, 81920
  buffer_load_dwordx4 v90, s[8:11], s23 offen  lds
  s_mov_b32 s8, s52
  s_mov_b32 s9, s53
  s_mov_b32 s24, 786432
  s_add_u32 m0, s40, 18432
  s_add_u32 s23, s24, 0
  buffer_load_dwordx4 v89, s[8:11], s23 offen  lds
  s_add_u32 m0, s40, 19456
  s_add_u32 s23, s24, 131072
  buffer_load_dwordx4 v89, s[8:11], s23 offen  lds
  s_mov_b32 s8, s54
  s_mov_b32 s9, s55
  s_mov_b32 s24, 786432
  s_add_u32 m0, s40, 20480
  s_add_u32 s23, s24, 0
  buffer_load_dwordx4 v89, s[8:11], s23 offen  lds
  s_add_u32 m0, s40, 21504
  s_add_u32 s23, s24, 131072
  buffer_load_dwordx4 v89, s[8:11], s23 offen  lds
  s_mov_b32 s8, s58
  s_mov_b32 s9, s59
  s_add_u32 m0, s40, 22528
  s_mov_b32 s23, 98304
  buffer_load_dwordx4 v90, s[8:11], s23 offen  lds
  s_add_u32 m0, s40, 23552
  s_mov_b32 s23, 114688
  buffer_load_dwordx4 v90, s[8:11], s23 offen  lds
  s_mov_b32 s8, s52
  s_mov_b32 s9, s53
  s_mov_b32 s24, 1048576
  s_add_u32 m0, s40, 24576
  s_add_u32 s23, s24, 0
  buffer_load_dwordx4 v89, s[8:11], s23 offen  lds
  s_add_u32 m0, s40, 25600
  s_add_u32 s23, s24, 131072
  buffer_load_dwordx4 v89, s[8:11], s23 offen  lds
  s_mov_b32 s8, s54
  s_mov_b32 s9, s55
  s_mov_b32 s24, 1048576
  s_add_u32 m0, s40, 26624
  s_add_u32 s23, s24, 0
  buffer_load_dwordx4 v89, s[8:11], s23 offen  lds
  s_add_u32 m0, s40, 27648
  s_add_u32 s23, s24, 131072
  buffer_load_dwordx4 v89, s[8:11], s23 offen  lds
  s_mov_b32 s8, s58
  s_mov_b32 s9, s59
  s_add_u32 m0, s40, 28672
  s_mov_b32 s23, 256
  buffer_load_dwordx4 v90, s[8:11], s23 offen  lds
  s_add_u32 m0, s40, 29696
  s_mov_b32 s23, 16640
  buffer_load_dwordx4 v90, s[8:11], s23 offen  lds
  s_mov_b32 s8, s52
  s_mov_b32 s9, s53
  s_mov_b32 s24, 1310720
  s_add_u32 m0, s40, 30720
  s_add_u32 s23, s24, 0
  buffer_load_dwordx4 v89, s[8:11], s23 offen  lds
  s_add_u32 m0, s40, 31744
  s_add_u32 s23, s24, 131072
  buffer_load_dwordx4 v89, s[8:11], s23 offen  lds
  s_cmp_lg_u32 s3, 0
  s_cbranch_scc1 ch_conf_ok
  v_mov_b32 v253, 30712
  s_cmp_lg_u32 s18, 0
  s_cbranch_scc1 ch_conf_w
  s_waitcnt vmcnt(32)
  v_readfirstlane_b32 s22, v255
  s_lshl_b32 s23, 1, s17
  s_nop 2
  s_and_b32 s22, s22, s23
  s_cmp_ge_u32 s16, 8
  s_cselect_b32 s22, 1, s22
  v_mov_b32 v252, s22
  ds_write_b32 v253, v252
ch_conf_w:
  s_waitcnt lgkmcnt(0)
  s_barrier
  ds_read_b32 v252, v253
  s_waitcnt lgkmcnt(0)
  v_readfirstlane_b32 s22, v252
  s_nop 3
  s_cmp_lg_u32 s22, 0
  s_cbranch_scc1 r_overflow
ch_conf_ok:
  s_or_b32 s22, s17, s18
  s_cmp_lg_u32 s22, 0
  s_cbranch_scc1 ch_conf_nl
  v_mbcnt_lo_u32_b32 v250, -1, 0
  v_mbcnt_hi_u32_b32 v250, -1, v250
  v_lshlrev_b32 v250, 3, v250
  v_mov_b64 v[252:253], 0
  s_lshl_b32 s22, s19, 10
  s_add_u32 s22, s22, 49152
  buffer_store_dwordx2 v[252:253], v250, s[4:7], s22 offen sc1
  v_lshlrev_b32 v250, 1, v250
  v_mov_b64 v[246:247], -1
  v_mov_b64 v[248:249], -1
  s_lshl_b32 s22, s19, 13
  s_add_u32 s22, s22, 655360
  buffer_store_dwordx4 v[246:249], v250, s[4:7], s22 offen sc1
  buffer_store_dwordx4 v[246:249], v250, s[4:7], s22 offen offset:1024 sc1
  s_lshl_b32 s22, s19, 2
  v_mov_b32 v251, 1
  s_waitcnt vmcnt(0)
  s_mov_b64 exec, 1
  buffer_store_dword v251, off, s[12:15], s22 offset:128 sc1
  s_mov_b64 exec, -1
ch_conf_nl:
  v_mov_b64 v[4:5], -1
  v_mov_b64 v[6:7], -1
  v_mov_b64 v[8:9], 0
  v_mov_b64 v[10:11], 0
  v_lshlrev_b32 v1, 4, v0
  v_lshrrev_b32 v2, 4, v0
  v_lshlrev_b32 v2, 13, v2
  v_and_b32 v3, 15, v0
  v_lshl_add_u32 v2, v3, 4, v2
  s_lshl_b32 s22, s17, 8
  s_add_u32 s24, s22, 8192
  s_add_u32 s22, s22, 65536
  s_lshl_b32 s23, s17, 11
  s_add_u32 s23, s23, 720896
  s_cmp_lg_u32 s18, 0
  s_cbranch_scc1 ci_skip
  buffer_store_dwordx4 v[4:7], v2, s[4:7], s22 offen sc1
  buffer_store_dwordx4 v[8:11], v1, s[4:7], s23 offen sc1
  buffer_store_dwordx4 v[8:11], v1, s[4:7], s23 offen offset:1024 sc1
  s_mov_b64 exec, 0xffff
  buffer_store_dwordx4 v[8:11], v1, s[4:7], s24 offen sc1
  s_mov_b64 exec, -1
ci_skip:
  s_lshl_b32 s22, s17, 13
  s_add_u32 s22, s22, 131072
  s_add_u32 s23, s22, 4096
  s_add_u32 s24, s22, 0x40000
  s_add_u32 s25, s23, 0x40000
  buffer_store_dwordx4 v[4:7], v1, s[4:7], s22 offen sc1
  buffer_store_dwordx4 v[4:7], v1, s[4:7], s23 offen sc1
  buffer_store_dwordx4 v[4:7], v1, s[4:7], s24 offen sc1
  buffer_store_dwordx4 v[4:7], v1, s[4:7], s25 offen sc1
  v_lshrrev_b32 v2, 6, v0
  v_lshlrev_b32 v2, 10, v2
  v_add_u32 v2, v2, v1
  s_lshl_b32 s22, s17, 13
  s_add_u32 s22, s22, 54263808
  buffer_store_dwordx4 v[4:7], v2, s[4:7], s22 offen sc1
  s_waitcnt vmcnt(35)
  ds_read_b64_tr_b16 a[0:1], v92 offset:0
  ds_read_b64_tr_b16 a[2:3], v93 offset:0
  ds_read_b64_tr_b16 a[4:5], v92 offset:1024
  ds_read_b64_tr_b16 a[6:7], v93 offset:1024
  s_waitcnt vmcnt(33)
  ds_read_b64_tr_b16 a[128:129], v92 offset:2048
  ds_read_b64_tr_b16 a[130:131], v93 offset:2048
  ds_read_b64_tr_b16 a[132:133], v92 offset:3072
  ds_read_b64_tr_b16 a[134:135], v93 offset:3072
  s_waitcnt lgkmcnt(4)
  s_mov_b32 s8, s54
  s_mov_b32 s9, s55
  s_mov_b32 s24, 1310720
  s_add_u32 m0, s40, 0
  s_add_u32 s23, s24, 0
  buffer_load_dwordx4 v89, s[8:11], s23 offen  lds
  s_add_u32 m0, s40, 1024
  s_add_u32 s23, s24, 131072
  buffer_load_dwordx4 v89, s[8:11], s23 offen  lds
  s_waitcnt vmcnt(33)
  ds_read_b64_tr_b16 v[128:129], v92 offset:4096
  ds_read_b64_tr_b16 v[130:131], v93 offset:4096
  ds_read_b64_tr_b16 v[132:133], v92 offset:5120
  ds_read_b64_tr_b16 v[134:135], v93 offset:5120
  s_waitcnt lgkmcnt(4)
  s_mov_b32 s8, s58
  s_mov_b32 s9, s59
  s_add_u32 m0, s40, 2048
  s_mov_b32 s23, 33024
  buffer_load_dwordx4 v90, s[8:11], s23 offen  lds
  s_add_u32 m0, s40, 3072
  s_mov_b32 s23, 49408
  buffer_load_dwordx4 v90, s[8:11], s23 offen  lds
  s_waitcnt vmcnt(33)
  ds_read_b64_tr_b16 a[8:9], v92 offset:6144
  ds_read_b64_tr_b16 a[10:11], v93 offset:6144
  ds_read_b64_tr_b16 a[12:13], v92 offset:7168
  ds_read_b64_tr_b16 a[14:15], v93 offset:7168
  s_waitcnt lgkmcnt(4)
  s_mov_b32 s8, s52
  s_mov_b32 s9, s53
  s_mov_b32 s24, 1572864
  s_add_u32 m0, s40, 4096
  s_add_u32 s23, s24, 0
  buffer_load_dwordx4 v89, s[8:11], s23 offen  lds
  s_add_u32 m0, s40, 5120
  s_add_u32 s23, s24, 131072
  buffer_load_dwordx4 v89, s[8:11], s23 offen  lds
  s_waitcnt vmcnt(33)
  ds_read_b64_tr_b16 a[136:137], v92 offset:8192
  ds_read_b64_tr_b16 a[138:139], v93 offset:8192
  ds_read_b64_tr_b16 a[140:141], v92 offset:9216
  ds_read_b64_tr_b16 a[142:143], v93 offset:9216
  s_waitcnt lgkmcnt(4)
  s_mov_b32 s8, s54
  s_mov_b32 s9, s55
  s_mov_b32 s24, 1572864
  s_add_u32 m0, s40, 6144
  s_add_u32 s23, s24, 0
  buffer_load_dwordx4 v89, s[8:11], s23 offen  lds
  s_add_u32 m0, s40, 7168
  s_add_u32 s23, s24, 131072
  buffer_load_dwordx4 v89, s[8:11], s23 offen  lds
  s_waitcnt vmcnt(33)
  ds_read_b64_tr_b16 v[136:137], v92 offset:10240
  ds_read_b64_tr_b16 v[138:139], v93 offset:10240
  ds_read_b64_tr_b16 v[140:141], v92 offset:11264
  ds_read_b64_tr_b16 v[142:143], v93 offset:11264
  s_waitcnt lgkmcnt(4)
  s_mov_b32 s8, s58
  s_mov_b32 s9, s59
  s_add_u32 m0, s40, 8192
  s_mov_b32 s23, 65792
  buffer_load_dwordx4 v90, s[8:11], s23 offen  lds
  s_add_u32 m0, s40, 9216
  s_mov_b32 s23, 82176
  buffer_load_dwordx4 v90, s[8:11], s23 offen  lds
  s_waitcnt vmcnt(33)
  ds_read_b64_tr_b16 a[16:17], v92 offset:12288
  ds_read_b64_tr_b16 a[18:19], v93 offset:12288
  ds_read_b64_tr_b16 a[20:21], v92 offset:13312
  ds_read_b64_tr_b16 a[22:23], v93 offset:13312
  s_waitcnt lgkmcnt(4)
  s_mov_b32 s8, s52
  s_mov_b32 s9, s53
  s_mov_b32 s24, 1835008
  s_add_u32 m0, s40, 10240
  s_add_u32 s23, s24, 0
  buffer_load_dwordx4 v89, s[8:11], s23 offen  lds
  s_add_u32 m0, s40, 11264
  s_add_u32 s23, s24, 131072
  buffer_load_dwordx4 v89, s[8:11], s23 offen  lds
  s_waitcnt vmcnt(33)
  ds_read_b64_tr_b16 a[144:145], v92 offset:14336
  ds_read_b64_tr_b16 a[146:147], v93 offset:14336
  ds_read_b64_tr_b16 a[148:149], v92 offset:15360
  ds_read_b64_tr_b16 a[150:151], v93 offset:15360
  s_waitcnt lgkmcnt(4)
  s_mov_b32 s8, s54
  s_mov_b32 s9, s55
  s_mov_b32 s24, 1835008
  s_add_u32 m0, s40, 12288
  s_add_u32 s23, s24, 0
  buffer_load_dwordx4 v89, s[8:11], s23 offen  lds
  s_add_u32 m0, s40, 13312
  s_add_u32 s23, s24, 131072
  buffer_load_dwordx4 v89, s[8:11], s23 offen  lds
  s_waitcnt vmcnt(33)
  ds_read_b64_tr_b16 v[144:145], v92 offset:16384
  ds_read_b64_tr_b16 v[146:147], v93 offset:16384
  ds_read_b64_tr_b16 v[148:149], v92 offset:17408
  ds_read_b64_tr_b16 v[150:151], v93 offset:17408
  s_waitcnt lgkmcnt(4)
  s_mov_b32 s8, s58
  s_mov_b32 s9, s59
  s_add_u32 m0, s40, 14336
  s_mov_b32 s23, 98560
  buffer_load_dwordx4 v90, s[8:11], s23 offen  lds
  s_add_u32 m0, s40, 15360
  s_mov_b32 s23, 114944
  buffer_load_dwordx4 v90, s[8:11], s23 offen  lds
  s_waitcnt vmcnt(33)
  ds_read_b64_tr_b16 a[24:25], v92 offset:18432
  ds_read_b64_tr_b16 a[26:27], v93 offset:18432
  ds_read_b64_tr_b16 a[28:29], v92 offset:19456
  ds_read_b64_tr_b16 a[30:31], v93 offset:19456
  s_waitcnt lgkmcnt(4)
  s_mov_b32 s8, s52
  s_mov_b32 s9, s53
  s_mov_b32 s24, 2097152
  s_add_u32 m0, s40, 16384
  s_add_u32 s23, s24, 0
  buffer_load_dwordx4 v89, s[8:11], s23 offen  lds
  s_add_u32 m0, s40, 17408
  s_add_u32 s23, s24, 131072
  buffer_load_dwordx4 v89, s[8:11], s23 offen  lds
  s_waitcnt vmcnt(33)
  ds_read_b64_tr_b16 a[152:153], v92 offset:20480
  ds_read_b64_tr_b16 a[154:155], v93 offset:20480
  ds_read_b64_tr_b16 a[156:157], v92 offset:21504
  ds_read_b64_tr_b16 a[158:159], v93 offset:21504
  s_waitcnt lgkmcnt(4)
  s_mov_b32 s8, s54
  s_mov_b32 s9, s55
  s_mov_b32 s24, 2097152
  s_add_u32 m0, s40, 18432
  s_add_u32 s23, s24, 0
  buffer_load_dwordx4 v89, s[8:11], s23 offen  lds
  s_add_u32 m0, s40, 19456
  s_add_u32 s23, s24, 131072
  buffer_load_dwordx4 v89, s[8:11], s23 offen  lds
  s_waitcnt vmcnt(33)
  ds_read_b64_tr_b16 v[152:153], v92 offset:22528
  ds_read_b64_tr_b16 v[154:155], v93 offset:22528
  ds_read_b64_tr_b16 v[156:157], v92 offset:23552
  ds_read_b64_tr_b16 v[158:159], v93 offset:23552
  s_waitcnt lgkmcnt(4)
  s_mov_b32 s8, s58
  s_mov_b32 s9, s59
  s_add_u32 m0, s40, 20480
  s_mov_b32 s23, 512
  buffer_load_dwordx4 v90, s[8:11], s23 offen  lds
  s_add_u32 m0, s40, 21504
  s_mov_b32 s23, 16896
  buffer_load_dwordx4 v90, s[8:11], s23 offen  lds
  s_waitcnt vmcnt(33)
  ds_read_b64_tr_b16 a[32:33], v92 offset:24576
  ds_read_b64_tr_b16 a[34:35], v93 offset:24576
  ds_read_b64_tr_b16 a[36:37], v92 offset:25600
  ds_read_b64_tr_b16 a[38:39], v93 offset:25600
  s_waitcnt lgkmcnt(4)
  s_mov_b32 s8, s52
  s_mov_b32 s9, s53
  s_mov_b32 s24, 2359296
  s_add_u32 m0, s40, 22528
  s_add_u32 s23, s24, 0
  buffer_load_dwordx4 v89, s[8:11], s23 offen  lds
  s_add_u32 m0, s40, 23552
  s_add_u32 s23, s24, 131072
  buffer_load_dwordx4 v89, s[8:11], s23 offen  lds
  s_waitcnt vmcnt(33)
  ds_read_b64_tr_b16 a[160:161], v92 offset:26624
  ds_read_b64_tr_b16 a[162:163], v93 offset:26624
  ds_read_b64_tr_b16 a[164:165], v92 offset:27648
  ds_read_b64_tr_b16 a[166:167], v93 offset:27648
  s_waitcnt lgkmcnt(4)
  s_mov_b32 s8, s54
  s_mov_b32 s9, s55
  s_mov_b32 s24, 2359296
  s_add_u32 m0, s40, 24576
  s_add_u32 s23, s24, 0
  buffer_load_dwordx4 v89, s[8:11], s23 offen  lds
  s_add_u32 m0, s40, 25600
  s_add_u32 s23, s24, 131072
  buffer_load_dwordx4 v89, s[8:11], s23 offen  lds
  s_waitcnt vmcnt(33)
  ds_read_b64_tr_b16 v[160:161], v92 offset:28672
  ds_read_b64_tr_b16 v[162:163], v93 offset:28672
  ds_read_b64_tr_b16 v[164:165], v92 offset:29696
  ds_read_b64_tr_b16 v[166:167], v93 offset:29696
  s_waitcnt lgkmcnt(4)
  s_mov_b32 s8, s58
  s_mov_b32 s9, s59
  s_add_u32 m0, s40, 26624
  s_mov_b32 s23, 33280
  buffer_load_dwordx4 v90, s[8:11], s23 offen  lds
  s_add_u32 m0, s40, 27648
  s_mov_b32 s23, 49664
  buffer_load_dwordx4 v90, s[8:11], s23 offen  lds
  s_waitcnt vmcnt(33)
  ds_read_b64_tr_b16 a[40:41], v92 offset:30720
  ds_read_b64_tr_b16 a[42:43], v93 offset:30720
  ds_read_b64_tr_b16 a[44:45], v92 offset:31744
  ds_read_b64_tr_b16 a[46:47], v93 offset:31744
  s_waitcnt lgkmcnt(4)
  s_mov_b32 s8, s52
  s_mov_b32 s9, s53
  s_mov_b32 s24, 2621440
  s_add_u32 m0, s40, 28672
  s_add_u32 s23, s24, 0
  buffer_load_dwordx4 v89, s[8:11], s23 offen  lds
  s_add_u32 m0, s40, 29696
  s_add_u32 s23, s24, 131072
  buffer_load_dwordx4 v89, s[8:11], s23 offen  lds
  s_waitcnt vmcnt(28)
  ds_read_b64_tr_b16 a[168:169], v92 offset:0
  ds_read_b64_tr_b16 a[170:171], v93 offset:0
  ds_read_b64_tr_b16 a[172:173], v92 offset:1024
  ds_read_b64_tr_b16 a[174:175], v93 offset:1024
  s_waitcnt lgkmcnt(4)
  s_mov_b32 s8, s54
  s_mov_b32 s9, s55
  s_mov_b32 s24, 2621440
  s_add_u32 m0, s40, 30720
  s_add_u32 s23, s24, 0
  buffer_load_dwordx4 v89, s[8:11], s23 offen  lds
  s_add_u32 m0, s40, 31744
  s_add_u32 s23, s24, 131072
  buffer_load_dwordx4 v89, s[8:11], s23 offen  lds
  s_waitcnt vmcnt(28)
  ds_read_b64_tr_b16 v[168:169], v92 offset:2048
  ds_read_b64_tr_b16 v[170:171], v93 offset:2048
  ds_read_b64_tr_b16 v[172:173], v92 offset:3072
  ds_read_b64_tr_b16 v[174:175], v93 offset:3072
  s_waitcnt lgkmcnt(4)
  s_mov_b32 s8, s58
  s_mov_b32 s9, s59
  s_add_u32 m0, s40, 0
  s_mov_b32 s23, 66048
  buffer_load_dwordx4 v90, s[8:11], s23 offen  lds
  s_add_u32 m0, s40, 1024
  s_mov_b32 s23, 82432
  buffer_load_dwordx4 v90, s[8:11], s23 offen  lds
  s_mov_b32 s24, 0
  s_lshl_b32 s22, s19, 2
wl_1:
  buffer_load_dword v1, off, s[12:15], s22 offset:128 sc1
  s_add_u32 s24, s24, 1
  s_cmp_gt_u32 s24, 4000000
  s_cbranch_scc1 k_exit
  s_waitcnt vmcnt(0)
  v_cmp_eq_u32 vcc, 0, v1
  s_cbranch_vccnz wl_1
  s_barrier
  s_cmp_lg_u32 s18, 0
  s_cbranch_scc1 gf_2
  s_lshl_b32 s22, s19, 10
  s_lshl_b32 s23, s17, 2
  s_add_u32 s22, s22, s23
  s_add_u32 s22, s22, 49536
  v_mov_b32 v1, 1
  s_mov_b64 exec, 1
  buffer_store_dword v1, off, s[4:7], s22 sc1
  s_mov_b64 exec, -1
gf_2:
  ds_read_b64_tr_b16 a[48:49], v92 offset:4096
  ds_read_b64_tr_b16 a[50:51], v93 offset:4096
  ds_read_b64_tr_b16 a[52:53], v92 offset:5120
  ds_read_b64_tr_b16 a[54:55], v93 offset:5120
  s_waitcnt lgkmcnt(4)
  s_mov_b32 s8, s52
  s_mov_b32 s9, s53
  s_mov_b32 s24, 2883584
  s_add_u32 m0, s40, 2048
  s_add_u32 s23, s24, 0
  buffer_load_dwordx4 v89, s[8:11], s23 offen  lds
  s_add_u32 m0, s40, 3072
  s_add_u32 s23, s24, 131072
  buffer_load_dwordx4 v89, s[8:11], s23 offen  lds
  ds_read_b64_tr_b16 a[176:177], v92 offset:6144
  ds_read_b64_tr_b16 a[178:179], v93 offset:6144
  ds_read_b64_tr_b16 a[180:181], v92 offset:7168
  ds_read_b64_tr_b16 a[182:183], v93 offset:7168
  s_waitcnt lgkmcnt(4)
  s_mov_b32 s8, s54
  s_mov_b32 s9, s55
  s_mov_b32 s24, 2883584
  s_add_u32 m0, s40, 4096
  s_add_u32 s23, s24, 0
  buffer_load_dwordx4 v89, s[8:11], s23 offen  lds
  s_add_u32 m0, s40, 5120
  s_add_u32 s23, s24, 131072
  buffer_load_dwordx4 v89, s[8:11], s23 offen  lds
  ds_read_b64_tr_b16 v[176:177], v92 offset:8192
  ds_read_b64_tr_b16 v[178:179], v93 offset:8192
  ds_read_b64_tr_b16 v[180:181], v92 offset:9216
  ds_read_b64_tr_b16 v[182:183], v93 offset:9216
  s_waitcnt lgkmcnt(4)
  s_mov_b32 s8, s58
  s_mov_b32 s9, s59
  s_add_u32 m0, s40, 6144
  s_mov_b32 s23, 98816
  buffer_load_dwordx4 v90, s[8:11], s23 offen  lds
  s_add_u32 m0, s40, 7168
  s_mov_b32 s23, 115200
  buffer_load_dwordx4 v90, s[8:11], s23 offen  lds
  ds_read_b64_tr_b16 a[56:57], v92 offset:10240
  ds_read_b64_tr_b16 a[58:59], v93 offset:10240
  ds_read_b64_tr_b16 a[60:61], v92 offset:11264
  ds_read_b64_tr_b16 a[62:63], v93 offset:11264
  s_waitcnt lgkmcnt(4)
  s_mov_b32 s8, s52
  s_mov_b32 s9, s53
  s_mov_b32 s24, 3145728
  s_add_u32 m0, s40, 8192
  s_add_u32 s23, s24, 0
  buffer_load_dwordx4 v89, s[8:11], s23 offen  lds
  s_add_u32 m0, s40, 9216
  s_add_u32 s23, s24, 131072
  buffer_load_dwordx4 v89, s[8:11], s23 offen  lds
  ds_read_b64_tr_b16 a[184:185], v92 offset:12288
  ds_read_b64_tr_b16 a[186:187], v93 offset:12288
  ds_read_b64_tr_b16 a[188:189], v92 offset:13312
  ds_read_b64_tr_b16 a[190:191], v93 offset:13312
  s_waitcnt lgkmcnt(4)
  s_mov_b32 s8, s54
  s_mov_b32 s9, s55
  s_mov_b32 s24, 3145728
  s_add_u32 m0, s40, 10240
  s_add_u32 s23, s24, 0
  buffer_load_dwordx4 v89, s[8:11], s23 offen  lds
  s_add_u32 m0, s40, 11264
  s_add_u32 s23, s24, 131072
  buffer_load_dwordx4 v89, s[8:11], s23 offen  lds
  ds_read_b64_tr_b16 v[184:185], v92 offset:14336
  ds_read_b64_tr_b16 v[186:187], v93 offset:14336
  ds_read_b64_tr_b16 v[188:189], v92 offset:15360
  ds_read_b64_tr_b16 v[190:191], v93 offset:15360
  s_waitcnt lgkmcnt(4)
  s_mov_b32 s8, s58
  s_mov_b32 s9, s59
  s_add_u32 m0, s40, 12288
  s_mov_b32 s23, 768
  buffer_load_dwordx4 v90, s[8:11], s23 offen  lds
  s_add_u32 m0, s40, 13312
  s_mov_b32 s23, 17152
  buffer_load_dwordx4 v90, s[8:11], s23 offen  lds
  ds_read_b64_tr_b16 a[64:65], v92 offset:16384
  ds_read_b64_tr_b16 a[66:67], v93 offset:16384
  ds_read_b64_tr_b16 a[68:69], v92 offset:17408
  ds_read_b64_tr_b16 a[70:71], v93 offset:17408
  s_waitcnt lgkmcnt(4)
  s_mov_b32 s8, s52
  s_mov_b32 s9, s53
  s_mov_b32 s24, 3407872
  s_add_u32 m0, s40, 14336
  s_add_u32 s23, s24, 0
  buffer_load_dwordx4 v89, s[8:11], s23 offen  lds
  s_add_u32 m0, s40, 15360
  s_add_u32 s23, s24, 131072
  buffer_load_dwordx4 v89, s[8:11], s23 offen  lds
  ds_read_b64_tr_b16 a[192:193], v92 offset:18432
  ds_read_b64_tr_b16 a[194:195], v93 offset:18432
  ds_read_b64_tr_b16 a[196:197], v92 offset:19456
  ds_read_b64_tr_b16 a[198:199], v93 offset:19456
  s_waitcnt lgkmcnt(4)
  s_mov_b32 s8, s54
  s_mov_b32 s9, s55
  s_mov_b32 s24, 3407872
  s_add_u32 m0, s40, 16384
  s_add_u32 s23, s24, 0
  buffer_load_dwordx4 v89, s[8:11], s23 offen  lds
  s_add_u32 m0, s40, 17408
  s_add_u32 s23, s24, 131072
  buffer_load_dwordx4 v89, s[8:11], s23 offen  lds
  ds_read_b64_tr_b16 v[192:193], v92 offset:20480
  ds_read_b64_tr_b16 v[194:195], v93 offset:20480
  ds_read_b64_tr_b16 v[196:197], v92 offset:21504
  ds_read_b64_tr_b16 v[198:199], v93 offset:21504
  s_waitcnt lgkmcnt(4)
  s_mov_b32 s8, s58
  s_mov_b32 s9, s59
  s_add_u32 m0, s40, 18432
  s_mov_b32 s23, 33536
  buffer_load_dwordx4 v90, s[8:11], s23 offen  lds
  s_add_u32 m0, s40, 19456
  s_mov_b32 s23, 49920
  buffer_load_dwordx4 v90, s[8:11], s23 offen  lds
  ds_read_b64_tr_b16 a[72:73], v92 offset:22528
  ds_read_b64_tr_b16 a[74:75], v93 offset:22528
  ds_read_b64_tr_b16 a[76:77], v92 offset:23552
  ds_read_b64_tr_b16 a[78:79], v93 offset:23552
  s_waitcnt lgkmcnt(4)
  s_mov_b32 s8, s52
  s_mov_b32 s9, s53
  s_mov_b32 s24, 3670016
  s_add_u32 m0, s40, 20480
  s_add_u32 s23, s24, 0
  buffer_load_dwordx4 v89, s[8:11], s23 offen  lds
  s_add_u32 m0, s40, 21504
  s_add_u32 s23, s24, 131072
  buffer_load_dwordx4 v89, s[8:11], s23 offen  lds
  ds_read_b64_tr_b16 a[200:201], v92 offset:24576
  ds_read_b64_tr_b16 a[202:203], v93 offset:24576
  ds_read_b64_tr_b16 a[204:205], v92 offset:25600
  ds_read_b64_tr_b16 a[206:207], v93 offset:25600
  s_waitcnt lgkmcnt(4)
  s_mov_b32 s8, s54
  s_mov_b32 s9, s55
  s_mov_b32 s24, 3670016
  s_add_u32 m0, s40, 22528
  s_add_u32 s23, s24, 0
  buffer_load_dwordx4 v89, s[8:11], s23 offen  lds
  s_add_u32 m0, s40, 23552
  s_add_u32 s23, s24, 131072
  buffer_load_dwordx4 v89, s[8:11], s23 offen  lds
  ds_read_b64_tr_b16 v[200:201], v92 offset:26624
  ds_read_b64_tr_b16 v[202:203], v93 offset:26624
  ds_read_b64_tr_b16 v[204:205], v92 offset:27648
  ds_read_b64_tr_b16 v[206:207], v93 offset:27648
  s_waitcnt lgkmcnt(4)
  s_mov_b32 s8, s58
  s_mov_b32 s9, s59
  s_add_u32 m0, s40, 24576
  s_mov_b32 s23, 66304
  buffer_load_dwordx4 v90, s[8:11], s23 offen  lds
  s_add_u32 m0, s40, 25600
  s_mov_b32 s23, 82688
  buffer_load_dwordx4 v90, s[8:11], s23 offen  lds
  ds_read_b64_tr_b16 a[80:81], v92 offset:28672
  ds_read_b64_tr_b16 a[82:83], v93 offset:28672
  ds_read_b64_tr_b16 a[84:85], v92 offset:29696
  ds_read_b64_tr_b16 a[86:87], v93 offset:29696
  s_waitcnt lgkmcnt(4)
  s_mov_b32 s8, s52
  s_mov_b32 s9, s53
  s_mov_b32 s24, 3932160
  s_add_u32 m0, s40, 26624
  s_add_u32 s23, s24, 0
  buffer_load_dwordx4 v89, s[8:11], s23 offen  lds
  s_add_u32 m0, s40, 27648
  s_add_u32 s23, s24, 131072
  buffer_load_dwordx4 v89, s[8:11], s23 offen  lds
  ds_read_b64_tr_b16 a[208:209], v92 offset:30720
  ds_read_b64_tr_b16 a[210:211], v93 offset:30720
  ds_read_b64_tr_b16 a[212:213], v92 offset:31744
  ds_read_b64_tr_b16 a[214:215], v93 offset:31744
  s_waitcnt lgkmcnt(4)
  s_mov_b32 s8, s54
  s_mov_b32 s9, s55
  s_mov_b32 s24, 3932160
  s_add_u32 m0, s40, 28672
  s_add_u32 s23, s24, 0
  buffer_load_dwordx4 v89, s[8:11], s23 offen  lds
  s_add_u32 m0, s40, 29696
  s_add_u32 s23, s24, 131072
  buffer_load_dwordx4 v89, s[8:11], s23 offen  lds
  ds_read_b64_tr_b16 v[208:209], v92 offset:0
  ds_read_b64_tr_b16 v[210:211], v93 offset:0
  ds_read_b64_tr_b16 v[212:213], v92 offset:1024
  ds_read_b64_tr_b16 v[214:215], v93 offset:1024
  s_waitcnt lgkmcnt(4)
  s_mov_b32 s8, s58
  s_mov_b32 s9, s59
  s_add_u32 m0, s40, 30720
  s_mov_b32 s23, 99072
  buffer_load_dwordx4 v90, s[8:11], s23 offen  lds
  s_add_u32 m0, s40, 31744
  s_mov_b32 s23, 115456
  buffer_load_dwordx4 v90, s[8:11], s23 offen  lds
  s_waitcnt vmcnt(28)
  ds_read_b64_tr_b16 a[88:89], v92 offset:2048
  ds_read_b64_tr_b16 a[90:91], v93 offset:2048
  ds_read_b64_tr_b16 a[92:93], v92 offset:3072
  ds_read_b64_tr_b16 a[94:95], v93 offset:3072
  s_waitcnt lgkmcnt(4)
  s_mov_b32 s8, s56
  s_mov_b32 s9, s57
  s_mov_b32 s24, 0
  s_add_u32 m0, s40, 0
  s_add_u32 s23, s24, 0
  buffer_load_dwordx4 v89, s[8:11], s23 offen  lds
  s_add_u32 m0, s40, 1024
  s_add_u32 s23, s24, 131072
  buffer_load_dwordx4 v89, s[8:11], s23 offen  lds
  s_waitcnt vmcnt(28)
  ds_read_b64_tr_b16 a[216:217], v92 offset:4096
  ds_read_b64_tr_b16 a[218:219], v93 offset:4096
  ds_read_b64_tr_b16 a[220:221], v92 offset:5120
  ds_read_b64_tr_b16 a[222:223], v93 offset:5120
  s_waitcnt lgkmcnt(4)
  s_mov_b32 s24, 262144
  s_add_u32 m0, s40, 2048
  s_add_u32 s23, s24, 0
  buffer_load_dwordx4 v89, s[8:11], s23 offen  lds
  s_add_u32 m0, s40, 3072
  s_add_u32 s23, s24, 131072
  buffer_load_dwordx4 v89, s[8:11], s23 offen  lds
  s_waitcnt vmcnt(28)
  ds_read_b64_tr_b16 v[216:217], v92 offset:6144
  ds_read_b64_tr_b16 v[218:219], v93 offset:6144
  ds_read_b64_tr_b16 v[220:221], v92 offset:7168
  ds_read_b64_tr_b16 v[222:223], v93 offset:7168
  s_waitcnt lgkmcnt(4)
  s_mov_b32 s24, 524288
  s_add_u32 m0, s40, 4096
  s_add_u32 s23, s24, 0
  buffer_load_dwordx4 v89, s[8:11], s23 offen  lds
  s_add_u32 m0, s40, 5120
  s_add_u32 s23, s24, 131072
  buffer_load_dwordx4 v89, s[8:11], s23 offen  lds
  s_waitcnt vmcnt(28)
  ds_read_b64_tr_b16 a[96:97], v92 offset:8192
  ds_read_b64_tr_b16 a[98:99], v93 offset:8192
  ds_read_b64_tr_b16 a[100:101], v92 offset:9216
  ds_read_b64_tr_b16 a[102:103], v93 offset:9216
  s_waitcnt lgkmcnt(4)
  s_mov_b32 s24, 786432
  s_add_u32 m0, s40, 6144
  s_add_u32 s23, s24, 0
  buffer_load_dwordx4 v89, s[8:11], s23 offen  lds
  s_add_u32 m0, s40, 7168
  s_add_u32 s23, s24, 131072
  buffer_load_dwordx4 v89, s[8:11], s23 offen  lds
  s_waitcnt vmcnt(28)
  ds_read_b64_tr_b16 a[224:225], v92 offset:10240
  ds_read_b64_tr_b16 a[226:227], v93 offset:10240
  ds_read_b64_tr_b16 a[228:229], v92 offset:11264
  ds_read_b64_tr_b16 a[230:231], v93 offset:11264
  s_waitcnt lgkmcnt(4)
  s_mov_b32 s24, 1048576
  s_add_u32 m0, s40, 8192
  s_add_u32 s23, s24, 0
  buffer_load_dwordx4 v89, s[8:11], s23 offen  lds
  s_add_u32 m0, s40, 9216
  s_add_u32 s23, s24, 131072
  buffer_load_dwordx4 v89, s[8:11], s23 offen  lds
  s_waitcnt vmcnt(28)
  ds_read_b64_tr_b16 v[224:225], v92 offset:12288
  ds_read_b64_tr_b16 v[226:227], v93 offset:12288
  ds_read_b64_tr_b16 v[228:229], v92 offset:13312
  ds_read_b64_tr_b16 v[230:231], v93 offset:13312
  s_waitcnt lgkmcnt(4)
  s_mov_b32 s24, 1310720
  s_add_u32 m0, s40, 10240
  s_add_u32 s23, s24, 0
  buffer_load_dwordx4 v89, s[8:11], s23 offen  lds
  s_add_u32 m0, s40, 11264
  s_add_u32 s23, s24, 131072
  buffer_load_dwordx4 v89, s[8:11], s23 offen  lds
  s_waitcnt vmcnt(28)
  ds_read_b64_tr_b16 a[104:105], v92 offset:14336
  ds_read_b64_tr_b16 a[106:107], v93 offset:14336
  ds_read_b64_tr_b16 a[108:109], v92 offset:15360
  ds_read_b64_tr_b16 a[110:111], v93 offset:15360
  s_waitcnt lgkmcnt(4)
  s_mov_b32 s24, 1572864
  s_add_u32 m0, s40, 12288
  s_add_u32 s23, s24, 0
  buffer_load_dwordx4 v89, s[8:11], s23 offen  lds
  s_add_u32 m0, s40, 13312
  s_add_u32 s23, s24, 131072
  buffer_load_dwordx4 v89, s[8:11], s23 offen  lds
  s_waitcnt vmcnt(28)
  ds_read_b64_tr_b16 a[232:233], v92 offset:16384
  ds_read_b64_tr_b16 a[234:235], v93 offset:16384
  ds_read_b64_tr_b16 a[236:237], v92 offset:17408
  ds_read_b64_tr_b16 a[238:239], v93 offset:17408
  s_waitcnt lgkmcnt(4)
  s_mov_b32 s24, 1835008
  s_add_u32 m0, s40, 14336
  s_add_u32 s23, s24, 0
  buffer_load_dwordx4 v89, s[8:11], s23 offen  lds
  s_add_u32 m0, s40, 15360
  s_add_u32 s23, s24, 131072
  buffer_load_dwordx4 v89, s[8:11], s23 offen  lds
  s_waitcnt vmcnt(28)
  ds_read_b64_tr_b16 v[232:233], v92 offset:18432
  ds_read_b64_tr_b16 v[234:235], v93 offset:18432
  ds_read_b64_tr_b16 v[236:237], v92 offset:19456
  ds_read_b64_tr_b16 v[238:239], v93 offset:19456
  s_waitcnt lgkmcnt(4)
  s_mov_b32 s24, 2097152
  s_add_u32 m0, s40, 16384
  s_add_u32 s23, s24, 0
  buffer_load_dwordx4 v89, s[8:11], s23 offen  lds
  s_add_u32 m0, s40, 17408
  s_add_u32 s23, s24, 131072
  buffer_load_dwordx4 v89, s[8:11], s23 offen  lds
  s_waitcnt vmcnt(28)
  ds_read_b64_tr_b16 a[112:113], v92 offset:20480
  ds_read_b64_tr_b16 a[114:115], v93 offset:20480
  ds_read_b64_tr_b16 a[116:117], v92 offset:21504
  ds_read_b64_tr_b16 a[118:119], v93 offset:21504
  s_waitcnt lgkmcnt(4)
  s_mov_b32 s24, 2359296
  s_add_u32 m0, s40, 18432
  s_add_u32 s23, s24, 0
  buffer_load_dwordx4 v89, s[8:11], s23 offen  lds
  s_add_u32 m0, s40, 19456
  s_add_u32 s23, s24, 131072
  buffer_load_dwordx4 v89, s[8:11], s23 offen  lds
  s_waitcnt vmcnt(28)
  ds_read_b64_tr_b16 a[240:241], v92 offset:22528
  ds_read_b64_tr_b16 a[242:243], v93 offset:22528
  ds_read_b64_tr_b16 a[244:245], v92 offset:23552
  ds_read_b64_tr_b16 a[246:247], v93 offset:23552
  s_waitcnt lgkmcnt(4)
  s_mov_b32 s24, 2621440
  s_add_u32 m0, s40, 20480
  s_add_u32 s23, s24, 0
  buffer_load_dwordx4 v89, s[8:11], s23 offen  lds
  s_add_u32 m0, s40, 21504
  s_add_u32 s23, s24, 131072
  buffer_load_dwordx4 v89, s[8:11], s23 offen  lds
  s_waitcnt vmcnt(28)
  ds_read_b64_tr_b16 v[240:241], v92 offset:24576
  ds_read_b64_tr_b16 v[242:243], v93 offset:24576
  ds_read_b64_tr_b16 v[244:245], v92 offset:25600
  ds_read_b64_tr_b16 v[246:247], v93 offset:25600
  s_waitcnt lgkmcnt(4)
  s_mov_b32 s24, 2883584
  s_add_u32 m0, s40, 22528
  s_add_u32 s23, s24, 0
  buffer_load_dwordx4 v89, s[8:11], s23 offen  lds
  s_add_u32 m0, s40, 23552
  s_add_u32 s23, s24, 131072
  buffer_load_dwordx4 v89, s[8:11], s23 offen  lds
  s_waitcnt vmcnt(28)
  ds_read_b64_tr_b16 a[120:121], v92 offset:26624
  ds_read_b64_tr_b16 a[122:123], v93 offset:26624
  ds_read_b64_tr_b16 a[124:125], v92 offset:27648
  ds_read_b64_tr_b16 a[126:127], v93 offset:27648
  s_waitcnt lgkmcnt(4)
  s_mov_b32 s24, 3145728
  s_add_u32 m0, s40, 24576
  s_add_u32 s23, s24, 0
  buffer_load_dwordx4 v89, s[8:11], s23 offen  lds
  s_add_u32 m0, s40, 25600
  s_add_u32 s23, s24, 131072
  buffer_load_dwordx4 v89, s[8:11], s23 offen  lds
  s_waitcnt vmcnt(28)
  ds_read_b64_tr_b16 a[248:249], v92 offset:28672
  ds_read_b64_tr_b16 a[250:251], v93 offset:28672
  ds_read_b64_tr_b16 a[252:253], v92 offset:29696
  ds_read_b64_tr_b16 a[254:255], v93 offset:29696
  s_waitcnt lgkmcnt(4)
  s_mov_b32 s24, 3407872
  s_add_u32 m0, s40, 26624
  s_add_u32 s23, s24, 0
  buffer_load_dwordx4 v89, s[8:11], s23 offen  lds
  s_add_u32 m0, s40, 27648
  s_add_u32 s23, s24, 131072
  buffer_load_dwordx4 v89, s[8:11], s23 offen  lds
  s_waitcnt vmcnt(28)
  ds_read_b64_tr_b16 v[248:249], v92 offset:30720
  ds_read_b64_tr_b16 v[250:251], v93 offset:30720
  ds_read_b64_tr_b16 v[252:253], v92 offset:31744
  ds_read_b64_tr_b16 v[254:255], v93 offset:31744
  s_waitcnt lgkmcnt(4)
  s_mov_b32 s24, 3670016
  s_add_u32 m0, s40, 28672
  s_add_u32 s23, s24, 0
  buffer_load_dwordx4 v89, s[8:11], s23 offen  lds
  s_add_u32 m0, s40, 29696
  s_add_u32 s23, s24, 131072
  buffer_load_dwordx4 v89, s[8:11], s23 offen  lds
  s_waitcnt lgkmcnt(0)
  s_mov_b32 s24, 3932160
  s_add_u32 m0, s40, 30720
  s_add_u32 s23, s24, 0
  buffer_load_dwordx4 v89, s[8:11], s23 offen  lds
  s_add_u32 m0, s40, 31744
  s_add_u32 s23, s24, 131072
  buffer_load_dwordx4 v89, s[8:11], s23 offen  lds
  v_lshlrev_b32 v96, 4, v88
  v_add_u32 v96, s40, v96
  s_waitcnt vmcnt(30)
  ds_read_b64_tr_b16 v[0:1], v92 offset:0
  ds_read_b64_tr_b16 v[2:3], v93 offset:0
  ds_read_b64_tr_b16 v[4:5], v92 offset:1024
  ds_read_b64_tr_b16 v[6:7], v93 offset:1024
  s_waitcnt vmcnt(28)
  ds_read_b64_tr_b16 v[8:9], v92 offset:2048
  ds_read_b64_tr_b16 v[10:11], v93 offset:2048
  ds_read_b64_tr_b16 v[12:13], v92 offset:3072
  ds_read_b64_tr_b16 v[14:15], v93 offset:3072
  s_waitcnt vmcnt(26)
  ds_read_b64_tr_b16 v[16:17], v92 offset:4096
  ds_read_b64_tr_b16 v[18:19], v93 offset:4096
  ds_read_b64_tr_b16 v[20:21], v92 offset:5120
  ds_read_b64_tr_b16 v[22:23], v93 offset:5120
  s_waitcnt vmcnt(24)
  ds_read_b64_tr_b16 v[24:25], v92 offset:6144
  ds_read_b64_tr_b16 v[26:27], v93 offset:6144
  ds_read_b64_tr_b16 v[28:29], v92 offset:7168
  ds_read_b64_tr_b16 v[30:31], v93 offset:7168
  s_waitcnt lgkmcnt(0)
  ds_write_b128 v96, v[128:131] offset:0
  ds_write_b128 v96, v[132:135] offset:1024
  ds_write_b128 v96, v[136:139] offset:2048
  ds_write_b128 v96, v[140:143] offset:3072
  ds_write_b128 v96, v[144:147] offset:4096
  ds_write_b128 v96, v[148:151] offset:5120
  ds_write_b128 v96, v[152:155] offset:6144
  ds_write_b128 v96, v[156:159] offset:7168
  s_waitcnt lgkmcnt(0)
  v_mov_b64 v[128:129], v[0:1]
  v_mov_b64 v[130:131], v[2:3]
  v_mov_b64 v[132:133], v[4:5]
  v_mov_b64 v[134:135], v[6:7]
  v_mov_b64 v[136:137], v[8:9]
  v_mov_b64 v[138:139], v[10:11]
  v_mov_b64 v[140:141], v[12:13]
  v_mov_b64 v[142:143], v[14:15]
  v_mov_b64 v[144:145], v[16:17]
  v_mov_b64 v[146:147], v[18:19]
  v_mov_b64 v[148:149], v[20:21]
  v_mov_b64 v[150:151], v[22:23]
  v_mov_b64 v[152:153], v[24:25]
  v_mov_b64 v[154:155], v[26:27]
  v_mov_b64 v[156:157], v[28:29]
  v_mov_b64 v[158:159], v[30:31]
  s_waitcnt vmcnt(22)
  ds_read_b64_tr_b16 v[0:1], v92 offset:8192
  ds_read_b64_tr_b16 v[2:3], v93 offset:8192
  ds_read_b64_tr_b16 v[4:5], v92 offset:9216
  ds_read_b64_tr_b16 v[6:7], v93 offset:9216
  s_waitcnt vmcnt(20)
  ds_read_b64_tr_b16 v[8:9], v92 offset:10240
  ds_read_b64_tr_b16 v[10:11], v93 offset:10240
  ds_read_b64_tr_b16 v[12:13], v92 offset:11264
  ds_read_b64_tr_b16 v[14:15], v93 offset:11264
  s_waitcnt vmcnt(18)
  ds_read_b64_tr_b16 v[16:17], v92 offset:12288
  ds_read_b64_tr_b16 v[18:19], v93 offset:12288
  ds_read_b64_tr_b16 v[20:21], v92 offset:13312
  ds_read_b64_tr_b16 v[22:23], v93 offset:13312
  s_waitcnt vmcnt(16)
  ds_read_b64_tr_b16 v[24:25], v92 offset:14336
  ds_read_b64_tr_b16 v[26:27], v93 offset:14336
  ds_read_b64_tr_b16 v[28:29], v92 offset:15360
  ds_read_b64_tr_b16 v[30:31], v93 offset:15360
  s_waitcnt lgkmcnt(0)
  ds_write_b128 v96, v[160:163] offset:8192
  ds_write_b128 v96, v[164:167] offset:9216
  ds_write_b128 v96, v[168:171] offset:10240
  ds_write_b128 v96, v[172:175] offset:11264
  ds_write_b128 v96, v[176:179] offset:12288
  ds_write_b128 v96, v[180:183] offset:13312
  ds_write_b128 v96, v[184:187] offset:14336
  ds_write_b128 v96, v[188:191] offset:15360
  s_waitcnt lgkmcnt(0)
  v_mov_b64 v[160:161], v[0:1]
  v_mov_b64 v[162:163], v[2:3]
  v_mov_b64 v[164:165], v[4:5]
  v_mov_b64 v[166:167], v[6:7]
  v_mov_b64 v[168:169], v[8:9]
  v_mov_b64 v[170:171], v[10:11]
  v_mov_b64 v[172:173], v[12:13]
  v_mov_b64 v[174:175], v[14:15]
  v_mov_b64 v[176:177], v[16:17]
  v_mov_b64 v[178:179], v[18:19]
  v_mov_b64 v[180:181], v[20:21]
  v_mov_b64 v[182:183], v[22:23]
  v_mov_b64 v[184:185], v[24:25]
  v_mov_b64 v[186:187], v[26:27]
  v_mov_b64 v[188:189], v[28:29]
  v_mov_b64 v[190:191], v[30:31]
  s_waitcnt vmcnt(14)
  ds_read_b64_tr_b16 v[0:1], v92 offset:16384
  ds_read_b64_tr_b16 v[2:3], v93 offset:16384
  ds_read_b64_tr_b16 v[4:5], v92 offset:17408
  ds_read_b64_tr_b16 v[6:7], v93 offset:17408
  s_waitcnt vmcnt(12)
  ds_read_b64_tr_b16 v[8:9], v92 offset:18432
  ds_read_b64_tr_b16 v[10:11], v93 offset:18432
  ds_read_b64_tr_b16 v[12:13], v92 offset:19456
  ds_read_b64_tr_b16 v[14:15], v93 offset:19456
  s_waitcnt vmcnt(10)
  ds_read_b64_tr_b16 v[16:17], v92 offset:20480
  ds_read_b64_tr_b16 v[18:19], v93 offset:20480
  ds_read_b64_tr_b16 v[20:21], v92 offset:21504
  ds_read_b64_tr_b16 v[22:23], v93 offset:21504
  s_waitcnt vmcnt(8)
  ds_read_b64_tr_b16 v[24:25], v92 offset:22528
  ds_read_b64_tr_b16 v[26:27], v93 offset:22528
  ds_read_b64_tr_b16 v[28:29], v92 offset:23552
  ds_read_b64_tr_b16 v[30:31], v93 offset:23552
  s_waitcnt lgkmcnt(0)
  ds_write_b128 v96, v[192:195] offset:16384
  ds_write_b128 v96, v[196:199] offset:17408
  ds_write_b128 v96, v[200:203] offset:18432
  ds_write_b128 v96, v[204:207] offset:19456
  ds_write_b128 v96, v[208:211] offset:20480
  ds_write_b128 v96, v[212:215] offset:21504
  ds_write_b128 v96, v[216:219] offset:22528
  ds_write_b128 v96, v[220:223] offset:23552
  s_waitcnt lgkmcnt(0)
  v_mov_b64 v[192:193], v[0:1]
  v_mov_b64 v[194:195], v[2:3]
  v_mov_b64 v[196:197], v[4:5]
  v_mov_b64 v[198:199], v[6:7]
  v_mov_b64 v[200:201], v[8:9]
  v_mov_b64 v[202:203], v[10:11]
  v_mov_b64 v[204:205], v[12:13]
  v_mov_b64 v[206:207], v[14:15]
  v_mov_b64 v[208:209], v[16:17]
  v_mov_b64 v[210:211], v[18:19]
  v_mov_b64 v[212:213], v[20:21]
  v_mov_b64 v[214:215], v[22:23]
  v_mov_b64 v[216:217], v[24:25]
  v_mov_b64 v[218:219], v[26:27]
  v_mov_b64 v[220:221], v[28:29]
  v_mov_b64 v[222:223], v[30:31]
  s_waitcnt vmcnt(6)
  ds_read_b64_tr_b16 v[0:1], v92 offset:24576
  ds_read_b64_tr_b16 v[2:3], v93 offset:24576
  ds_read_b64_tr_b16 v[4:5], v92 offset:25600
  ds_read_b64_tr_b16 v[6:7], v93 offset:25600
  s_waitcnt vmcnt(4)
  ds_read_b64_tr_b16 v[8:9], v92 offset:26624
  ds_read_b64_tr_b16 v[10:11], v93 offset:26624
  ds_read_b64_tr_b16 v[12:13], v92 offset:27648
  ds_read_b64_tr_b16 v[14:15], v93 offset:27648
  s_waitcnt vmcnt(2)
  ds_read_b64_tr_b16 v[16:17], v92 offset:28672
  ds_read_b64_tr_b16 v[18:19], v93 offset:28672
  ds_read_b64_tr_b16 v[20:21], v92 offset:29696
  ds_read_b64_tr_b16 v[22:23], v93 offset:29696
  s_waitcnt vmcnt(0)
  ds_read_b64_tr_b16 v[24:25], v92 offset:30720
  ds_read_b64_tr_b16 v[26:27], v93 offset:30720
  ds_read_b64_tr_b16 v[28:29], v92 offset:31744
  ds_read_b64_tr_b16 v[30:31], v93 offset:31744
  s_waitcnt lgkmcnt(0)
  ds_write_b128 v96, v[224:227] offset:24576
  ds_write_b128 v96, v[228:231] offset:25600
  ds_write_b128 v96, v[232:235] offset:26624
  ds_write_b128 v96, v[236:239] offset:27648
  ds_write_b128 v96, v[240:243] offset:28672
  ds_write_b128 v96, v[244:247] offset:29696
  ds_write_b128 v96, v[248:251] offset:30720
  ds_write_b128 v96, v[252:255] offset:31744
  s_waitcnt lgkmcnt(0)
  v_mov_b64 v[224:225], v[0:1]
  v_mov_b64 v[226:227], v[2:3]
  v_mov_b64 v[228:229], v[4:5]
  v_mov_b64 v[230:231], v[6:7]
  v_mov_b64 v[232:233], v[8:9]
  v_mov_b64 v[234:235], v[10:11]
  v_mov_b64 v[236:237], v[12:13]
  v_mov_b64 v[238:239], v[14:15]
  v_mov_b64 v[240:241], v[16:17]
  v_mov_b64 v[242:243], v[18:19]
  v_mov_b64 v[244:245], v[20:21]
  v_mov_b64 v[246:247], v[22:23]
  v_mov_b64 v[248:249], v[24:25]
  v_mov_b64 v[250:251], v[26:27]
  v_mov_b64 v[252:253], v[28:29]
  v_mov_b64 v[254:255], v[30:31]
  v_lshlrev_b32 v104, 4, v88
  s_lshl_b32 s23, s18, 11
  v_add_u32 v105, s23, v104
  v_lshrrev_b32 v96, 4, v88
  v_lshlrev_b32 v96, 7, v96
  v_and_b32 v97, 7, v88
  v_lshl_add_u32 v115, v97, 4, v96
  v_add_u32 v106, s40, v104
  v_bfe_u32 v96, v88, 5, 1
  v_and_b32 v97, 15, v88
  v_lshl_add_u32 v96, v96, 4, v97
  v_lshlrev_b32 v96, 4, v96
  v_bfe_u32 v97, v88, 4, 1
  v_lshl_add_u32 v96, v97, 3, v96
  s_lshl_b32 s23, s18, 9
  v_add_u32 v96, s23, v96
  v_add_u32 v107, 24576, v96
  v_bfe_u32 v96, v88, 5, 1
  v_lshlrev_b32 v96, 8, v96
  v_bfe_u32 v97, v88, 4, 1
  v_lshl_add_u32 v96, v97, 6, v96
  v_bfe_u32 v97, v88, 2, 2
  v_lshl_add_u32 v96, v97, 4, v96
  v_and_b32 v97, 1, v88
  v_lshl_add_u32 v96, v97, 3, v96
  v_add_u32 v108, 24576, v96
  v_bfe_u32 v96, v88, 5, 1
  v_lshlrev_b32 v96, 7, v96
  v_and_b32 v97, 7, v88
  v_lshl_add_u32 v96, v97, 4, v96
  v_bfe_u32 v97, v88, 4, 1
  v_lshl_add_u32 v96, v97, 3, v96
  s_lshl_b32 s23, s18, 9
  s_add_u32 s23, s23, 28672
  v_add_u32 v109, s23, v96
  v_bfe_u32 v96, v88, 5, 1
  v_lshlrev_b32 v96, 13, v96
  v_bfe_u32 v97, v88, 4, 1
  v_lshl_add_u32 v96, v97, 12, v96
  v_bfe_u32 v97, v88, 3, 1
  v_lshl_add_u32 v96, v97, 11, v96
  v_and_b32 v97, 7, v88
  v_lshl_add_u32 v96, v97, 3, v96
  s_lshl_b32 s23, s18, 14
  s_lshl_b32 s24, s17, 6
  s_add_u32 s23, s23, s24
  v_add_u32 v110, s23, v96
  v_lshrrev_b32 v96, 4, v88
  v_lshlrev_b32 v96, 8, v96
  v_and_b32 v97, 3, v88
  v_lshl_add_u32 v96, v97, 6, v96
  v_bfe_u32 v97, v88, 2, 2
  v_lshl_add_u32 v96, v97, 4, v96
  s_lshl_b32 s23, s17, 13
  s_lshl_b32 s24, s18, 11
  s_add_u32 s23, s23, s24
  v_add_u32 v111, s23, v96
  v_and_b32 v96, 3, v88
  v_lshlrev_b32 v96, 4, v96
  v_lshrrev_b32 v97, 4, v88
  v_lshl_add_u32 v96, v97, 2, v96
  s_lshl_b32 s23, s17, 8
  s_and_b32 s24, s18, 1
  s_lshl_b32 s24, s24, 7
  s_add_u32 s23, s23, s24
  s_lshr_b32 s24, s18, 1
  s_lshl_b32 s24, s24, 6
  s_add_u32 s23, s23, s24
  v_add_u32 v112, s23, v96
  v_and_b32 v96, 8, v88
  v_cmp_ne_u32 vcc, 0, v96
  v_mov_b32 v97, 0x4444
  v_mov_b32 v98, 0xeeee
  v_cndmask_b32 v113, v97, v98, vcc
  v_and_b32 v96, 7, v88
  v_mov_b32 v97, 0x3f80
  v_mov_b32 v98, 0x3f800000
  v_cmp_eq_u32 vcc, 0, v96
  s_nop 1
  v_cndmask_b32 v116, 0, v97, vcc
  v_cmp_eq_u32 vcc, 1, v96
  s_nop 1
  v_cndmask_b32 v116, v116, v98, vcc
  v_mov_b32 v120, 0x3f803f80
  v_cmp_eq_u32 vcc, 2, v96
  s_nop 1
  v_cndmask_b32 v117, 0, v97, vcc
  v_cmp_eq_u32 vcc, 3, v96
  s_nop 1
  v_cndmask_b32 v117, v117, v98, vcc
  v_mov_b32 v121, 0x3f803f80
  v_cmp_eq_u32 vcc, 4, v96
  s_nop 1
  v_cndmask_b32 v118, 0, v97, vcc
  v_cmp_eq_u32 vcc, 5, v96
  s_nop 1
  v_cndmask_b32 v118, v118, v98, vcc
  v_mov_b32 v122, 0x3f803f80
  v_cmp_eq_u32 vcc, 6, v96
  s_nop 1
  v_cndmask_b32 v119, 0, v97, vcc
  v_cmp_eq_u32 vcc, 7, v96
  s_nop 1
  v_cndmask_b32 v119, v119, v98, vcc
  v_mov_b32 v123, 0x3f803f80
  s_mov_b32 s28, 0x3e0293ee
  s_mov_b32 s29, 0x3e0293ee
  s_mov_b32 s30, -1
  s_mov_b32 s31, 0
  s_mov_b32 s32, 0x000f000f
  s_mov_b32 s33, 0x000f000f
  v_mbcnt_lo_u32_b32 v1, -1, 0
  v_mbcnt_hi_u32_b32 v1, -1, v1
  v_lshlrev_b32 v1, 2, v1
  s_mov_b32 s24, 0
ch_census:
  buffer_load_dword v2, v1, s[12:15], 0 offen sc1
  s_add_u32 s24, s24, 1
  s_cmp_gt_u32 s24, 4000000
  s_cbranch_scc1 k_exit
  s_waitcnt vmcnt(0)
  s_mov_b32 s23, 0
  v_readlane_b32 s25, v2, 0
  v_readlane_b32 s26, v2, 40
  s_nop 3
  s_bcnt1_i32_b32 s25, s25
  s_add_u32 s23, s23, s26
  s_add_u32 s23, s23, s25
  v_readlane_b32 s25, v2, 1
  v_readlane_b32 s26, v2, 41
  s_nop 3
  s_bcnt1_i32_b32 s25, s25
  s_add_u32 s23, s23, s26
  s_add_u32 s23, s23, s25
  v_readlane_b32 s25, v2, 2
  v_readlane_b32 s26, v2, 42
  s_nop 3
  s_bcnt1_i32_b32 s25, s25
  s_add_u32 s23, s23, s26
  s_add_u32 s23, s23, s25
  v_readlane_b32 s25, v2, 3
  v_readlane_b32 s26, v2, 43
  s_nop 3
  s_bcnt1_i32_b32 s25, s25
  s_add_u32 s23, s23, s26
  s_add_u32 s23, s23, s25
  v_readlane_b32 s25, v2, 4
  v_readlane_b32 s26, v2, 44
  s_nop 3
  s_bcnt1_i32_b32 s25, s25
  s_add_u32 s23, s23, s26
  s_add_u32 s23, s23, s25
  v_readlane_b32 s25, v2, 5
  v_readlane_b32 s26, v2, 45
  s_nop 3
  s_bcnt1_i32_b32 s25, s25
  s_add_u32 s23, s23, s26
  s_add_u32 s23, s23, s25
  v_readlane_b32 s25, v2, 6
  v_readlane_b32 s26, v2, 46
  s_nop 3
  s_bcnt1_i32_b32 s25, s25
  s_add_u32 s23, s23, s26
  s_add_u32 s23, s23, s25
  v_readlane_b32 s25, v2, 7
  v_readlane_b32 s26, v2, 47
  s_nop 3
  s_bcnt1_i32_b32 s25, s25
  s_add_u32 s23, s23, s26
  s_add_u32 s23, s23, s25
  v_readlane_b32 s25, v2, 49
  s_nop 3
  s_add_u32 s23, s23, s25
  s_cmp_lt_u32 s23, 256
  s_cbranch_scc1 ch_census
  v_cmp_ne_u32 vcc, 0, v2
  s_nop 3
  s_and_b32 s23, vcc_hi, 0xff
  s_cmp_lg_u32 s23, 0xff
  s_cbranch_scc1 ch_census
  s_add_u32 s27, s19, 40
  v_readlane_b32 s23, v2, s19
  v_readlane_b32 s22, v2, s27
  s_nop 3
  s_bcnt1_i32_b32 s23, s23
  s_add_u32 s23, s23, s22
  s_cmp_ge_u32 s23, 32
  s_cselect_b32 s45, 1, 0
  s_mov_b32 s22, 49536
  v_mbcnt_lo_u32_b32 v2, -1, 0
  v_lshlrev_b32 v2, 2, v2
  v_and_b32 v2, 127, v2
  s_mov_b32 s24, 0
wg_3:
  buffer_load_dword v1, v2, s[4:7], s22 offen sc1
  s_add_u32 s24, s24, 1
  s_cmp_gt_u32 s24, 4000000
  s_cbranch_scc1 k_exit
  s_waitcnt vmcnt(0)
  v_cmp_eq_u32 vcc, 0, v1
  s_cbranch_vccnz wg_3
  s_cmp_eq_u32 s45, 0
  s_cbranch_scc1 chain_slow
ch_warm_start:
  s_mov_b32 s20, 0
  s_mov_b32 s21, 65536
  s_mov_b32 s47, 81920
  s_mov_b32 s22, 131072
  s_lshl_b32 s23, s17, 13
  s_add_u32 s34, s23, 4194304
  s_add_u32 s46, s23, 20971520
  s_add_u32 s35, s23, 37748736
  s_lshl_b32 s23, s17, 8
  s_add_u32 s36, s23, 8192
  s_lshl_b32 s23, s17, 11
  s_lshl_b32 s24, s18, 2
  s_add_u32 s23, s23, s24
  s_add_u32 s37, s23, 720896
  s_lshl_b32 s23, s18, 11
  s_add_u32 s48, s23, 8192
  s_add_u32 s49, s23, 16384
  s_add_u32 s52, s23, 0
  s_cmp_ge_u32 s17, 24
  s_cselect_b32 s50, 4, 0
  s_cselect_b32 s51, 0, 6
  s_mov_b32 s38, 0
ch_kvs_4:
  buffer_load_dword v114, off, s[4:7], s36 sc1
  s_add_u32 s38, s38, 1
  s_cmp_gt_u32 s38, 4000000
  s_cbranch_scc1 ch_bail_f
  s_waitcnt vmcnt(0)
  v_cmp_eq_u32 vcc, 0, v114
  s_cbranch_vccnz ch_kvs_4
  s_mov_b32 m0, s48
  s_nop 0
  buffer_load_dwordx4 v105, s[4:7], s34 offen sc1 lds
  buffer_load_dwordx4 v105, s[4:7], s34 offen offset:1024 sc1 lds
  s_mov_b32 m0, s49
  s_add_u32 s34, s34, 262144
  buffer_load_dwordx4 v105, s[4:7], s46 offen sc1 lds
  buffer_load_dwordx4 v105, s[4:7], s46 offen offset:1024 sc1 lds
  s_add_u32 s46, s46, 262144
  s_add_u32 s36, s36, 4
  buffer_load_dword v114, off, s[4:7], s36 sc1
  s_load_dwordx2 s[8:9], s[0:1], 8
  s_mov_b32 s10, 0x2000
  s_mov_b32 s11, 0x00020000
  v_mbcnt_lo_u32_b32 v88, -1, 0
  v_mbcnt_hi_u32_b32 v88, -1, v88
  v_and_b32 v89, 7, v88
  v_lshlrev_b32 v89, 10, v89
  v_lshrrev_b32 v90, 3, v88
  v_lshl_add_u32 v89, v90, 4, v89
  s_lshl_b32 s23, s18, 8
  s_waitcnt lgkmcnt(0)
  buffer_load_dwordx4 v[96:99], v89, s[8:11], s23 offen offset:0
  buffer_load_dwordx4 v[100:103], v89, s[8:11], s23 offen offset:128
  v_mov_b64 v[32:33], 0
  v_mov_b64 v[34:35], 0
  v_mov_b64 v[36:37], 0
  v_mov_b64 v[38:39], 0
  v_mov_b64 v[40:41], 0
  v_mov_b64 v[42:43], 0
  v_mov_b64 v[124:125], -1
  v_mov_b64 v[126:127], -1
  s_waitcnt vmcnt(0)
  s_barrier
  ds_read_b128 v[56:59], v104 offset:8192
  ds_read_b128 v[60:63], v104 offset:9216
  ds_read_b128 v[64:67], v104 offset:10240
  ds_read_b128 v[68:71], v104 offset:11264
  ds_read_b128 v[72:75], v104 offset:12288
  ds_read_b128 v[76:79], v104 offset:13312
  ds_read_b128 v[80:83], v104 offset:14336
  ds_read_b128 v[84:87], v104 offset:15360
  ds_read_b128 v[44:47], v105 offset:16384
  ds_read_b128 v[48:51], v105 offset:17408
  s_branch ch_gotmem_f
.p2align 6
ch_step_f:
  s_mov_b32 s38, 0
  s_barrier
  s_nop 7
  buffer_load_dwordx4 v[96:99], v105, s[4:7], s21 offen offset:0 sc1
  buffer_load_dwordx4 v[100:103], v105, s[4:7], s21 offen offset:1024 sc1
  s_nop 7
  s_nop 7
  s_nop 7
  s_nop 7
  s_nop 7
  buffer_load_dwordx4 v[96:99], v105, s[4:7], s21 offen offset:0 sc1
  buffer_load_dwordx4 v[100:103], v105, s[4:7], s21 offen offset:1024 sc1
  ds_read_b128 v[56:59], v104 offset:8192
  ds_read_b128 v[60:63], v104 offset:9216
  ds_read_b128 v[64:67], v104 offset:10240
  ds_read_b128 v[68:71], v104 offset:11264
  ds_read_b128 v[72:75], v104 offset:12288
  ds_read_b128 v[76:79], v104 offset:13312
  ds_read_b128 v[80:83], v104 offset:14336
  ds_read_b128 v[84:87], v104 offset:15360
  ds_read_b128 v[44:47], v105 offset:16384
  ds_read_b128 v[48:51], v105 offset:17408
  s_waitcnt vmcnt(2)
  v_max3_u32 v92, v96, v97, v98
  v_max3_u32 v93, v99, v100, v101
  v_max3_u32 v92, v92, v102, v103
  v_max_u32 v92, v92, v93
  v_cmp_eq_u32 vcc, -1, v92
  s_cbranch_vccz ch_pB_f_ok
ch_pB_f_loop:
  s_mov_b64 exec, vcc
  buffer_load_dwordx4 v[96:99], v105, s[4:7], s21 offen offset:0 sc1
  buffer_load_dwordx4 v[100:103], v105, s[4:7], s21 offen offset:1024 sc1
  s_mov_b64 exec, -1
  s_add_u32 s38, s38, 1
  s_cmp_gt_u32 s38, 4000000
  s_cbranch_scc1 ch_bail_f
  s_waitcnt vmcnt(2)
  v_max3_u32 v92, v96, v97, v98
  v_max3_u32 v93, v99, v100, v101
  v_max3_u32 v92, v92, v102, v103
  v_max_u32 v92, v92, v93
  v_cmp_eq_u32 vcc, -1, v92
  s_cbranch_vccnz ch_pB_f_loop
ch_pB_f_ok:
ch_gotmem_f:
  ds_write_b128 v105, v[96:99] offset:0
  ds_write_b128 v105, v[100:103] offset:1024
  s_xor_b32 s24, s22, 0x40000
  v_cmp_ne_u32 vcc, 0, v114
  s_cbranch_vccnz ch_kvok_5
  s_cmp_ge_u32 s20, 62
  s_cbranch_scc1 ch_kvok_5
  s_mov_b32 s38, 0
ch_kvs_6:
  buffer_load_dword v114, off, s[4:7], s36 sc1
  s_add_u32 s38, s38, 1
  s_cmp_gt_u32 s38, 4000000
  s_cbranch_scc1 ch_bail_f
  s_waitcnt vmcnt(0)
  v_cmp_eq_u32 vcc, 0, v114
  s_cbranch_vccnz ch_kvs_6
ch_kvok_5:
  s_add_u32 s36, s36, 4
  s_mov_b32 m0, s48
  s_add_u32 s41, s22, 0
  s_add_u32 s42, s22, 65536
  s_add_u32 s43, s22, 131072
  s_add_u32 s44, s22, 196608
  s_waitcnt lgkmcnt(0)
  s_barrier
  s_cmp_ge_u32 s20, 63
  s_cbranch_scc1 ch_final_f
  ds_read_b128 v[0:3], v115 offset:0
  ds_read_b128 v[4:7], v115 offset:512
  ds_read_b128 v[8:11], v115 offset:1024
  ds_read_b128 v[12:15], v115 offset:1536
  s_waitcnt lgkmcnt(3)
  v_smfmac_f32_16x16x64_bf16 v[32:35], v[0:3], a[0:7], v113
  ds_read_b128 v[16:19], v115 offset:2048
  v_smfmac_f32_16x16x64_bf16 v[36:39], v[0:3], a[128:135], v113
  ds_read_b128 v[20:23], v115 offset:2560
  buffer_load_dwordx4 v105, s[4:7], s34 offen sc1 lds
  v_smfmac_f32_16x16x64_bf16 v[40:43], v[0:3], v[128:135], v113
  ds_read_b128 v[24:27], v115 offset:3072
  ds_read_b128 v[0:3], v115 offset:4096
  s_waitcnt lgkmcnt(6)
  v_smfmac_f32_16x16x64_bf16 v[32:35], v[4:7], a[8:15], v113
  ds_read_b128 v[28:31], v115 offset:3584
  v_smfmac_f32_16x16x64_bf16 v[36:39], v[4:7], a[136:143], v113
  v_smfmac_f32_16x16x64_bf16 v[40:43], v[4:7], v[136:143], v113
  ds_read_b128 v[4:7], v115 offset:4608
  buffer_load_dwordx4 v105, s[4:7], s34 offen offset:1024 sc1 lds
  s_mov_b32 m0, s49
  s_add_u32 s34, s34, 262144
  s_waitcnt lgkmcnt(7)
  v_smfmac_f32_16x16x64_bf16 v[32:35], v[8:11], a[16:23], v113
  v_smfmac_f32_16x16x64_bf16 v[36:39], v[8:11], a[144:151], v113
  v_smfmac_f32_16x16x64_bf16 v[40:43], v[8:11], v[144:151], v113
  ds_read_b128 v[8:11], v115 offset:5120
  s_waitcnt lgkmcnt(7)
  v_smfmac_f32_16x16x64_bf16 v[32:35], v[12:15], a[24:31], v113
  buffer_load_dwordx4 v105, s[4:7], s46 offen sc1 lds
  v_smfmac_f32_16x16x64_bf16 v[36:39], v[12:15], a[152:159], v113
  v_smfmac_f32_16x16x64_bf16 v[40:43], v[12:15], v[152:159], v113
  ds_read_b128 v[12:15], v115 offset:5632
  s_waitcnt lgkmcnt(7)
  v_smfmac_f32_16x16x64_bf16 v[32:35], v[16:19], a[32:39], v113
  v_smfmac_f32_16x16x64_bf16 v[36:39], v[16:19], a[160:167], v113
  buffer_load_dwordx4 v105, s[4:7], s46 offen offset:1024 sc1 lds
  s_add_u32 s46, s46, 262144
  v_smfmac_f32_16x16x64_bf16 v[40:43], v[16:19], v[160:167], v113
  ds_read_b128 v[16:19], v115 offset:6144
  s_waitcnt lgkmcnt(7)
  v_smfmac_f32_16x16x64_bf16 v[32:35], v[20:23], a[40:47], v113
  v_smfmac_f32_16x16x64_bf16 v[36:39], v[20:23], a[168:175], v113
  v_smfmac_f32_16x16x64_bf16 v[40:43], v[20:23], v[168:175], v113
  ds_read_b128 v[20:23], v115 offset:6656
  s_waitcnt lgkmcnt(7)
  v_smfmac_f32_16x16x64_bf16 v[32:35], v[24:27], a[48:55], v113
  v_smfmac_f32_16x16x64_bf16 v[36:39], v[24:27], a[176:183], v113
  v_smfmac_f32_16x16x64_bf16 v[40:43], v[24:27], v[176:183], v113
  ds_read_b128 v[24:27], v115 offset:7168
  s_waitcnt lgkmcnt(6)
  v_smfmac_f32_16x16x64_bf16 v[32:35], v[28:31], a[56:63], v113
  v_smfmac_f32_16x16x64_bf16 v[36:39], v[28:31], a[184:191], v113
  v_smfmac_f32_16x16x64_bf16 v[40:43], v[28:31], v[184:191], v113
  ds_read_b128 v[28:31], v115 offset:7680
  v_smfmac_f32_16x16x64_bf16 v[32:35], v[0:3], a[64:71], v113
  s_waitcnt lgkmcnt(6)
  v_smfmac_f32_16x16x64_bf16 v[32:35], v[4:7], a[72:79], v113
  s_waitcnt lgkmcnt(5)
  v_smfmac_f32_16x16x64_bf16 v[32:35], v[8:11], a[80:87], v113
  s_waitcnt lgkmcnt(4)
  v_smfmac_f32_16x16x64_bf16 v[32:35], v[12:15], a[88:95], v113
  s_waitcnt lgkmcnt(3)
  v_smfmac_f32_16x16x64_bf16 v[32:35], v[16:19], a[96:103], v113
  s_waitcnt lgkmcnt(2)
  v_smfmac_f32_16x16x64_bf16 v[32:35], v[20:23], a[104:111], v113
  s_waitcnt lgkmcnt(1)
  v_smfmac_f32_16x16x64_bf16 v[32:35], v[24:27], a[112:119], v113
  s_waitcnt lgkmcnt(0)
  v_smfmac_f32_16x16x64_bf16 v[32:35], v[28:31], a[120:127], v113
  s_waitcnt vmcnt(4)
  v_smfmac_f32_16x16x64_bf16 v[36:39], v[0:3], a[192:199], v113
  v_smfmac_f32_16x16x64_bf16 v[36:39], v[4:7], a[200:207], v113
  v_smfmac_f32_16x16x64_bf16 v[36:39], v[8:11], a[208:215], v113
  v_cvt_pk_bf16_f32 v32, v32, v33
  v_cvt_pk_bf16_f32 v33, v34, v35
  ds_write_b64 v107, v[32:33]
  v_smfmac_f32_16x16x64_bf16 v[36:39], v[12:15], a[216:223], v113
  v_smfmac_f32_16x16x64_bf16 v[36:39], v[16:19], a[224:231], v113
  v_smfmac_f32_16x16x64_bf16 v[36:39], v[20:23], a[232:239], v113
  s_waitcnt lgkmcnt(0)
  s_barrier
  ds_read_b64_tr_b16 v[88:89], v108 offset:0
  ds_read_b64_tr_b16 v[90:91], v108 offset:128
  v_smfmac_f32_16x16x64_bf16 v[36:39], v[24:27], a[240:247], v113
  ds_read_b64_tr_b16 v[92:93], v108 offset:512
  ds_read_b64_tr_b16 v[94:95], v108 offset:640
  v_smfmac_f32_16x16x64_bf16 v[36:39], v[28:31], a[248:255], v113
  ds_read_b64_tr_b16 v[96:97], v108 offset:1024
  ds_read_b64_tr_b16 v[98:99], v108 offset:1152
  v_smfmac_f32_16x16x64_bf16 v[40:43], v[0:3], v[192:199], v113
  ds_read_b64_tr_b16 v[100:101], v108 offset:1536
  ds_read_b64_tr_b16 v[102:103], v108 offset:1664
  v_smfmac_f32_16x16x64_bf16 v[40:43], v[4:7], v[200:207], v113
  v_smfmac_f32_16x16x64_bf16 v[40:43], v[8:11], v[208:215], v113
  buffer_store_dwordx4 v[124:127], v111, s[4:7], s24 offen
  v_cvt_pk_bf16_f32 v52, v36, v37
  s_waitcnt lgkmcnt(6)
  v_mfma_f32_16x16x32_bf16 v[32:35], v[56:59], v[88:91], 0
  v_cvt_pk_bf16_f32 v53, v38, v39
  ds_write_b64 v107, v[52:53] offset:2048
  s_waitcnt lgkmcnt(5)
  v_mfma_f32_16x16x32_bf16 v[32:35], v[60:63], v[92:95], v[32:35]
  buffer_store_dwordx4 v[124:127], v111, s[4:7], s24 offen offset:1024
  ds_read_b128 v[56:59], v106 offset:0
  s_waitcnt lgkmcnt(4)
  v_mfma_f32_16x16x32_bf16 v[32:35], v[64:67], v[96:99], v[32:35]
  ds_read_b128 v[60:63], v106 offset:1024
  s_waitcnt lgkmcnt(3)
  v_mfma_f32_16x16x32_bf16 v[32:35], v[68:71], v[100:103], v[32:35]
  s_mov_b64 exec, s[32:33]
  buffer_store_dword v124, v112, s[4:7], s47 offen
  s_mov_b64 exec, -1
  s_waitcnt lgkmcnt(2)
  s_barrier
  ds_read_b64_tr_b16 v[0:1], v108 offset:2048
  v_mfma_f32_16x16x32_bf16 v[124:127], v[72:75], v[88:91], 0
  ds_read_b64_tr_b16 v[2:3], v108 offset:2176
  ds_read_b64_tr_b16 v[4:5], v108 offset:2560
  v_mfma_f32_16x16x32_bf16 v[124:127], v[76:79], v[92:95], v[124:127]
  s_mov_b64 exec, 1
  buffer_store_dword v120, off, s[4:7], s37 sc1
  s_mov_b64 exec, -1
  s_add_u32 s37, s37, 16
  ds_read_b64_tr_b16 v[6:7], v108 offset:2688
  v_mfma_f32_16x16x32_bf16 v[124:127], v[80:83], v[96:99], v[124:127]
  ds_read_b64_tr_b16 v[8:9], v108 offset:3072
  ds_read_b64_tr_b16 v[10:11], v108 offset:3200
  v_mfma_f32_16x16x32_bf16 v[124:127], v[84:87], v[100:103], v[124:127]
  buffer_load_dword v114, off, s[4:7], s36 sc1
  ds_read_b128 v[64:67], v106 offset:2048
  v_smfmac_f32_16x16x64_bf16 v[40:43], v[12:15], v[216:223], v113
  ds_read_b64_tr_b16 v[12:13], v108 offset:3584
  ds_read_b64_tr_b16 v[14:15], v108 offset:3712
  v_smfmac_f32_16x16x64_bf16 v[40:43], v[16:19], v[224:231], v113
  ds_read_b128 v[68:71], v106 offset:3072
  ds_read_b128 v[72:75], v106 offset:4096
  v_smfmac_f32_16x16x64_bf16 v[40:43], v[20:23], v[232:239], v113
  ds_read_b128 v[76:79], v106 offset:5120
  ds_read_b128 v[80:83], v106 offset:6144
  v_smfmac_f32_16x16x64_bf16 v[40:43], v[24:27], v[240:247], v113
  ds_read_b128 v[84:87], v106 offset:7168
  v_smfmac_f32_16x16x64_bf16 v[40:43], v[28:31], v[248:255], v113
  s_waitcnt lgkmcnt(12)
  v_mfma_f32_16x16x32_bf16 v[16:19], v[0:3], v[88:91], 0
  v_max3_f32 v20, v32, v33, v34
  v_max3_f32 v21, v35, v124, v125
  s_waitcnt lgkmcnt(10)
  v_mfma_f32_16x16x32_bf16 v[16:19], v[4:7], v[92:95], v[16:19]
  v_max3_f32 v20, v20, v126, v127
  v_max_f32 v20, v20, v21
  s_waitcnt lgkmcnt(8)
  v_mfma_f32_16x16x32_bf16 v[16:19], v[8:11], v[96:99], v[16:19]
  v_cvt_pk_bf16_f32 v54, v40, v41
  v_cvt_pk_bf16_f32 v55, v42, v43
  s_waitcnt lgkmcnt(5)
  v_mfma_f32_16x16x32_bf16 v[16:19], v[12:15], v[100:103], v[16:19]
  s_nop 7
  v_max3_f32 v21, v16, v17, v18
  v_max3_f32 v20, v20, v21, v19
  v_mov_b32 v21, v20
  s_nop 1
  v_permlane16_swap_b32 v20, v21
  v_max_f32 v20, v20, v21
  v_mov_b32 v21, v20
  s_nop 1
  v_permlane32_swap_b32 v20, v21
  v_max_f32 v20, v20, v21
  v_mul_f32 v20, s28, v20
  v_pk_fma_f32 v[32:33], v[32:33], s[28:29], v[20:21] op_sel_hi:[1,1,0] neg_lo:[0,0,1] neg_hi:[0,0,1]
  v_pk_fma_f32 v[34:35], v[34:35], s[28:29], v[20:21] op_sel_hi:[1,1,0] neg_lo:[0,0,1] neg_hi:[0,0,1]
  v_pk_fma_f32 v[124:125], v[124:125], s[28:29], v[20:21] op_sel_hi:[1,1,0] neg_lo:[0,0,1] neg_hi:[0,0,1]
  v_pk_fma_f32 v[126:127], v[126:127], s[28:29], v[20:21] op_sel_hi:[1,1,0] neg_lo:[0,0,1] neg_hi:[0,0,1]
  v_pk_fma_f32 v[16:17], v[16:17], s[28:29], v[20:21] op_sel_hi:[1,1,0] neg_lo:[0,0,1] neg_hi:[0,0,1]
  v_pk_fma_f32 v[18:19], v[18:19], s[28:29], v[20:21] op_sel_hi:[1,1,0] neg_lo:[0,0,1] neg_hi:[0,0,1]
  v_exp_f32 v32, v32
  v_exp_f32 v33, v33
  v_exp_f32 v34, v34
  v_exp_f32 v35, v35
  v_exp_f32 v124, v124
  v_exp_f32 v125, v125
  v_exp_f32 v126, v126
  v_exp_f32 v127, v127
  v_exp_f32 v16, v16
  v_cvt_pk_bf16_f32 v88, v32, v33
  v_exp_f32 v17, v17
  v_cvt_pk_bf16_f32 v89, v34, v35
  v_exp_f32 v18, v18
  v_cvt_pk_bf16_f32 v90, v124, v125
  v_exp_f32 v19, v19
  v_cvt_pk_bf16_f32 v91, v126, v127
  v_cvt_pk_bf16_f32 v92, v16, v17
  v_cvt_pk_bf16_f32 v93, v18, v19
  v_mfma_f32_16x16x32_bf16 v[8:11], v[120:123], v[88:91], 0
  v_cndmask_b32 v94, 0, v92, s[30:31]
  v_cndmask_b32 v95, 0, v93, s[30:31]
  v_mfma_f32_16x16x32_bf16 v[0:3], v[44:47], v[88:91], 0
  v_cndmask_b32 v96, v92, 0, s[30:31]
  v_cndmask_b32 v97, v93, 0, s[30:31]
  v_mfma_f32_16x16x32_bf16 v[4:7], v[48:51], v[88:91], 0
  v_mov_b64 v[32:33], 0
  v_mov_b64 v[34:35], 0
  v_mfma_f32_16x16x16_bf16 v[8:11], v[120:121], v[94:95], v[8:11]
  v_mov_b64 v[36:37], 0
  buffer_store_dwordx4 v[52:55], v105, s[4:7], s35 offen sc1
  v_mfma_f32_16x16x16_bf16 v[0:3], v[54:55], v[94:95], v[0:3]
  v_mov_b64 v[38:39], 0
  ds_read_b128 v[88:91], v106 offset:8192
  v_mfma_f32_16x16x16_bf16 v[4:7], v[54:55], v[96:97], v[4:7]
  v_mov_b64 v[40:41], 0
  ds_read_b128 v[92:95], v106 offset:9216
  v_mov_b64 v[42:43], 0
  v_rcp_f32 v98, v8
  ds_read_b128 v[48:51], v106 offset:10240
  v_mov_b64 v[44:45], 0
  ds_read_b128 v[52:55], v106 offset:11264
  v_mov_b64 v[46:47], 0
  v_pk_mul_f32 v[0:1], v[0:1], v[98:99] op_sel_hi:[1,0]
  v_cvt_pk_bf16_f32 v100, v0, v1
  v_pk_mul_f32 v[2:3], v[2:3], v[98:99] op_sel_hi:[1,0]
  v_cvt_pk_bf16_f32 v101, v2, v3
  ds_write_b64 v109, v[100:101]
  v_pk_mul_f32 v[4:5], v[4:5], v[98:99] op_sel_hi:[1,0]
  v_cvt_pk_bf16_f32 v102, v4, v5
  v_pk_mul_f32 v[6:7], v[6:7], v[98:99] op_sel_hi:[1,0]
  v_cvt_pk_bf16_f32 v103, v6, v7
  ds_write_b64 v109, v[102:103] offset:256
  ds_read_b128 v[0:3], v106 offset:12288
  ds_read_b128 v[4:7], v106 offset:13312
  s_waitcnt lgkmcnt(2)
  s_barrier
  ds_read_b128 v[16:19], v115 offset:28672
  ds_read_b128 v[20:23], v115 offset:29184
  ds_read_b128 v[24:27], v115 offset:29696
  ds_read_b128 v[28:31], v115 offset:30208
  ds_read_b128 v[8:11], v106 offset:14336
  ds_read_b128 v[12:15], v106 offset:15360
  s_waitcnt lgkmcnt(5)
  v_smfmac_f32_16x16x64_bf16 v[32:35], v[16:19], v[56:63], v113
  ds_read_b128 v[56:59], v106 offset:16384
  s_waitcnt lgkmcnt(5)
  v_smfmac_f32_16x16x64_bf16 v[32:35], v[20:23], v[64:71], v113
  ds_read_b128 v[60:63], v106 offset:17408
  s_waitcnt lgkmcnt(5)
  v_smfmac_f32_16x16x64_bf16 v[32:35], v[24:27], v[72:79], v113
  ds_read_b128 v[64:67], v106 offset:18432
  s_waitcnt lgkmcnt(5)
  v_smfmac_f32_16x16x64_bf16 v[32:35], v[28:31], v[80:87], v113
  ds_read_b128 v[68:71], v106 offset:19456
  v_smfmac_f32_16x16x64_bf16 v[36:39], v[16:19], v[88:95], v113
  ds_read_b128 v[72:75], v106 offset:20480
  v_smfmac_f32_16x16x64_bf16 v[36:39], v[20:23], v[48:55], v113
  ds_read_b128 v[76:79], v106 offset:21504
  v_smfmac_f32_16x16x64_bf16 v[36:39], v[24:27], v[0:7], v113
  ds_read_b128 v[80:83], v106 offset:22528
  v_cvt_pk_bf16_f32 v32, v32, v33
  v_cvt_pk_bf16_f32 v33, v34, v35
  buffer_store_dwordx2 v[32:33], v110, s[4:7], s41 offen
  s_waitcnt lgkmcnt(7)
  v_smfmac_f32_16x16x64_bf16 v[36:39], v[28:31], v[8:15], v113
  ds_read_b128 v[84:87], v106 offset:23552
  s_waitcnt lgkmcnt(6)
  v_smfmac_f32_16x16x64_bf16 v[40:43], v[16:19], v[56:63], v113
  ds_read_b128 v[88:91], v106 offset:24576
  ds_read_b128 v[92:95], v106 offset:25600
  s_waitcnt lgkmcnt(6)
  v_smfmac_f32_16x16x64_bf16 v[40:43], v[20:23], v[64:71], v113
  ds_read_b128 v[48:51], v106 offset:26624
  ds_read_b128 v[52:55], v106 offset:27648
  s_waitcnt lgkmcnt(6)
  v_smfmac_f32_16x16x64_bf16 v[40:43], v[24:27], v[72:79], v113
  ds_read_b128 v[0:3], v106 offset:28672
  ds_read_b128 v[4:7], v106 offset:29696
  v_cvt_pk_bf16_f32 v36, v36, v37
  v_cvt_pk_bf16_f32 v37, v38, v39
  buffer_store_dwordx2 v[36:37], v110, s[4:7], s42 offen
  s_waitcnt lgkmcnt(6)
  v_smfmac_f32_16x16x64_bf16 v[40:43], v[28:31], v[80:87], v113
  ds_read_b128 v[8:11], v106 offset:30720
  ds_read_b128 v[12:15], v106 offset:31744
  s_waitcnt lgkmcnt(6)
  v_smfmac_f32_16x16x64_bf16 v[44:47], v[16:19], v[88:95], v113
  s_waitcnt lgkmcnt(4)
  v_smfmac_f32_16x16x64_bf16 v[44:47], v[20:23], v[48:55], v113
  s_waitcnt lgkmcnt(2)
  v_smfmac_f32_16x16x64_bf16 v[44:47], v[24:27], v[0:7], v113
  v_cvt_pk_bf16_f32 v40, v40, v41
  v_cvt_pk_bf16_f32 v41, v42, v43
  buffer_store_dwordx2 v[40:41], v110, s[4:7], s43 offen
  s_waitcnt lgkmcnt(0)
  v_smfmac_f32_16x16x64_bf16 v[44:47], v[28:31], v[8:15], v113
  s_add_u32 s21, s21, 8192
  s_and_b32 s21, s21, 0x7fff
  s_add_u32 s47, s21, 16384
  s_add_u32 s21, s21, 65536
  s_and_b32 s47, s47, 0x7fff
  s_add_u32 s47, s47, 65536
  s_add_u32 s35, s35, 262144
  s_add_u32 s20, s20, 1
  v_cvt_pk_bf16_f32 v44, v44, v45
  v_cvt_pk_bf16_f32 v45, v46, v47
  buffer_store_dwordx2 v[44:45], v110, s[4:7], s44 offen
  s_mov_b32 s38, 0
  v_mov_b64 v[32:33], 0
  v_mov_b64 v[34:35], 0
  v_mov_b64 v[36:37], 0
  v_mov_b64 v[38:39], 0
  v_mov_b64 v[40:41], 0
  v_mov_b64 v[42:43], 0
  v_mov_b64 v[124:125], -1
  v_mov_b64 v[126:127], -1
  s_nop 7
  s_nop 7
  s_nop 7
  s_nop 7
  buffer_load_dwordx4 v[16:19], v111, s[4:7], s22 offen offset:0 sc1
  buffer_load_dwordx4 v[20:23], v111, s[4:7], s22 offen offset:1024 sc1
  s_waitcnt vmcnt(0)
  v_mfma_f32_16x16x32_bf16 v[24:27], v[16:19], v[116:119], 0
  v_mfma_f32_16x16x32_bf16 v[24:27], v[20:23], v[116:119], v[24:27]
  v_max3_u32 v28, v16, v17, v18
  v_max3_u32 v29, v19, v20, v21
  v_max3_u32 v28, v28, v22, v23
  v_max_u32 v28, v28, v29
  v_cmp_eq_u32 vcc, -1, v28
  s_cbranch_vccz ch_pA_f_ok
ch_pA_f_loop:
  s_mov_b64 exec, vcc
  buffer_load_dwordx4 v[16:19], v111, s[4:7], s22 offen offset:0 sc1
  buffer_load_dwordx4 v[20:23], v111, s[4:7], s22 offen offset:1024 sc1
  s_mov_b64 exec, -1
  s_add_u32 s38, s38, 1
  s_cmp_gt_u32 s38, 4000000
  s_cbranch_scc1 ch_bail_f
  s_waitcnt vmcnt(0)
  v_mfma_f32_16x16x32_bf16 v[24:27], v[16:19], v[116:119], 0
  v_mfma_f32_16x16x32_bf16 v[24:27], v[20:23], v[116:119], v[24:27]
  v_max3_u32 v28, v16, v17, v18
  v_max3_u32 v29, v19, v20, v21
  v_max3_u32 v28, v28, v22, v23
  v_max_u32 v28, v28, v29
  v_cmp_eq_u32 vcc, -1, v28
  s_cbranch_vccnz ch_pA_f_loop
ch_pA_f_ok:
  s_xor_b32 s22, s22, 0x40000
  s_nop 1
  v_add_f32 v28, v24, v25
  v_add_f32 v29, v26, v27
  v_add_f32 v28, v28, v29
  s_nop 1
  v_mov_b32_dpp v29, v28 row_shl:4 row_mask:0xf bank_mask:0xf
  s_mov_b64 exec, s[32:33]
  v_cvt_pk_bf16_f32 v28, v28, v29
  buffer_store_dword v28, v112, s[4:7], s21 offen
  s_mov_b64 exec, -1
  s_branch ch_step_f
ch_final_f:
  ds_read_b128 v[0:3], v115 offset:0
  ds_read_b128 v[4:7], v115 offset:512
  ds_read_b128 v[8:11], v115 offset:1024
  ds_read_b128 v[12:15], v115 offset:1536
  ds_read_b128 v[16:19], v115 offset:2048
  ds_read_b128 v[20:23], v115 offset:2560
  ds_read_b128 v[24:27], v115 offset:3072
  ds_read_b128 v[28:31], v115 offset:3584
  s_mov_b64 exec, 1
  buffer_store_dword v120, off, s[4:7], s37 sc1
  s_mov_b64 exec, -1
  s_add_u32 s37, s37, 16
  s_waitcnt lgkmcnt(7)
  v_smfmac_f32_16x16x64_bf16 v[36:39], v[0:3], a[128:135], v113
  v_smfmac_f32_16x16x64_bf16 v[40:43], v[0:3], v[128:135], v113
  ds_read_b128 v[0:3], v115 offset:4096
  s_waitcnt lgkmcnt(7)
  v_smfmac_f32_16x16x64_bf16 v[36:39], v[4:7], a[136:143], v113
  v_smfmac_f32_16x16x64_bf16 v[40:43], v[4:7], v[136:143], v113
  ds_read_b128 v[4:7], v115 offset:4608
  s_waitcnt lgkmcnt(7)
  v_smfmac_f32_16x16x64_bf16 v[36:39], v[8:11], a[144:151], v113
  v_smfmac_f32_16x16x64_bf16 v[40:43], v[8:11], v[144:151], v113
  ds_read_b128 v[8:11], v115 offset:5120
  s_waitcnt lgkmcnt(7)
  v_smfmac_f32_16x16x64_bf16 v[36:39], v[12:15], a[152:159], v113
  v_smfmac_f32_16x16x64_bf16 v[40:43], v[12:15], v[152:159], v113
  ds_read_b128 v[12:15], v115 offset:5632
  s_waitcnt lgkmcnt(7)
  v_smfmac_f32_16x16x64_bf16 v[36:39], v[16:19], a[160:167], v113
  v_smfmac_f32_16x16x64_bf16 v[40:43], v[16:19], v[160:167], v113
  ds_read_b128 v[16:19], v115 offset:6144
  s_waitcnt lgkmcnt(7)
  v_smfmac_f32_16x16x64_bf16 v[36:39], v[20:23], a[168:175], v113
  v_smfmac_f32_16x16x64_bf16 v[40:43], v[20:23], v[168:175], v113
  ds_read_b128 v[20:23], v115 offset:6656
  s_waitcnt lgkmcnt(7)
  v_smfmac_f32_16x16x64_bf16 v[36:39], v[24:27], a[176:183], v113
  v_smfmac_f32_16x16x64_bf16 v[40:43], v[24:27], v[176:183], v113
  ds_read_b128 v[24:27], v115 offset:7168
  s_waitcnt lgkmcnt(7)
  v_smfmac_f32_16x16x64_bf16 v[36:39], v[28:31], a[184:191], v113
  v_smfmac_f32_16x16x64_bf16 v[40:43], v[28:31], v[184:191], v113
  ds_read_b128 v[28:31], v115 offset:7680
  s_waitcnt lgkmcnt(7)
  v_smfmac_f32_16x16x64_bf16 v[36:39], v[0:3], a[192:199], v113
  v_smfmac_f32_16x16x64_bf16 v[40:43], v[0:3], v[192:199], v113
  s_waitcnt lgkmcnt(6)
  v_smfmac_f32_16x16x64_bf16 v[36:39], v[4:7], a[200:207], v113
  v_smfmac_f32_16x16x64_bf16 v[40:43], v[4:7], v[200:207], v113
  s_waitcnt lgkmcnt(5)
  v_smfmac_f32_16x16x64_bf16 v[36:39], v[8:11], a[208:215], v113
  v_smfmac_f32_16x16x64_bf16 v[40:43], v[8:11], v[208:215], v113
  s_waitcnt lgkmcnt(4)
  v_smfmac_f32_16x16x64_bf16 v[36:39], v[12:15], a[216:223], v113
  v_smfmac_f32_16x16x64_bf16 v[40:43], v[12:15], v[216:223], v113
  s_waitcnt lgkmcnt(3)
  v_smfmac_f32_16x16x64_bf16 v[36:39], v[16:19], a[224:231], v113
  v_smfmac_f32_16x16x64_bf16 v[40:43], v[16:19], v[224:231], v113
  s_waitcnt lgkmcnt(2)
  v_smfmac_f32_16x16x64_bf16 v[36:39], v[20:23], a[232:239], v113
  v_smfmac_f32_16x16x64_bf16 v[40:43], v[20:23], v[232:239], v113
  s_waitcnt lgkmcnt(1)
  v_smfmac_f32_16x16x64_bf16 v[36:39], v[24:27], a[240:247], v113
  v_smfmac_f32_16x16x64_bf16 v[40:43], v[24:27], v[240:247], v113
  s_waitcnt lgkmcnt(0)
  v_smfmac_f32_16x16x64_bf16 v[36:39], v[28:31], a[248:255], v113
  v_smfmac_f32_16x16x64_bf16 v[40:43], v[28:31], v[248:255], v113
  s_nop 7
  v_cvt_pk_bf16_f32 v52, v36, v37
  v_cvt_pk_bf16_f32 v53, v38, v39
  v_cvt_pk_bf16_f32 v54, v40, v41
  v_cvt_pk_bf16_f32 v55, v42, v43
  buffer_store_dwordx4 v[52:55], v105, s[4:7], s35 offen sc1
  s_waitcnt vmcnt(0)
  s_mov_b64 exec, 1
  buffer_store_dword v120, off, s[4:7], s37 sc1
ch_bail_f:
  s_waitcnt vmcnt(0) lgkmcnt(0)
  s_endpgm
chain_slow:
  s_mov_b32 s20, 0
  s_mov_b32 s21, 65536
  s_mov_b32 s47, 81920
  s_mov_b32 s22, 131072
  s_lshl_b32 s23, s17, 13
  s_add_u32 s34, s23, 4194304
  s_add_u32 s46, s23, 20971520
  s_add_u32 s35, s23, 37748736
  s_lshl_b32 s23, s17, 8
  s_add_u32 s36, s23, 8192
  s_lshl_b32 s23, s17, 11
  s_lshl_b32 s24, s18, 2
  s_add_u32 s23, s23, s24
  s_add_u32 s37, s23, 720896
  s_lshl_b32 s23, s18, 11
  s_add_u32 s48, s23, 8192
  s_add_u32 s49, s23, 16384
  s_add_u32 s52, s23, 0
  s_cmp_ge_u32 s17, 24
  s_cselect_b32 s50, 4, 0
  s_cselect_b32 s51, 0, 6
  s_mov_b32 s38, 0
ch_kvs_7:
  buffer_load_dword v114, off, s[4:7], s36 sc1
  s_add_u32 s38, s38, 1
  s_cmp_gt_u32 s38, 4000000
  s_cbranch_scc1 ch_bail_s
  s_waitcnt vmcnt(0)
  v_cmp_eq_u32 vcc, 0, v114
  s_cbranch_vccnz ch_kvs_7
  s_mov_b32 m0, s48
  s_nop 0
  buffer_load_dwordx4 v105, s[4:7], s34 offen sc1 lds
  buffer_load_dwordx4 v105, s[4:7], s34 offen offset:1024 sc1 lds
  s_mov_b32 m0, s49
  s_add_u32 s34, s34, 262144
  buffer_load_dwordx4 v105, s[4:7], s46 offen sc1 lds
  buffer_load_dwordx4 v105, s[4:7], s46 offen offset:1024 sc1 lds
  s_add_u32 s46, s46, 262144
  s_add_u32 s36, s36, 4
  buffer_load_dword v114, off, s[4:7], s36 sc1
  s_load_dwordx2 s[8:9], s[0:1], 8
  s_mov_b32 s10, 0x2000
  s_mov_b32 s11, 0x00020000
  v_mbcnt_lo_u32_b32 v88, -1, 0
  v_mbcnt_hi_u32_b32 v88, -1, v88
  v_and_b32 v89, 7, v88
  v_lshlrev_b32 v89, 10, v89
  v_lshrrev_b32 v90, 3, v88
  v_lshl_add_u32 v89, v90, 4, v89
  s_lshl_b32 s23, s18, 8
  s_waitcnt lgkmcnt(0)
  buffer_load_dwordx4 v[96:99], v89, s[8:11], s23 offen offset:0
  buffer_load_dwordx4 v[100:103], v89, s[8:11], s23 offen offset:128
  v_mov_b64 v[32:33], 0
  v_mov_b64 v[34:35], 0
  v_mov_b64 v[36:37], 0
  v_mov_b64 v[38:39], 0
  v_mov_b64 v[40:41], 0
  v_mov_b64 v[42:43], 0
  v_mov_b64 v[124:125], -1
  v_mov_b64 v[126:127], -1
  s_waitcnt vmcnt(0)
  s_barrier
  ds_read_b128 v[56:59], v104 offset:8192
  ds_read_b128 v[60:63], v104 offset:9216
  ds_read_b128 v[64:67], v104 offset:10240
  ds_read_b128 v[68:71], v104 offset:11264
  ds_read_b128 v[72:75], v104 offset:12288
  ds_read_b128 v[76:79], v104 offset:13312
  ds_read_b128 v[80:83], v104 offset:14336
  ds_read_b128 v[84:87], v104 offset:15360
  ds_read_b128 v[44:47], v105 offset:16384
  ds_read_b128 v[48:51], v105 offset:17408
  s_branch ch_gotmem_s
.p2align 6
ch_step_s:
  s_mov_b32 s38, 0
  s_barrier
  s_nop 7
  buffer_load_dwordx4 v[96:99], v105, s[4:7], s21 offen offset:0 sc1
  buffer_load_dwordx4 v[100:103], v105, s[4:7], s21 offen offset:1024 sc1
  s_nop 7
  s_nop 7
  s_nop 7
  s_nop 7
  s_nop 7
  buffer_load_dwordx4 v[96:99], v105, s[4:7], s21 offen offset:0 sc1
  buffer_load_dwordx4 v[100:103], v105, s[4:7], s21 offen offset:1024 sc1
  ds_read_b128 v[56:59], v104 offset:8192
  ds_read_b128 v[60:63], v104 offset:9216
  ds_read_b128 v[64:67], v104 offset:10240
  ds_read_b128 v[68:71], v104 offset:11264
  ds_read_b128 v[72:75], v104 offset:12288
  ds_read_b128 v[76:79], v104 offset:13312
  ds_read_b128 v[80:83], v104 offset:14336
  ds_read_b128 v[84:87], v104 offset:15360
  ds_read_b128 v[44:47], v105 offset:16384
  ds_read_b128 v[48:51], v105 offset:17408
  s_waitcnt vmcnt(2)
  v_max3_u32 v92, v96, v97, v98
  v_max3_u32 v93, v99, v100, v101
  v_max3_u32 v92, v92, v102, v103
  v_max_u32 v92, v92, v93
  v_cmp_eq_u32 vcc, -1, v92
  s_cbranch_vccz ch_pB_s_ok
ch_pB_s_loop:
  s_mov_b64 exec, vcc
  buffer_load_dwordx4 v[96:99], v105, s[4:7], s21 offen offset:0 sc1
  buffer_load_dwordx4 v[100:103], v105, s[4:7], s21 offen offset:1024 sc1
  s_mov_b64 exec, -1
  s_add_u32 s38, s38, 1
  s_cmp_gt_u32 s38, 4000000
  s_cbranch_scc1 ch_bail_s
  s_waitcnt vmcnt(2)
  v_max3_u32 v92, v96, v97, v98
  v_max3_u32 v93, v99, v100, v101
  v_max3_u32 v92, v92, v102, v103
  v_max_u32 v92, v92, v93
  v_cmp_eq_u32 vcc, -1, v92
  s_cbranch_vccnz ch_pB_s_loop
ch_pB_s_ok:
ch_gotmem_s:
  ds_write_b128 v105, v[96:99] offset:0
  ds_write_b128 v105, v[100:103] offset:1024
  s_xor_b32 s24, s22, 0x40000
  v_cmp_ne_u32 vcc, 0, v114
  s_cbranch_vccnz ch_kvok_8
  s_cmp_ge_u32 s20, 62
  s_cbranch_scc1 ch_kvok_8
  s_mov_b32 s38, 0
ch_kvs_9:
  buffer_load_dword v114, off, s[4:7], s36 sc1
  s_add_u32 s38, s38, 1
  s_cmp_gt_u32 s38, 4000000
  s_cbranch_scc1 ch_bail_s
  s_waitcnt vmcnt(0)
  v_cmp_eq_u32 vcc, 0, v114
  s_cbranch_vccnz ch_kvs_9
ch_kvok_8:
  s_add_u32 s36, s36, 4
  s_mov_b32 m0, s48
  s_add_u32 s41, s22, 0
  s_add_u32 s42, s22, 65536
  s_add_u32 s43, s22, 131072
  s_add_u32 s44, s22, 196608
  s_waitcnt lgkmcnt(0)
  s_barrier
  s_cmp_ge_u32 s20, 63
  s_cbranch_scc1 ch_final_s
  ds_read_b128 v[0:3], v115 offset:0
  ds_read_b128 v[4:7], v115 offset:512
  ds_read_b128 v[8:11], v115 offset:1024
  ds_read_b128 v[12:15], v115 offset:1536
  s_waitcnt lgkmcnt(3)
  v_smfmac_f32_16x16x64_bf16 v[32:35], v[0:3], a[0:7], v113
  ds_read_b128 v[16:19], v115 offset:2048
  v_smfmac_f32_16x16x64_bf16 v[36:39], v[0:3], a[128:135], v113
  ds_read_b128 v[20:23], v115 offset:2560
  buffer_load_dwordx4 v105, s[4:7], s34 offen sc1 lds
  v_smfmac_f32_16x16x64_bf16 v[40:43], v[0:3], v[128:135], v113
  ds_read_b128 v[24:27], v115 offset:3072
  ds_read_b128 v[0:3], v115 offset:4096
  s_waitcnt lgkmcnt(6)
  v_smfmac_f32_16x16x64_bf16 v[32:35], v[4:7], a[8:15], v113
  ds_read_b128 v[28:31], v115 offset:3584
  v_smfmac_f32_16x16x64_bf16 v[36:39], v[4:7], a[136:143], v113
  v_smfmac_f32_16x16x64_bf16 v[40:43], v[4:7], v[136:143], v113
  ds_read_b128 v[4:7], v115 offset:4608
  buffer_load_dwordx4 v105, s[4:7], s34 offen offset:1024 sc1 lds
  s_mov_b32 m0, s49
  s_add_u32 s34, s34, 262144
  s_waitcnt lgkmcnt(7)
  v_smfmac_f32_16x16x64_bf16 v[32:35], v[8:11], a[16:23], v113
  v_smfmac_f32_16x16x64_bf16 v[36:39], v[8:11], a[144:151], v113
  v_smfmac_f32_16x16x64_bf16 v[40:43], v[8:11], v[144:151], v113
  ds_read_b128 v[8:11], v115 offset:5120
  s_waitcnt lgkmcnt(7)
  v_smfmac_f32_16x16x64_bf16 v[32:35], v[12:15], a[24:31], v113
  buffer_load_dwordx4 v105, s[4:7], s46 offen sc1 lds
  v_smfmac_f32_16x16x64_bf16 v[36:39], v[12:15], a[152:159], v113
  v_smfmac_f32_16x16x64_bf16 v[40:43], v[12:15], v[152:159], v113
  ds_read_b128 v[12:15], v115 offset:5632
  s_waitcnt lgkmcnt(7)
  v_smfmac_f32_16x16x64_bf16 v[32:35], v[16:19], a[32:39], v113
  v_smfmac_f32_16x16x64_bf16 v[36:39], v[16:19], a[160:167], v113
  buffer_load_dwordx4 v105, s[4:7], s46 offen offset:1024 sc1 lds
  s_add_u32 s46, s46, 262144
  v_smfmac_f32_16x16x64_bf16 v[40:43], v[16:19], v[160:167], v113
  ds_read_b128 v[16:19], v115 offset:6144
  s_waitcnt lgkmcnt(7)
  v_smfmac_f32_16x16x64_bf16 v[32:35], v[20:23], a[40:47], v113
  v_smfmac_f32_16x16x64_bf16 v[36:39], v[20:23], a[168:175], v113
  v_smfmac_f32_16x16x64_bf16 v[40:43], v[20:23], v[168:175], v113
  ds_read_b128 v[20:23], v115 offset:6656
  s_waitcnt lgkmcnt(7)
  v_smfmac_f32_16x16x64_bf16 v[32:35], v[24:27], a[48:55], v113
  v_smfmac_f32_16x16x64_bf16 v[36:39], v[24:27], a[176:183], v113
  v_smfmac_f32_16x16x64_bf16 v[40:43], v[24:27], v[176:183], v113
  ds_read_b128 v[24:27], v115 offset:7168
  s_waitcnt lgkmcnt(6)
  v_smfmac_f32_16x16x64_bf16 v[32:35], v[28:31], a[56:63], v113
  v_smfmac_f32_16x16x64_bf16 v[36:39], v[28:31], a[184:191], v113
  v_smfmac_f32_16x16x64_bf16 v[40:43], v[28:31], v[184:191], v113
  ds_read_b128 v[28:31], v115 offset:7680
  v_smfmac_f32_16x16x64_bf16 v[32:35], v[0:3], a[64:71], v113
  s_waitcnt lgkmcnt(6)
  v_smfmac_f32_16x16x64_bf16 v[32:35], v[4:7], a[72:79], v113
  s_waitcnt lgkmcnt(5)
  v_smfmac_f32_16x16x64_bf16 v[32:35], v[8:11], a[80:87], v113
  s_waitcnt lgkmcnt(4)
  v_smfmac_f32_16x16x64_bf16 v[32:35], v[12:15], a[88:95], v113
  s_waitcnt lgkmcnt(3)
  v_smfmac_f32_16x16x64_bf16 v[32:35], v[16:19], a[96:103], v113
  s_waitcnt lgkmcnt(2)
  v_smfmac_f32_16x16x64_bf16 v[32:35], v[20:23], a[104:111], v113
  s_waitcnt lgkmcnt(1)
  v_smfmac_f32_16x16x64_bf16 v[32:35], v[24:27], a[112:119], v113
  s_waitcnt lgkmcnt(0)
  v_smfmac_f32_16x16x64_bf16 v[32:35], v[28:31], a[120:127], v113
  s_waitcnt vmcnt(4)
  v_smfmac_f32_16x16x64_bf16 v[36:39], v[0:3], a[192:199], v113
  v_smfmac_f32_16x16x64_bf16 v[36:39], v[4:7], a[200:207], v113
  v_smfmac_f32_16x16x64_bf16 v[36:39], v[8:11], a[208:215], v113
  v_cvt_pk_bf16_f32 v32, v32, v33
  v_cvt_pk_bf16_f32 v33, v34, v35
  ds_write_b64 v107, v[32:33]
  v_smfmac_f32_16x16x64_bf16 v[36:39], v[12:15], a[216:223], v113
  v_smfmac_f32_16x16x64_bf16 v[36:39], v[16:19], a[224:231], v113
  v_smfmac_f32_16x16x64_bf16 v[36:39], v[20:23], a[232:239], v113
  s_waitcnt lgkmcnt(0)
  s_barrier
  ds_read_b64_tr_b16 v[88:89], v108 offset:0
  ds_read_b64_tr_b16 v[90:91], v108 offset:128
  v_smfmac_f32_16x16x64_bf16 v[36:39], v[24:27], a[240:247], v113
  ds_read_b64_tr_b16 v[92:93], v108 offset:512
  ds_read_b64_tr_b16 v[94:95], v108 offset:640
  v_smfmac_f32_16x16x64_bf16 v[36:39], v[28:31], a[248:255], v113
  ds_read_b64_tr_b16 v[96:97], v108 offset:1024
  ds_read_b64_tr_b16 v[98:99], v108 offset:1152
  v_smfmac_f32_16x16x64_bf16 v[40:43], v[0:3], v[192:199], v113
  ds_read_b64_tr_b16 v[100:101], v108 offset:1536
  ds_read_b64_tr_b16 v[102:103], v108 offset:1664
  v_smfmac_f32_16x16x64_bf16 v[40:43], v[4:7], v[200:207], v113
  v_smfmac_f32_16x16x64_bf16 v[40:43], v[8:11], v[208:215], v113
  buffer_store_dwordx4 v[124:127], v111, s[4:7], s24 offen sc1
  v_cvt_pk_bf16_f32 v52, v36, v37
  s_waitcnt lgkmcnt(6)
  v_mfma_f32_16x16x32_bf16 v[32:35], v[56:59], v[88:91], 0
  v_cvt_pk_bf16_f32 v53, v38, v39
  ds_write_b64 v107, v[52:53] offset:2048
  s_waitcnt lgkmcnt(5)
  v_mfma_f32_16x16x32_bf16 v[32:35], v[60:63], v[92:95], v[32:35]
  buffer_store_dwordx4 v[124:127], v111, s[4:7], s24 offen offset:1024 sc1
  ds_read_b128 v[56:59], v106 offset:0
  s_waitcnt lgkmcnt(4)
  v_mfma_f32_16x16x32_bf16 v[32:35], v[64:67], v[96:99], v[32:35]
  ds_read_b128 v[60:63], v106 offset:1024
  s_waitcnt lgkmcnt(3)
  v_mfma_f32_16x16x32_bf16 v[32:35], v[68:71], v[100:103], v[32:35]
  s_mov_b64 exec, s[32:33]
  buffer_store_dword v124, v112, s[4:7], s47 offen sc1
  s_mov_b64 exec, -1
  s_waitcnt lgkmcnt(2)
  s_barrier
  ds_read_b64_tr_b16 v[0:1], v108 offset:2048
  v_mfma_f32_16x16x32_bf16 v[124:127], v[72:75], v[88:91], 0
  ds_read_b64_tr_b16 v[2:3], v108 offset:2176
  ds_read_b64_tr_b16 v[4:5], v108 offset:2560
  v_mfma_f32_16x16x32_bf16 v[124:127], v[76:79], v[92:95], v[124:127]
  s_mov_b64 exec, 1
  buffer_store_dword v120, off, s[4:7], s37 sc1
  s_mov_b64 exec, -1
  s_add_u32 s37, s37, 16
  ds_read_b64_tr_b16 v[6:7], v108 offset:2688
  v_mfma_f32_16x16x32_bf16 v[124:127], v[80:83], v[96:99], v[124:127]
  ds_read_b64_tr_b16 v[8:9], v108 offset:3072
  ds_read_b64_tr_b16 v[10:11], v108 offset:3200
  v_mfma_f32_16x16x32_bf16 v[124:127], v[84:87], v[100:103], v[124:127]
  buffer_load_dword v114, off, s[4:7], s36 sc1
  ds_read_b128 v[64:67], v106 offset:2048
  v_smfmac_f32_16x16x64_bf16 v[40:43], v[12:15], v[216:223], v113
  ds_read_b64_tr_b16 v[12:13], v108 offset:3584
  ds_read_b64_tr_b16 v[14:15], v108 offset:3712
  v_smfmac_f32_16x16x64_bf16 v[40:43], v[16:19], v[224:231], v113
  ds_read_b128 v[68:71], v106 offset:3072
  ds_read_b128 v[72:75], v106 offset:4096
  v_smfmac_f32_16x16x64_bf16 v[40:43], v[20:23], v[232:239], v113
  ds_read_b128 v[76:79], v106 offset:5120
  ds_read_b128 v[80:83], v106 offset:6144
  v_smfmac_f32_16x16x64_bf16 v[40:43], v[24:27], v[240:247], v113
  ds_read_b128 v[84:87], v106 offset:7168
  v_smfmac_f32_16x16x64_bf16 v[40:43], v[28:31], v[248:255], v113
  s_waitcnt lgkmcnt(12)
  v_mfma_f32_16x16x32_bf16 v[16:19], v[0:3], v[88:91], 0
  v_max3_f32 v20, v32, v33, v34
  v_max3_f32 v21, v35, v124, v125
  s_waitcnt lgkmcnt(10)
  v_mfma_f32_16x16x32_bf16 v[16:19], v[4:7], v[92:95], v[16:19]
  v_max3_f32 v20, v20, v126, v127
  v_max_f32 v20, v20, v21
  s_waitcnt lgkmcnt(8)
  v_mfma_f32_16x16x32_bf16 v[16:19], v[8:11], v[96:99], v[16:19]
  v_cvt_pk_bf16_f32 v54, v40, v41
  v_cvt_pk_bf16_f32 v55, v42, v43
  s_waitcnt lgkmcnt(5)
  v_mfma_f32_16x16x32_bf16 v[16:19], v[12:15], v[100:103], v[16:19]
  s_nop 7
  v_max3_f32 v21, v16, v17, v18
  v_max3_f32 v20, v20, v21, v19
  v_mov_b32 v21, v20
  s_nop 1
  v_permlane16_swap_b32 v20, v21
  v_max_f32 v20, v20, v21
  v_mov_b32 v21, v20
  s_nop 1
  v_permlane32_swap_b32 v20, v21
  v_max_f32 v20, v20, v21
  v_mul_f32 v20, s28, v20
  v_pk_fma_f32 v[32:33], v[32:33], s[28:29], v[20:21] op_sel_hi:[1,1,0] neg_lo:[0,0,1] neg_hi:[0,0,1]
  v_pk_fma_f32 v[34:35], v[34:35], s[28:29], v[20:21] op_sel_hi:[1,1,0] neg_lo:[0,0,1] neg_hi:[0,0,1]
  v_pk_fma_f32 v[124:125], v[124:125], s[28:29], v[20:21] op_sel_hi:[1,1,0] neg_lo:[0,0,1] neg_hi:[0,0,1]
  v_pk_fma_f32 v[126:127], v[126:127], s[28:29], v[20:21] op_sel_hi:[1,1,0] neg_lo:[0,0,1] neg_hi:[0,0,1]
  v_pk_fma_f32 v[16:17], v[16:17], s[28:29], v[20:21] op_sel_hi:[1,1,0] neg_lo:[0,0,1] neg_hi:[0,0,1]
  v_pk_fma_f32 v[18:19], v[18:19], s[28:29], v[20:21] op_sel_hi:[1,1,0] neg_lo:[0,0,1] neg_hi:[0,0,1]
  v_exp_f32 v32, v32
  v_exp_f32 v33, v33
  v_exp_f32 v34, v34
  v_exp_f32 v35, v35
  v_exp_f32 v124, v124
  v_exp_f32 v125, v125
  v_exp_f32 v126, v126
  v_exp_f32 v127, v127
  v_exp_f32 v16, v16
  v_cvt_pk_bf16_f32 v88, v32, v33
  v_exp_f32 v17, v17
  v_cvt_pk_bf16_f32 v89, v34, v35
  v_exp_f32 v18, v18
  v_cvt_pk_bf16_f32 v90, v124, v125
  v_exp_f32 v19, v19
  v_cvt_pk_bf16_f32 v91, v126, v127
  v_cvt_pk_bf16_f32 v92, v16, v17
  v_cvt_pk_bf16_f32 v93, v18, v19
  v_mfma_f32_16x16x32_bf16 v[8:11], v[120:123], v[88:91], 0
  v_cndmask_b32 v94, 0, v92, s[30:31]
  v_cndmask_b32 v95, 0, v93, s[30:31]
  v_mfma_f32_16x16x32_bf16 v[0:3], v[44:47], v[88:91], 0
  v_cndmask_b32 v96, v92, 0, s[30:31]
  v_cndmask_b32 v97, v93, 0, s[30:31]
  v_mfma_f32_16x16x32_bf16 v[4:7], v[48:51], v[88:91], 0
  v_mov_b64 v[32:33], 0
  v_mov_b64 v[34:35], 0
  v_mfma_f32_16x16x16_bf16 v[8:11], v[120:121], v[94:95], v[8:11]
  v_mov_b64 v[36:37], 0
  buffer_store_dwordx4 v[52:55], v105, s[4:7], s35 offen sc1
  v_mfma_f32_16x16x16_bf16 v[0:3], v[54:55], v[94:95], v[0:3]
  v_mov_b64 v[38:39], 0
  ds_read_b128 v[88:91], v106 offset:8192
  v_mfma_f32_16x16x16_bf16 v[4:7], v[54:55], v[96:97], v[4:7]
  v_mov_b64 v[40:41], 0
  ds_read_b128 v[92:95], v106 offset:9216
  v_mov_b64 v[42:43], 0
  v_rcp_f32 v98, v8
  ds_read_b128 v[48:51], v106 offset:10240
  v_mov_b64 v[44:45], 0
  ds_read_b128 v[52:55], v106 offset:11264
  v_mov_b64 v[46:47], 0
  v_pk_mul_f32 v[0:1], v[0:1], v[98:99] op_sel_hi:[1,0]
  v_cvt_pk_bf16_f32 v100, v0, v1
  v_pk_mul_f32 v[2:3], v[2:3], v[98:99] op_sel_hi:[1,0]
  v_cvt_pk_bf16_f32 v101, v2, v3
  ds_write_b64 v109, v[100:101]
  v_pk_mul_f32 v[4:5], v[4:5], v[98:99] op_sel_hi:[1,0]
  v_cvt_pk_bf16_f32 v102, v4, v5
  v_pk_mul_f32 v[6:7], v[6:7], v[98:99] op_sel_hi:[1,0]
  v_cvt_pk_bf16_f32 v103, v6, v7
  ds_write_b64 v109, v[102:103] offset:256
  ds_read_b128 v[0:3], v106 offset:12288
  ds_read_b128 v[4:7], v106 offset:13312
  s_waitcnt lgkmcnt(2)
  s_barrier
  ds_read_b128 v[16:19], v115 offset:28672
  ds_read_b128 v[20:23], v115 offset:29184
  ds_read_b128 v[24:27], v115 offset:29696
  ds_read_b128 v[28:31], v115 offset:30208
  ds_read_b128 v[8:11], v106 offset:14336
  ds_read_b128 v[12:15], v106 offset:15360
  s_waitcnt lgkmcnt(5)
  v_smfmac_f32_16x16x64_bf16 v[32:35], v[16:19], v[56:63], v113
  ds_read_b128 v[56:59], v106 offset:16384
  s_waitcnt lgkmcnt(5)
  v_smfmac_f32_16x16x64_bf16 v[32:35], v[20:23], v[64:71], v113
  ds_read_b128 v[60:63], v106 offset:17408
  s_waitcnt lgkmcnt(5)
  v_smfmac_f32_16x16x64_bf16 v[32:35], v[24:27], v[72:79], v113
  ds_read_b128 v[64:67], v106 offset:18432
  s_waitcnt lgkmcnt(5)
  v_smfmac_f32_16x16x64_bf16 v[32:35], v[28:31], v[80:87], v113
  ds_read_b128 v[68:71], v106 offset:19456
  v_smfmac_f32_16x16x64_bf16 v[36:39], v[16:19], v[88:95], v113
  ds_read_b128 v[72:75], v106 offset:20480
  v_smfmac_f32_16x16x64_bf16 v[36:39], v[20:23], v[48:55], v113
  ds_read_b128 v[76:79], v106 offset:21504
  v_smfmac_f32_16x16x64_bf16 v[36:39], v[24:27], v[0:7], v113
  ds_read_b128 v[80:83], v106 offset:22528
  v_cvt_pk_bf16_f32 v32, v32, v33
  v_cvt_pk_bf16_f32 v33, v34, v35
  buffer_store_dwordx2 v[32:33], v110, s[4:7], s41 offen sc1
  s_waitcnt lgkmcnt(7)
  v_smfmac_f32_16x16x64_bf16 v[36:39], v[28:31], v[8:15], v113
  ds_read_b128 v[84:87], v106 offset:23552
  s_waitcnt lgkmcnt(6)
  v_smfmac_f32_16x16x64_bf16 v[40:43], v[16:19], v[56:63], v113
  ds_read_b128 v[88:91], v106 offset:24576
  ds_read_b128 v[92:95], v106 offset:25600
  s_waitcnt lgkmcnt(6)
  v_smfmac_f32_16x16x64_bf16 v[40:43], v[20:23], v[64:71], v113
  ds_read_b128 v[48:51], v106 offset:26624
  ds_read_b128 v[52:55], v106 offset:27648
  s_waitcnt lgkmcnt(6)
  v_smfmac_f32_16x16x64_bf16 v[40:43], v[24:27], v[72:79], v113
  ds_read_b128 v[0:3], v106 offset:28672
  ds_read_b128 v[4:7], v106 offset:29696
  v_cvt_pk_bf16_f32 v36, v36, v37
  v_cvt_pk_bf16_f32 v37, v38, v39
  buffer_store_dwordx2 v[36:37], v110, s[4:7], s42 offen sc1
  s_waitcnt lgkmcnt(6)
  v_smfmac_f32_16x16x64_bf16 v[40:43], v[28:31], v[80:87], v113
  ds_read_b128 v[8:11], v106 offset:30720
  ds_read_b128 v[12:15], v106 offset:31744
  s_waitcnt lgkmcnt(6)
  v_smfmac_f32_16x16x64_bf16 v[44:47], v[16:19], v[88:95], v113
  s_waitcnt lgkmcnt(4)
  v_smfmac_f32_16x16x64_bf16 v[44:47], v[20:23], v[48:55], v113
  s_waitcnt lgkmcnt(2)
  v_smfmac_f32_16x16x64_bf16 v[44:47], v[24:27], v[0:7], v113
  v_cvt_pk_bf16_f32 v40, v40, v41
  v_cvt_pk_bf16_f32 v41, v42, v43
  buffer_store_dwordx2 v[40:41], v110, s[4:7], s43 offen sc1
  s_waitcnt lgkmcnt(0)
  v_smfmac_f32_16x16x64_bf16 v[44:47], v[28:31], v[8:15], v113
  s_add_u32 s21, s21, 8192
  s_and_b32 s21, s21, 0x7fff
  s_add_u32 s47, s21, 16384
  s_add_u32 s21, s21, 65536
  s_and_b32 s47, s47, 0x7fff
  s_add_u32 s47, s47, 65536
  s_add_u32 s35, s35, 262144
  s_add_u32 s20, s20, 1
  v_cvt_pk_bf16_f32 v44, v44, v45
  v_cvt_pk_bf16_f32 v45, v46, v47
  buffer_store_dwordx2 v[44:45], v110, s[4:7], s44 offen sc1
  s_mov_b32 s38, 0
  v_mov_b64 v[32:33], 0
  v_mov_b64 v[34:35], 0
  v_mov_b64 v[36:37], 0
  v_mov_b64 v[38:39], 0
  v_mov_b64 v[40:41], 0
  v_mov_b64 v[42:43], 0
  v_mov_b64 v[124:125], -1
  v_mov_b64 v[126:127], -1
  s_nop 7
  s_nop 7
  s_nop 7
  s_nop 7
  buffer_load_dwordx4 v[16:19], v111, s[4:7], s22 offen offset:0 sc1
  buffer_load_dwordx4 v[20:23], v111, s[4:7], s22 offen offset:1024 sc1
  s_waitcnt vmcnt(0)
  v_mfma_f32_16x16x32_bf16 v[24:27], v[16:19], v[116:119], 0
  v_mfma_f32_16x16x32_bf16 v[24:27], v[20:23], v[116:119], v[24:27]
  v_max3_u32 v28, v16, v17, v18
  v_max3_u32 v29, v19, v20, v21
  v_max3_u32 v28, v28, v22, v23
  v_max_u32 v28, v28, v29
  v_cmp_eq_u32 vcc, -1, v28
  s_cbranch_vccz ch_pA_s_ok
ch_pA_s_loop:
  s_mov_b64 exec, vcc
  buffer_load_dwordx4 v[16:19], v111, s[4:7], s22 offen offset:0 sc1
  buffer_load_dwordx4 v[20:23], v111, s[4:7], s22 offen offset:1024 sc1
  s_mov_b64 exec, -1
  s_add_u32 s38, s38, 1
  s_cmp_gt_u32 s38, 4000000
  s_cbranch_scc1 ch_bail_s
  s_waitcnt vmcnt(0)
  v_mfma_f32_16x16x32_bf16 v[24:27], v[16:19], v[116:119], 0
  v_mfma_f32_16x16x32_bf16 v[24:27], v[20:23], v[116:119], v[24:27]
  v_max3_u32 v28, v16, v17, v18
  v_max3_u32 v29, v19, v20, v21
  v_max3_u32 v28, v28, v22, v23
  v_max_u32 v28, v28, v29
  v_cmp_eq_u32 vcc, -1, v28
  s_cbranch_vccnz ch_pA_s_loop
ch_pA_s_ok:
  s_xor_b32 s22, s22, 0x40000
  s_nop 1
  v_add_f32 v28, v24, v25
  v_add_f32 v29, v26, v27
  v_add_f32 v28, v28, v29
  s_nop 1
  v_mov_b32_dpp v29, v28 row_shl:4 row_mask:0xf bank_mask:0xf
  s_mov_b64 exec, s[32:33]
  v_cvt_pk_bf16_f32 v28, v28, v29
  buffer_store_dword v28, v112, s[4:7], s21 offen sc1
  s_mov_b64 exec, -1
  s_branch ch_step_s
ch_final_s:
  ds_read_b128 v[0:3], v115 offset:0
  ds_read_b128 v[4:7], v115 offset:512
  ds_read_b128 v[8:11], v115 offset:1024
  ds_read_b128 v[12:15], v115 offset:1536
  ds_read_b128 v[16:19], v115 offset:2048
  ds_read_b128 v[20:23], v115 offset:2560
  ds_read_b128 v[24:27], v115 offset:3072
  ds_read_b128 v[28:31], v115 offset:3584
  s_mov_b64 exec, 1
  buffer_store_dword v120, off, s[4:7], s37 sc1
  s_mov_b64 exec, -1
  s_add_u32 s37, s37, 16
  s_waitcnt lgkmcnt(7)
  v_smfmac_f32_16x16x64_bf16 v[36:39], v[0:3], a[128:135], v113
  v_smfmac_f32_16x16x64_bf16 v[40:43], v[0:3], v[128:135], v113
  ds_read_b128 v[0:3], v115 offset:4096
  s_waitcnt lgkmcnt(7)
  v_smfmac_f32_16x16x64_bf16 v[36:39], v[4:7], a[136:143], v113
  v_smfmac_f32_16x16x64_bf16 v[40:43], v[4:7], v[136:143], v113
  ds_read_b128 v[4:7], v115 offset:4608
  s_waitcnt lgkmcnt(7)
  v_smfmac_f32_16x16x64_bf16 v[36:39], v[8:11], a[144:151], v113
  v_smfmac_f32_16x16x64_bf16 v[40:43], v[8:11], v[144:151], v113
  ds_read_b128 v[8:11], v115 offset:5120
  s_waitcnt lgkmcnt(7)
  v_smfmac_f32_16x16x64_bf16 v[36:39], v[12:15], a[152:159], v113
  v_smfmac_f32_16x16x64_bf16 v[40:43], v[12:15], v[152:159], v113
  ds_read_b128 v[12:15], v115 offset:5632
  s_waitcnt lgkmcnt(7)
  v_smfmac_f32_16x16x64_bf16 v[36:39], v[16:19], a[160:167], v113
  v_smfmac_f32_16x16x64_bf16 v[40:43], v[16:19], v[160:167], v113
  ds_read_b128 v[16:19], v115 offset:6144
  s_waitcnt lgkmcnt(7)
  v_smfmac_f32_16x16x64_bf16 v[36:39], v[20:23], a[168:175], v113
  v_smfmac_f32_16x16x64_bf16 v[40:43], v[20:23], v[168:175], v113
  ds_read_b128 v[20:23], v115 offset:6656
  s_waitcnt lgkmcnt(7)
  v_smfmac_f32_16x16x64_bf16 v[36:39], v[24:27], a[176:183], v113
  v_smfmac_f32_16x16x64_bf16 v[40:43], v[24:27], v[176:183], v113
  ds_read_b128 v[24:27], v115 offset:7168
  s_waitcnt lgkmcnt(7)
  v_smfmac_f32_16x16x64_bf16 v[36:39], v[28:31], a[184:191], v113
  v_smfmac_f32_16x16x64_bf16 v[40:43], v[28:31], v[184:191], v113
  ds_read_b128 v[28:31], v115 offset:7680
  s_waitcnt lgkmcnt(7)
  v_smfmac_f32_16x16x64_bf16 v[36:39], v[0:3], a[192:199], v113
  v_smfmac_f32_16x16x64_bf16 v[40:43], v[0:3], v[192:199], v113
  s_waitcnt lgkmcnt(6)
  v_smfmac_f32_16x16x64_bf16 v[36:39], v[4:7], a[200:207], v113
  v_smfmac_f32_16x16x64_bf16 v[40:43], v[4:7], v[200:207], v113
  s_waitcnt lgkmcnt(5)
  v_smfmac_f32_16x16x64_bf16 v[36:39], v[8:11], a[208:215], v113
  v_smfmac_f32_16x16x64_bf16 v[40:43], v[8:11], v[208:215], v113
  s_waitcnt lgkmcnt(4)
  v_smfmac_f32_16x16x64_bf16 v[36:39], v[12:15], a[216:223], v113
  v_smfmac_f32_16x16x64_bf16 v[40:43], v[12:15], v[216:223], v113
  s_waitcnt lgkmcnt(3)
  v_smfmac_f32_16x16x64_bf16 v[36:39], v[16:19], a[224:231], v113
  v_smfmac_f32_16x16x64_bf16 v[40:43], v[16:19], v[224:231], v113
  s_waitcnt lgkmcnt(2)
  v_smfmac_f32_16x16x64_bf16 v[36:39], v[20:23], a[232:239], v113
  v_smfmac_f32_16x16x64_bf16 v[40:43], v[20:23], v[232:239], v113
  s_waitcnt lgkmcnt(1)
  v_smfmac_f32_16x16x64_bf16 v[36:39], v[24:27], a[240:247], v113
  v_smfmac_f32_16x16x64_bf16 v[40:43], v[24:27], v[240:247], v113
  s_waitcnt lgkmcnt(0)
  v_smfmac_f32_16x16x64_bf16 v[36:39], v[28:31], a[248:255], v113
  v_smfmac_f32_16x16x64_bf16 v[40:43], v[28:31], v[248:255], v113
  s_nop 7
  v_cvt_pk_bf16_f32 v52, v36, v37
  v_cvt_pk_bf16_f32 v53, v38, v39
  v_cvt_pk_bf16_f32 v54, v40, v41
  v_cvt_pk_bf16_f32 v55, v42, v43
  buffer_store_dwordx4 v[52:55], v105, s[4:7], s35 offen sc1
  s_waitcnt vmcnt(0)
  s_mov_b64 exec, 1
  buffer_store_dword v120, off, s[4:7], s37 sc1
ch_bail_s:
  s_waitcnt vmcnt(0) lgkmcnt(0)
  s_endpgm
r_overflow:
  s_waitcnt vmcnt(0)
  s_barrier
  v_mov_b32 v252, 1
  v_mov_b32 v251, 1
  s_cmp_lg_u32 s18, 0
  s_cbranch_scc1 ro_w
  s_mov_b64 exec, 1
  s_mov_b32 s22, 0x7fff
  s_cmp_ge_u32 s16, 8
  s_cbranch_scc0 ro_tick
  buffer_atomic_add v251, off, s[12:15], 0 offset:196
  s_branch ro_reg
ro_tick:
  buffer_atomic_add v252, v254, s[12:15], 0 offen offset:160 sc0
  s_waitcnt vmcnt(0)
  v_readfirstlane_b32 s22, v252
  s_nop 1
ro_reg:
  v_mov_b32 v252, s22
  ds_write_b32 v253, v252
  s_mov_b64 exec, -1
ro_w:
  s_waitcnt vmcnt(0) lgkmcnt(0)
  s_barrier
  ds_read_b32 v252, v253
  v_mbcnt_lo_u32_b32 v251, -1, 0
  v_mbcnt_hi_u32_b32 v251, -1, v251
  v_lshlrev_b32 v251, 2, v251
  s_waitcnt lgkmcnt(0)
  v_readfirstlane_b32 s22, v252
  s_mov_b32 s24, 0
ro_census:
  buffer_load_dword v250, v251, s[12:15], 0 offen sc1
  s_add_u32 s24, s24, 1
  s_cmp_gt_u32 s24, 4000000
  s_cbranch_scc1 k_exit
  s_waitcnt vmcnt(0)
  s_mov_b32 s23, 0
  v_readlane_b32 s25, v250, 0
  v_readlane_b32 s26, v250, 40
  s_nop 3
  s_bcnt1_i32_b32 s25, s25
  s_add_u32 s23, s23, s26
  s_add_u32 s23, s23, s25
  v_readlane_b32 s25, v250, 1
  v_readlane_b32 s26, v250, 41
  s_nop 3
  s_bcnt1_i32_b32 s25, s25
  s_add_u32 s23, s23, s26
  s_add_u32 s23, s23, s25
  v_readlane_b32 s25, v250, 2
  v_readlane_b32 s26, v250, 42
  s_nop 3
  s_bcnt1_i32_b32 s25, s25
  s_add_u32 s23, s23, s26
  s_add_u32 s23, s23, s25
  v_readlane_b32 s25, v250, 3
  v_readlane_b32 s26, v250, 43
  s_nop 3
  s_bcnt1_i32_b32 s25, s25
  s_add_u32 s23, s23, s26
  s_add_u32 s23, s23, s25
  v_readlane_b32 s25, v250, 4
  v_readlane_b32 s26, v250, 44
  s_nop 3
  s_bcnt1_i32_b32 s25, s25
  s_add_u32 s23, s23, s26
  s_add_u32 s23, s23, s25
  v_readlane_b32 s25, v250, 5
  v_readlane_b32 s26, v250, 45
  s_nop 3
  s_bcnt1_i32_b32 s25, s25
  s_add_u32 s23, s23, s26
  s_add_u32 s23, s23, s25
  v_readlane_b32 s25, v250, 6
  v_readlane_b32 s26, v250, 46
  s_nop 3
  s_bcnt1_i32_b32 s25, s25
  s_add_u32 s23, s23, s26
  s_add_u32 s23, s23, s25
  v_readlane_b32 s25, v250, 7
  v_readlane_b32 s26, v250, 47
  s_nop 3
  s_bcnt1_i32_b32 s25, s25
  s_add_u32 s23, s23, s26
  s_add_u32 s23, s23, s25
  v_readlane_b32 s25, v250, 49
  s_nop 3
  s_add_u32 s23, s23, s25
  s_cmp_lt_u32 s23, 256
  s_cbranch_scc1 ro_census
  v_readlane_b32 s26, v250, s19
  s_nop 3
  s_not_b32 s26, s26
  s_bcnt1_i32_b32 s25, s26
  s_cmp_lt_u32 s22, s25
  s_cbranch_scc1 ro_nth
  s_barrier
  s_cmp_lg_u32 s18, 0
  s_cbranch_scc1 ro_w2
  s_mov_b64 exec, 1
  v_mov_b32 v252, 1
  buffer_atomic_add v252, off, s[12:15], 0 offset:192 sc0
  s_waitcnt vmcnt(0)
  ds_write_b32 v253, v252
  s_mov_b64 exec, -1
ro_w2:
  s_waitcnt lgkmcnt(0)
  s_barrier
  ds_read_b32 v252, v253
  s_waitcnt lgkmcnt(0)
  v_readfirstlane_b32 s27, v252
  v_readlane_b32 s26, v250, 0
  v_readlane_b32 s24, v250, 40
  s_nop 3
  s_not_b32 s26, s26
  s_bcnt1_i32_b32 s25, s26
  s_min_u32 s24, s24, s25
  s_sub_u32 s25, s25, s24
  s_add_u32 s22, s24, s27
  s_mov_b32 s19, 0
  s_cmp_lt_u32 s27, s25
  s_cbranch_scc1 ro_nth
  s_sub_u32 s27, s27, s25
  v_readlane_b32 s26, v250, 1
  v_readlane_b32 s24, v250, 41
  s_nop 3
  s_not_b32 s26, s26
  s_bcnt1_i32_b32 s25, s26
  s_min_u32 s24, s24, s25
  s_sub_u32 s25, s25, s24
  s_add_u32 s22, s24, s27
  s_mov_b32 s19, 1
  s_cmp_lt_u32 s27, s25
  s_cbranch_scc1 ro_nth
  s_sub_u32 s27, s27, s25
  v_readlane_b32 s26, v250, 2
  v_readlane_b32 s24, v250, 42
  s_nop 3
  s_not_b32 s26, s26
  s_bcnt1_i32_b32 s25, s26
  s_min_u32 s24, s24, s25
  s_sub_u32 s25, s25, s24
  s_add_u32 s22, s24, s27
  s_mov_b32 s19, 2
  s_cmp_lt_u32 s27, s25
  s_cbranch_scc1 ro_nth
  s_sub_u32 s27, s27, s25
  v_readlane_b32 s26, v250, 3
  v_readlane_b32 s24, v250, 43
  s_nop 3
  s_not_b32 s26, s26
  s_bcnt1_i32_b32 s25, s26
  s_min_u32 s24, s24, s25
  s_sub_u32 s25, s25, s24
  s_add_u32 s22, s24, s27
  s_mov_b32 s19, 3
  s_cmp_lt_u32 s27, s25
  s_cbranch_scc1 ro_nth
  s_sub_u32 s27, s27, s25
  v_readlane_b32 s26, v250, 4
  v_readlane_b32 s24, v250, 44
  s_nop 3
  s_not_b32 s26, s26
  s_bcnt1_i32_b32 s25, s26
  s_min_u32 s24, s24, s25
  s_sub_u32 s25, s25, s24
  s_add_u32 s22, s24, s27
  s_mov_b32 s19, 4
  s_cmp_lt_u32 s27, s25
  s_cbranch_scc1 ro_nth
  s_sub_u32 s27, s27, s25
  v_readlane_b32 s26, v250, 5
  v_readlane_b32 s24, v250, 45
  s_nop 3
  s_not_b32 s26, s26
  s_bcnt1_i32_b32 s25, s26
  s_min_u32 s24, s24, s25
  s_sub_u32 s25, s25, s24
  s_add_u32 s22, s24, s27
  s_mov_b32 s19, 5
  s_cmp_lt_u32 s27, s25
  s_cbranch_scc1 ro_nth
  s_sub_u32 s27, s27, s25
  v_readlane_b32 s26, v250, 6
  v_readlane_b32 s24, v250, 46
  s_nop 3
  s_not_b32 s26, s26
  s_bcnt1_i32_b32 s25, s26
  s_min_u32 s24, s24, s25
  s_sub_u32 s25, s25, s24
  s_add_u32 s22, s24, s27
  s_mov_b32 s19, 6
  s_cmp_lt_u32 s27, s25
  s_cbranch_scc1 ro_nth
  s_sub_u32 s27, s27, s25
  v_readlane_b32 s26, v250, 7
  v_readlane_b32 s24, v250, 47
  s_nop 3
  s_not_b32 s26, s26
  s_bcnt1_i32_b32 s25, s26
  s_min_u32 s24, s24, s25
  s_sub_u32 s25, s25, s24
  s_add_u32 s22, s24, s27
  s_mov_b32 s19, 7
  s_cmp_lt_u32 s27, s25
  s_cbranch_scc1 ro_nth
  s_sub_u32 s27, s27, s25
  s_branch k_exit
ro_nth:
  s_ff1_i32_b32 s17, s26
  s_cmp_eq_u32 s22, 0
  s_cbranch_scc1 r_resolved
  s_bitset0_b32 s26, s17
  s_sub_u32 s22, s22, 1
  s_branch ro_nth
r_resolved:
  s_mov_b32 s3, 1
  s_barrier
  v_mbcnt_lo_u32_b32 v0, -1, 0
  v_mbcnt_hi_u32_b32 v0, -1, v0
  s_lshl_b32 s22, s18, 6
  v_add_u32 v0, s22, v0
  s_branch r_dispatch
role_worker:
  v_and_b32 v112, 63, v0
  v_lshlrev_b32 v113, 4, v112
  s_lshl_b32 s32, s18, 14
  s_add_u32 s32, s32, 98304
  s_lshl_b32 s21, s18, 10
  v_add_u32 v116, s21, v113
  v_bfe_u32 v0, v112, 2, 2
  v_lshlrev_b32 v0, 6, v0
  v_bfe_u32 v1, v112, 4, 1
  v_lshl_add_u32 v0, v1, 5, v0
  v_and_b32 v1, 3, v112
  v_lshl_add_u32 v0, v1, 3, v0
  v_add_u32 v0, s32, v0
  v_lshrrev_b32 v1, 5, v112
  v_lshl_add_u32 v114, v1, 9, v0
  v_lshl_add_u32 v115, v1, 8, v0
  v_lshlrev_b32 v0, 9, v112
  s_lshl_b32 s21, s17, 4
  v_add_u32 v125, s21, v0
  v_and_b32 v0, 31, v112
  v_lshlrev_b32 v0, 3, v0
  v_lshrrev_b32 v1, 5, v112
  v_lshl_add_u32 v0, v1, 2, v0
  s_lshl_b32 s21, s18, 8
  v_add_u32 v118, s21, v0
  v_lshlrev_b32 v0, 16, v1
  v_and_b32 v1, 31, v112
  v_lshl_add_u32 v0, v1, 2, v0
  s_lshl_b32 s21, s18, 7
  v_add_u32 v117, s21, v0
  v_bfe_u32 v0, v112, 3, 1
  v_lshlrev_b32 v0, 12, v0
  v_bfe_u32 v1, v112, 4, 1
  v_lshl_add_u32 v0, v1, 7, v0
  v_and_b32 v1, 7, v112
  v_lshl_add_u32 v0, v1, 4, v0
  v_lshrrev_b32 v1, 5, v112
  v_lshl_add_u32 v119, v1, 8, v0
  v_bfe_u32 v0, v112, 4, 1
  v_lshlrev_b32 v0, 10, v0
  v_lshrrev_b32 v1, 5, v112
  v_lshl_add_u32 v0, v1, 8, v0
  v_and_b32 v1, 15, v112
  v_lshl_add_u32 v0, v1, 4, v0
  s_lshl_b32 s21, s18, 11
  v_add_u32 v120, s21, v0
  v_lshrrev_b32 v0, 5, v112
  v_lshlrev_b32 v0, 6, v0
  v_bfe_u32 v1, v112, 2, 2
  v_lshl_add_u32 v0, v1, 4, v0
  v_and_b32 v1, 1, v112
  v_lshl_add_u32 v121, v1, 8, v0
  v_bfe_u32 v0, v112, 4, 1
  v_lshlrev_b32 v0, 9, v0
  v_lshrrev_b32 v1, 5, v112
  v_lshl_add_u32 v0, v1, 8, v0
  v_and_b32 v1, 15, v112
  v_lshl_add_u32 v0, v1, 4, v0
  s_lshl_b32 s21, s18, 10
  s_add_u32 s21, s21, 8
  v_add_u32 v122, s21, v0
  v_lshrrev_b32 v0, 5, v112
  v_lshlrev_b32 v0, 9, v0
  v_and_b32 v1, 15, v112
  v_lshl_add_u32 v0, v1, 4, v0
  v_bfe_u32 v1, v112, 4, 1
  v_lshl_add_u32 v0, v1, 3, v0
  s_lshl_b32 s21, s18, 10
  v_add_u32 v123, s21, v0
  v_lshrrev_b32 v0, 4, v112
  v_lshlrev_b32 v0, 9, v0
  v_and_b32 v1, 15, v112
  v_lshl_add_u32 v124, v1, 4, v0
  s_mov_b32 s78, -1
  s_mov_b32 s79, 0
  s_load_dwordx2 s[8:9], s[0:1], 104
  s_mov_b32 s10, 0x300000
  s_mov_b32 s11, 0x00020000
  s_waitcnt lgkmcnt(0)
  v_lshrrev_b32 v0, 2, v112
  s_lshl_b32 s21, s18, 7
  v_add_u32 v0, s21, v0
  v_mul_u32_u24 v0, 6144, v0
  v_and_b32 v1, 3, v112
  v_lshl_add_u32 v0, v1, 4, v0
  s_mul_i32 s21, s17, 64
  s_add_u32 s21, s21, 0
  s_lshl_b32 s22, s18, 14
  s_add_u32 s22, s22, 32768
  s_add_u32 m0, s22, 0
  s_add_u32 s80, s21, 0
  buffer_load_dwordx4 v0, s[8:11], s80 offen lds
  s_add_u32 m0, s22, 1024
  s_add_u32 s80, s21, 98304
  buffer_load_dwordx4 v0, s[8:11], s80 offen lds
  s_add_u32 m0, s22, 2048
  s_add_u32 s80, s21, 196608
  buffer_load_dwordx4 v0, s[8:11], s80 offen lds
  s_add_u32 m0, s22, 3072
  s_add_u32 s80, s21, 294912
  buffer_load_dwordx4 v0, s[8:11], s80 offen lds
  s_add_u32 m0, s22, 4096
  s_add_u32 s80, s21, 393216
  buffer_load_dwordx4 v0, s[8:11], s80 offen lds
  s_add_u32 m0, s22, 5120
  s_add_u32 s80, s21, 491520
  buffer_load_dwordx4 v0, s[8:11], s80 offen lds
  s_add_u32 m0, s22, 6144
  s_add_u32 s80, s21, 589824
  buffer_load_dwordx4 v0, s[8:11], s80 offen lds
  s_add_u32 m0, s22, 7168
  s_add_u32 s80, s21, 688128
  buffer_load_dwordx4 v0, s[8:11], s80 offen lds
  s_load_dwordx2 s[8:9], s[0:1], 96
  s_mov_b32 s10, 0x400
  s_mov_b32 s11, 0x00020000
  s_waitcnt lgkmcnt(0)
  s_lshl_b32 s21, s18, 8
  v_lshlrev_b32 v98, 2, v112
  v_add_u32 v98, s21, v98
  buffer_load_dword v99, v98, s[8:11], 0 offen
  s_load_dwordx2 s[8:9], s[0:1], 0
  s_mov_b32 s10, 0x200000
  s_mov_b32 s11, 0x00020000
  s_waitcnt lgkmcnt(0)
  s_mul_i32 s21, s18, 7
  s_add_u32 s21, s21, s19
  s_sub_u32 s20, s21, 1
  s_lshl_b32 s21, s20, 5
  s_add_u32 s21, s21, s17
  s_lshl_b32 s21, s21, 10
  buffer_load_dwordx4 v[100:103], v113, s[8:11], s21 offen
  s_add_u32 s21, s21, 917504
  buffer_load_dwordx4 v[104:107], v113, s[8:11], s21 offen
  s_add_u32 s21, s21, 917504
  buffer_load_dwordx4 v[108:111], v113, s[8:11], s21 offen
  v_lshrrev_b32 v0, 2, v112
  v_lshlrev_b32 v0, 13, v0
  v_and_b32 v1, 3, v112
  v_lshl_add_u32 v0, v1, 4, v0
  s_lshl_b32 s21, s17, 8
  s_lshl_b32 s22, s18, 6
  s_add_u32 s21, s21, s22
  v_add_u32 v126, s21, v0
  s_load_dwordx2 s[28:29], s[0:1], 24
  s_mov_b32 s30, 0x400000
  s_mov_b32 s31, 0x00020000
  s_waitcnt lgkmcnt(0)
  s_add_u32 m0, s32, 0
  s_mov_b32 s80, 0
  buffer_load_dwordx4 v126, s[28:31], s80 offen  lds
  s_add_u32 m0, s32, 1024
  s_mov_b32 s80, 131072
  buffer_load_dwordx4 v126, s[28:31], s80 offen  lds
  s_add_u32 m0, s32, 2048
  s_mov_b32 s80, 262144
  buffer_load_dwordx4 v126, s[28:31], s80 offen  lds
  s_add_u32 m0, s32, 3072
  s_mov_b32 s80, 393216
  buffer_load_dwordx4 v126, s[28:31], s80 offen  lds
  s_add_u32 m0, s32, 4096
  s_mov_b32 s80, 524288
  buffer_load_dwordx4 v126, s[28:31], s80 offen  lds
  s_add_u32 m0, s32, 5120
  s_mov_b32 s80, 655360
  buffer_load_dwordx4 v126, s[28:31], s80 offen  lds
  s_add_u32 m0, s32, 6144
  s_mov_b32 s80, 786432
  buffer_load_dwordx4 v126, s[28:31], s80 offen  lds
  s_add_u32 m0, s32, 7168
  s_mov_b32 s80, 917504
  buffer_load_dwordx4 v126, s[28:31], s80 offen  lds
  s_add_u32 m0, s32, 8192
  s_mov_b32 s80, 1048576
  buffer_load_dwordx4 v126, s[28:31], s80 offen  lds
  s_add_u32 m0, s32, 9216
  s_mov_b32 s80, 1179648
  buffer_load_dwordx4 v126, s[28:31], s80 offen  lds
  s_add_u32 m0, s32, 10240
  s_mov_b32 s80, 1310720
  buffer_load_dwordx4 v126, s[28:31], s80 offen  lds
  s_add_u32 m0, s32, 11264
  s_mov_b32 s80, 1441792
  buffer_load_dwordx4 v126, s[28:31], s80 offen  lds
  s_add_u32 m0, s32, 12288
  s_mov_b32 s80, 1572864
  buffer_load_dwordx4 v126, s[28:31], s80 offen  lds
  s_add_u32 m0, s32, 13312
  s_mov_b32 s80, 1703936
  buffer_load_dwordx4 v126, s[28:31], s80 offen  lds
  s_add_u32 m0, s32, 14336
  s_mov_b32 s80, 1835008
  buffer_load_dwordx4 v126, s[28:31], s80 offen  lds
  s_add_u32 m0, s32, 15360
  s_mov_b32 s80, 1966080
  buffer_load_dwordx4 v126, s[28:31], s80 offen  lds
  s_waitcnt vmcnt(19)
  v_lshlrev_b32 v4, 16, v99
  v_and_b32 v5, 0xffff0000, v99
  v_mul_f32 v6, 0xbfb8aa3b, v4
  v_exp_f32 v6, v6
  s_nop 0
  v_add_f32 v6, 1.0, v6
  v_rcp_f32 v6, v6
  s_nop 0
  v_mul_f32 v4, v4, v6
  v_mul_f32 v7, 0xbfb8aa3b, v5
  v_exp_f32 v7, v7
  s_nop 0
  v_add_f32 v7, 1.0, v7
  v_rcp_f32 v7, v7
  s_nop 0
  v_mul_f32 v5, v5, v7
  v_cvt_pk_bf16_f32 v3, v4, v5
  ds_write_b32 v98, v3 offset:30720
  s_waitcnt lgkmcnt(0)
  s_barrier
  s_lshl_b32 s22, s18, 14
  s_add_u32 s22, s22, 32768
  s_sub_u32 s22, s22, s32
  v_add_u32 v1, s22, v114
  v_lshrrev_b32 v2, 5, v112
  v_lshlrev_b32 v2, 4, v2
  s_lshl_b32 s21, s18, 8
  v_add_u32 v2, s21, v2
  ds_read_b128 v[4:7], v2 offset:30720
  ds_read_b128 v[8:11], v2 offset:30752
  ds_read_b128 v[12:15], v2 offset:30784
  ds_read_b128 v[16:19], v2 offset:30816
  ds_read_b128 v[20:23], v2 offset:30848
  ds_read_b128 v[24:27], v2 offset:30880
  ds_read_b128 v[28:31], v2 offset:30912
  ds_read_b128 v[32:35], v2 offset:30944
  s_waitcnt lgkmcnt(0)
  ds_read_b64_tr_b16 v[36:37], v1 offset:0
  ds_read_b64_tr_b16 v[38:39], v1 offset:256
  ds_read_b64_tr_b16 v[40:41], v1 offset:1024
  ds_read_b64_tr_b16 v[42:43], v1 offset:1280
  ds_read_b64_tr_b16 v[44:45], v1 offset:2048
  ds_read_b64_tr_b16 v[46:47], v1 offset:2304
  ds_read_b64_tr_b16 v[48:49], v1 offset:3072
  ds_read_b64_tr_b16 v[50:51], v1 offset:3328
  ds_read_b64_tr_b16 v[52:53], v1 offset:4096
  ds_read_b64_tr_b16 v[54:55], v1 offset:4352
  ds_read_b64_tr_b16 v[56:57], v1 offset:5120
  ds_read_b64_tr_b16 v[58:59], v1 offset:5376
  ds_read_b64_tr_b16 v[60:61], v1 offset:6144
  ds_read_b64_tr_b16 v[62:63], v1 offset:6400
  ds_read_b64_tr_b16 v[64:65], v1 offset:7168
  ds_read_b64_tr_b16 v[66:67], v1 offset:7424
  s_waitcnt lgkmcnt(0)
  v_mfma_f32_32x32x16_bf16 v[68:83], v[4:7], v[36:39], 0
  v_mfma_f32_32x32x16_bf16 v[68:83], v[8:11], v[40:43], v[68:83]
  v_mfma_f32_32x32x16_bf16 v[68:83], v[12:15], v[44:47], v[68:83]
  v_mfma_f32_32x32x16_bf16 v[68:83], v[16:19], v[48:51], v[68:83]
  v_mfma_f32_32x32x16_bf16 v[68:83], v[20:23], v[52:55], v[68:83]
  v_mfma_f32_32x32x16_bf16 v[68:83], v[24:27], v[56:59], v[68:83]
  v_mfma_f32_32x32x16_bf16 v[68:83], v[28:31], v[60:63], v[68:83]
  v_mfma_f32_32x32x16_bf16 v[68:83], v[32:35], v[64:67], v[68:83]
  s_nop 15
  v_and_b32 v1, 31, v112
  v_lshlrev_b32 v1, 2, v1
  s_lshl_b32 s21, s18, 8
  v_add_u32 v2, s21, v1
  ds_write_b32 v2, v68 offset:31744
  s_waitcnt lgkmcnt(0)
  s_barrier
  v_lshlrev_b32 v1, 3, v112
  v_and_b32 v1, 255, v1
  ds_read_b64 v[4:5], v1 offset:31744
  ds_read_b64 v[6:7], v1 offset:32000
  ds_read_b64 v[8:9], v1 offset:32256
  ds_read_b64 v[10:11], v1 offset:32512
  s_waitcnt lgkmcnt(0)
  v_add_f32 v4, v4, v6
  v_add_f32 v8, v8, v10
  v_add_f32 v4, v4, v8
  v_add_f32 v5, v5, v7
  v_add_f32 v9, v9, v11
  v_add_f32 v5, v5, v9
  v_cvt_pk_bf16_f32 v4, v4, v5
  s_cmp_lg_u32 s3, 0
  s_cbranch_scc1 wk_conf_ok
  v_mov_b32 v253, 30712
  s_cmp_lg_u32 s18, 0
  s_cbranch_scc1 wk_conf_w
  s_waitcnt vmcnt(19)
  v_readfirstlane_b32 s22, v255
  s_lshl_b32 s23, 1, s17
  s_nop 2
  s_and_b32 s22, s22, s23
  s_cmp_ge_u32 s16, 8
  s_cselect_b32 s22, 1, s22
  v_mov_b32 v252, s22
  ds_write_b32 v253, v252
wk_conf_w:
  s_waitcnt lgkmcnt(0)
  s_barrier
  ds_read_b32 v252, v253
  s_waitcnt lgkmcnt(0)
  v_readfirstlane_b32 s22, v252
  s_nop 3
  s_cmp_lg_u32 s22, 0
  s_cbranch_scc1 r_overflow
wk_conf_ok:
  s_or_b32 s22, s17, s18
  s_cmp_lg_u32 s22, 0
  s_cbranch_scc1 wk_conf_nl
  v_mbcnt_lo_u32_b32 v250, -1, 0
  v_mbcnt_hi_u32_b32 v250, -1, v250
  v_lshlrev_b32 v250, 3, v250
  v_mov_b64 v[252:253], 0
  s_lshl_b32 s22, s19, 10
  s_add_u32 s22, s22, 49152
  buffer_store_dwordx2 v[252:253], v250, s[4:7], s22 offen sc1
  v_lshlrev_b32 v250, 1, v250
  v_mov_b64 v[246:247], -1
  v_mov_b64 v[248:249], -1
  s_lshl_b32 s22, s19, 13
  s_add_u32 s22, s22, 655360
  buffer_store_dwordx4 v[246:249], v250, s[4:7], s22 offen sc1
  buffer_store_dwordx4 v[246:249], v250, s[4:7], s22 offen offset:1024 sc1
  s_lshl_b32 s22, s19, 2
  v_mov_b32 v251, 1
  s_waitcnt vmcnt(0)
  s_mov_b64 exec, 1
  buffer_store_dword v251, off, s[12:15], s22 offset:128 sc1
  s_mov_b64 exec, -1
wk_conf_nl:
  v_mbcnt_lo_u32_b32 v1, -1, 0
  v_mbcnt_hi_u32_b32 v1, -1, v1
  v_lshlrev_b32 v1, 2, v1
  s_mov_b32 s24, 0
wk_census:
  buffer_load_dword v2, v1, s[12:15], 0 offen sc1
  s_add_u32 s24, s24, 1
  s_cmp_gt_u32 s24, 4000000
  s_cbranch_scc1 k_exit
  s_waitcnt vmcnt(0)
  s_mov_b32 s23, 0
  v_readlane_b32 s25, v2, 0
  v_readlane_b32 s26, v2, 40
  s_nop 3
  s_bcnt1_i32_b32 s25, s25
  s_add_u32 s23, s23, s26
  s_add_u32 s23, s23, s25
  v_readlane_b32 s25, v2, 1
  v_readlane_b32 s26, v2, 41
  s_nop 3
  s_bcnt1_i32_b32 s25, s25
  s_add_u32 s23, s23, s26
  s_add_u32 s23, s23, s25
  v_readlane_b32 s25, v2, 2
  v_readlane_b32 s26, v2, 42
  s_nop 3
  s_bcnt1_i32_b32 s25, s25
  s_add_u32 s23, s23, s26
  s_add_u32 s23, s23, s25
  v_readlane_b32 s25, v2, 3
  v_readlane_b32 s26, v2, 43
  s_nop 3
  s_bcnt1_i32_b32 s25, s25
  s_add_u32 s23, s23, s26
  s_add_u32 s23, s23, s25
  v_readlane_b32 s25, v2, 4
  v_readlane_b32 s26, v2, 44
  s_nop 3
  s_bcnt1_i32_b32 s25, s25
  s_add_u32 s23, s23, s26
  s_add_u32 s23, s23, s25
  v_readlane_b32 s25, v2, 5
  v_readlane_b32 s26, v2, 45
  s_nop 3
  s_bcnt1_i32_b32 s25, s25
  s_add_u32 s23, s23, s26
  s_add_u32 s23, s23, s25
  v_readlane_b32 s25, v2, 6
  v_readlane_b32 s26, v2, 46
  s_nop 3
  s_bcnt1_i32_b32 s25, s25
  s_add_u32 s23, s23, s26
  s_add_u32 s23, s23, s25
  v_readlane_b32 s25, v2, 7
  v_readlane_b32 s26, v2, 47
  s_nop 3
  s_bcnt1_i32_b32 s25, s25
  s_add_u32 s23, s23, s26
  s_add_u32 s23, s23, s25
  v_readlane_b32 s25, v2, 49
  s_nop 3
  s_add_u32 s23, s23, s25
  s_cmp_lt_u32 s23, 256
  s_cbranch_scc1 wk_census
  v_cmp_ne_u32 vcc, 0, v2
  s_nop 3
  s_and_b32 s23, vcc_hi, 0xff
  s_cmp_lg_u32 s23, 0xff
  s_cbranch_scc1 wk_census
  s_add_u32 s27, s19, 40
  v_readlane_b32 s23, v2, s19
  v_readlane_b32 s22, v2, s27
  s_nop 3
  s_bcnt1_i32_b32 s23, s23
  s_add_u32 s23, s23, s22
  s_cmp_ge_u32 s23, 32
  s_cselect_b32 s81, 1, 0
  v_lshlrev_b32 v1, 2, v112
  s_lshl_b32 s21, s19, 13
  s_mul_i32 s22, s17, 64
  s_add_u32 s21, s21, s22
  s_add_u32 s21, s21, 655360
  s_cmp_lg_u32 s18, 0
  s_cbranch_scc1 modskip_11
  s_mov_b64 exec, 0xffff
  s_cmp_eq_u32 s81, 0
  s_cbranch_scc1 gs_12_s
  buffer_store_dword v4, v1, s[4:7], s21 offen
  s_branch gs_12_e
gs_12_s:
  buffer_store_dword v4, v1, s[4:7], s21 offen sc1
gs_12_e:
  s_mov_b64 exec, -1
modskip_11:
  s_lshl_b32 s34, s19, 13
  s_add_u32 s34, s34, 655360
  s_mov_b32 s33, 0
wk_pm_13:
  buffer_load_dwordx4 v[4:7], v113, s[4:7], s34 offen sc1
  buffer_load_dwordx4 v[8:11], v113, s[4:7], s34 offen offset:1024 sc1
  s_add_u32 s33, s33, 1
  s_cmp_gt_u32 s33, 4000000
  s_cbranch_scc1 wk_bail
  s_waitcnt vmcnt(0)
  v_max_u32 v2, v4, v5
  v_max3_u32 v2, v2, v6, v7
  v_max3_u32 v2, v2, v8, v9
  v_max3_u32 v2, v2, v10, v11
  v_cmp_eq_u32 vcc, -1, v2
  s_cbranch_vccnz wk_pm_13
  v_lshlrev_b32 v16, 16, v4
  v_and_b32 v17, 0xffff0000, v4
  v_lshlrev_b32 v18, 16, v5
  v_and_b32 v19, 0xffff0000, v5
  v_lshlrev_b32 v20, 16, v6
  v_and_b32 v21, 0xffff0000, v6
  v_lshlrev_b32 v22, 16, v7
  v_and_b32 v23, 0xffff0000, v7
  v_lshlrev_b32 v24, 16, v8
  v_and_b32 v25, 0xffff0000, v8
  v_lshlrev_b32 v26, 16, v9
  v_and_b32 v27, 0xffff0000, v9
  v_lshlrev_b32 v28, 16, v10
  v_and_b32 v29, 0xffff0000, v10
  v_lshlrev_b32 v30, 16, v11
  v_and_b32 v31, 0xffff0000, v11
  v_add_f32 v24, 1.0, v24
  v_add_f32 v25, 1.0, v25
  v_add_f32 v26, 1.0, v26
  v_add_f32 v27, 1.0, v27
  v_add_f32 v28, 1.0, v28
  v_add_f32 v29, 1.0, v29
  v_add_f32 v30, 1.0, v30
  v_add_f32 v31, 1.0, v31
  v_cvt_pk_bf16_f32 v12, v24, v25
  v_lshlrev_b32 v24, 16, v12
  v_and_b32 v25, 0xffff0000, v12
  v_cvt_pk_bf16_f32 v12, v26, v27
  v_lshlrev_b32 v26, 16, v12
  v_and_b32 v27, 0xffff0000, v12
  v_cvt_pk_bf16_f32 v12, v28, v29
  v_lshlrev_b32 v28, 16, v12
  v_and_b32 v29, 0xffff0000, v12
  v_cvt_pk_bf16_f32 v12, v30, v31
  v_lshlrev_b32 v30, 16, v12
  v_and_b32 v31, 0xffff0000, v12
  v_lshlrev_b32 v32, 16, v100
  v_lshlrev_b32 v52, 16, v104
  v_lshlrev_b32 v72, 16, v108
  v_and_b32 v33, 0xffff0000, v100
  v_and_b32 v53, 0xffff0000, v104
  v_and_b32 v73, 0xffff0000, v108
  v_lshlrev_b32 v34, 16, v101
  v_lshlrev_b32 v54, 16, v105
  v_lshlrev_b32 v74, 16, v109
  v_and_b32 v35, 0xffff0000, v101
  v_and_b32 v55, 0xffff0000, v105
  v_and_b32 v75, 0xffff0000, v109
  v_lshlrev_b32 v36, 16, v102
  v_lshlrev_b32 v56, 16, v106
  v_lshlrev_b32 v76, 16, v110
  v_and_b32 v37, 0xffff0000, v102
  v_and_b32 v57, 0xffff0000, v106
  v_and_b32 v77, 0xffff0000, v110
  v_lshlrev_b32 v38, 16, v103
  v_lshlrev_b32 v58, 16, v107
  v_lshlrev_b32 v78, 16, v111
  v_and_b32 v39, 0xffff0000, v103
  v_and_b32 v59, 0xffff0000, v107
  v_and_b32 v79, 0xffff0000, v111
  v_add_f32 v48, v32, v33
  v_add_f32 v68, v52, v53
  v_add_f32 v88, v72, v73
  v_add_f32 v48, v48, v34
  v_add_f32 v68, v68, v54
  v_add_f32 v88, v88, v74
  v_add_f32 v48, v48, v35
  v_add_f32 v68, v68, v55
  v_add_f32 v88, v88, v75
  v_add_f32 v48, v48, v36
  v_add_f32 v68, v68, v56
  v_add_f32 v88, v88, v76
  v_add_f32 v48, v48, v37
  v_add_f32 v68, v68, v57
  v_add_f32 v88, v88, v77
  v_add_f32 v48, v48, v38
  v_add_f32 v68, v68, v58
  v_add_f32 v88, v88, v78
  v_add_f32 v48, v48, v39
  v_add_f32 v68, v68, v59
  v_add_f32 v88, v88, v79
  v_add_f32_dpp v48, v48, v48 quad_perm:[1,0,3,2] row_mask:0xf bank_mask:0xf
  v_add_f32_dpp v68, v68, v68 quad_perm:[1,0,3,2] row_mask:0xf bank_mask:0xf
  v_add_f32_dpp v88, v88, v88 quad_perm:[1,0,3,2] row_mask:0xf bank_mask:0xf
  v_add_f32_dpp v48, v48, v48 quad_perm:[2,3,0,1] row_mask:0xf bank_mask:0xf
  v_add_f32_dpp v68, v68, v68 quad_perm:[2,3,0,1] row_mask:0xf bank_mask:0xf
  v_add_f32_dpp v88, v88, v88 quad_perm:[2,3,0,1] row_mask:0xf bank_mask:0xf
  v_add_f32_dpp v48, v48, v48 row_ror:4 row_mask:0xf bank_mask:0xf
  v_add_f32_dpp v68, v68, v68 row_ror:4 row_mask:0xf bank_mask:0xf
  v_add_f32_dpp v88, v88, v88 row_ror:4 row_mask:0xf bank_mask:0xf
  v_add_f32_dpp v48, v48, v48 row_ror:8 row_mask:0xf bank_mask:0xf
  v_add_f32_dpp v68, v68, v68 row_ror:8 row_mask:0xf bank_mask:0xf
  v_add_f32_dpp v88, v88, v88 row_ror:8 row_mask:0xf bank_mask:0xf
  v_mov_b32 v49, v48
  v_mov_b32 v69, v68
  v_mov_b32 v89, v88
  v_permlane16_swap_b32 v48, v49
  v_permlane16_swap_b32 v68, v69
  v_permlane16_swap_b32 v88, v89
  v_add_f32 v48, v48, v49
  v_add_f32 v68, v68, v69
  v_add_f32 v88, v88, v89
  v_mov_b32 v49, v48
  v_mov_b32 v69, v68
  v_mov_b32 v89, v88
  v_permlane32_swap_b32 v48, v49
  v_permlane32_swap_b32 v68, v69
  v_permlane32_swap_b32 v88, v89
  v_add_f32 v48, v48, v49
  v_add_f32 v68, v68, v69
  v_add_f32 v88, v88, v89
  v_mul_f32 v48, 0x3b000000, v48
  v_mul_f32 v68, 0x3b000000, v68
  v_mul_f32 v88, 0x3b000000, v88
  v_sub_f32 v40, v32, v48
  v_sub_f32 v60, v52, v68
  v_sub_f32 v80, v72, v88
  v_sub_f32 v41, v33, v48
  v_sub_f32 v61, v53, v68
  v_sub_f32 v81, v73, v88
  v_sub_f32 v42, v34, v48
  v_sub_f32 v62, v54, v68
  v_sub_f32 v82, v74, v88
  v_sub_f32 v43, v35, v48
  v_sub_f32 v63, v55, v68
  v_sub_f32 v83, v75, v88
  v_sub_f32 v44, v36, v48
  v_sub_f32 v64, v56, v68
  v_sub_f32 v84, v76, v88
  v_sub_f32 v45, v37, v48
  v_sub_f32 v65, v57, v68
  v_sub_f32 v85, v77, v88
  v_sub_f32 v46, v38, v48
  v_sub_f32 v66, v58, v68
  v_sub_f32 v86, v78, v88
  v_sub_f32 v47, v39, v48
  v_sub_f32 v67, v59, v68
  v_sub_f32 v87, v79, v88
  v_mul_f32 v50, v40, v40
  v_mul_f32 v70, v60, v60
  v_mul_f32 v90, v80, v80
  v_fmac_f32 v50, v41, v41
  v_fmac_f32 v70, v61, v61
  v_fmac_f32 v90, v81, v81
  v_fmac_f32 v50, v42, v42
  v_fmac_f32 v70, v62, v62
  v_fmac_f32 v90, v82, v82
  v_fmac_f32 v50, v43, v43
  v_fmac_f32 v70, v63, v63
  v_fmac_f32 v90, v83, v83
  v_fmac_f32 v50, v44, v44
  v_fmac_f32 v70, v64, v64
  v_fmac_f32 v90, v84, v84
  v_fmac_f32 v50, v45, v45
  v_fmac_f32 v70, v65, v65
  v_fmac_f32 v90, v85, v85
  v_fmac_f32 v50, v46, v46
  v_fmac_f32 v70, v66, v66
  v_fmac_f32 v90, v86, v86
  v_fmac_f32 v50, v47, v47
  v_fmac_f32 v70, v67, v67
  v_fmac_f32 v90, v87, v87
  v_add_f32_dpp v50, v50, v50 quad_perm:[1,0,3,2] row_mask:0xf bank_mask:0xf
  v_add_f32_dpp v70, v70, v70 quad_perm:[1,0,3,2] row_mask:0xf bank_mask:0xf
  v_add_f32_dpp v90, v90, v90 quad_perm:[1,0,3,2] row_mask:0xf bank_mask:0xf
  v_add_f32_dpp v50, v50, v50 quad_perm:[2,3,0,1] row_mask:0xf bank_mask:0xf
  v_add_f32_dpp v70, v70, v70 quad_perm:[2,3,0,1] row_mask:0xf bank_mask:0xf
  v_add_f32_dpp v90, v90, v90 quad_perm:[2,3,0,1] row_mask:0xf bank_mask:0xf
  v_add_f32_dpp v50, v50, v50 row_ror:4 row_mask:0xf bank_mask:0xf
  v_add_f32_dpp v70, v70, v70 row_ror:4 row_mask:0xf bank_mask:0xf
  v_add_f32_dpp v90, v90, v90 row_ror:4 row_mask:0xf bank_mask:0xf
  v_add_f32_dpp v50, v50, v50 row_ror:8 row_mask:0xf bank_mask:0xf
  v_add_f32_dpp v70, v70, v70 row_ror:8 row_mask:0xf bank_mask:0xf
  v_add_f32_dpp v90, v90, v90 row_ror:8 row_mask:0xf bank_mask:0xf
  v_mov_b32 v49, v50
  v_mov_b32 v69, v70
  v_mov_b32 v89, v90
  v_permlane16_swap_b32 v50, v49
  v_permlane16_swap_b32 v70, v69
  v_permlane16_swap_b32 v90, v89
  v_add_f32 v50, v50, v49
  v_add_f32 v70, v70, v69
  v_add_f32 v90, v90, v89
  v_mov_b32 v49, v50
  v_mov_b32 v69, v70
  v_mov_b32 v89, v90
  v_permlane32_swap_b32 v50, v49
  v_permlane32_swap_b32 v70, v69
  v_permlane32_swap_b32 v90, v89
  v_add_f32 v50, v50, v49
  v_add_f32 v70, v70, v69
  v_add_f32 v90, v90, v89
  v_mul_f32 v50, 0x3b000000, v50
  v_mul_f32 v70, 0x3b000000, v70
  v_mul_f32 v90, 0x3b000000, v90
  v_cvt_pk_bf16_f32 v50, v50, v50
  v_cvt_pk_bf16_f32 v70, v70, v70
  v_cvt_pk_bf16_f32 v90, v90, v90
  v_lshlrev_b32 v50, 16, v50
  v_lshlrev_b32 v70, 16, v70
  v_lshlrev_b32 v90, 16, v90
  v_add_f32 v50, 0x3727c5ac, v50
  v_add_f32 v70, 0x3727c5ac, v70
  v_add_f32 v90, 0x3727c5ac, v90
  v_cvt_pk_bf16_f32 v50, v50, v50
  v_cvt_pk_bf16_f32 v70, v70, v70
  v_cvt_pk_bf16_f32 v90, v90, v90
  v_lshlrev_b32 v50, 16, v50
  v_lshlrev_b32 v70, 16, v70
  v_lshlrev_b32 v90, 16, v90
  v_sqrt_f32 v50, v50
  v_sqrt_f32 v70, v70
  v_sqrt_f32 v90, v90
  v_cvt_pk_bf16_f32 v48, v48, v48
  v_cvt_pk_bf16_f32 v68, v68, v68
  v_cvt_pk_bf16_f32 v88, v88, v88
  v_lshlrev_b32 v48, 16, v48
  v_lshlrev_b32 v68, 16, v68
  v_lshlrev_b32 v88, 16, v88
  v_cvt_pk_bf16_f32 v50, v50, v50
  v_cvt_pk_bf16_f32 v70, v70, v70
  v_cvt_pk_bf16_f32 v90, v90, v90
  v_lshlrev_b32 v50, 16, v50
  v_lshlrev_b32 v70, 16, v70
  v_lshlrev_b32 v90, 16, v90
  v_rcp_f32 v50, v50
  v_rcp_f32 v70, v70
  v_rcp_f32 v90, v90
  v_sub_f32 v40, v32, v48
  v_sub_f32 v60, v52, v68
  v_sub_f32 v80, v72, v88
  v_sub_f32 v41, v33, v48
  v_sub_f32 v61, v53, v68
  v_sub_f32 v81, v73, v88
  v_sub_f32 v42, v34, v48
  v_sub_f32 v62, v54, v68
  v_sub_f32 v82, v74, v88
  v_sub_f32 v43, v35, v48
  v_sub_f32 v63, v55, v68
  v_sub_f32 v83, v75, v88
  v_sub_f32 v44, v36, v48
  v_sub_f32 v64, v56, v68
  v_sub_f32 v84, v76, v88
  v_sub_f32 v45, v37, v48
  v_sub_f32 v65, v57, v68
  v_sub_f32 v85, v77, v88
  v_sub_f32 v46, v38, v48
  v_sub_f32 v66, v58, v68
  v_sub_f32 v86, v78, v88
  v_sub_f32 v47, v39, v48
  v_sub_f32 v67, v59, v68
  v_sub_f32 v87, v79, v88
  v_cvt_pk_bf16_f32 v49, v40, v41
  v_cvt_pk_bf16_f32 v69, v60, v61
  v_cvt_pk_bf16_f32 v89, v80, v81
  v_lshlrev_b32 v40, 16, v49
  v_lshlrev_b32 v60, 16, v69
  v_lshlrev_b32 v80, 16, v89
  v_and_b32 v41, 0xffff0000, v49
  v_and_b32 v61, 0xffff0000, v69
  v_and_b32 v81, 0xffff0000, v89
  v_cvt_pk_bf16_f32 v49, v42, v43
  v_cvt_pk_bf16_f32 v69, v62, v63
  v_cvt_pk_bf16_f32 v89, v82, v83
  v_lshlrev_b32 v42, 16, v49
  v_lshlrev_b32 v62, 16, v69
  v_lshlrev_b32 v82, 16, v89
  v_and_b32 v43, 0xffff0000, v49
  v_and_b32 v63, 0xffff0000, v69
  v_and_b32 v83, 0xffff0000, v89
  v_cvt_pk_bf16_f32 v49, v44, v45
  v_cvt_pk_bf16_f32 v69, v64, v65
  v_cvt_pk_bf16_f32 v89, v84, v85
  v_lshlrev_b32 v44, 16, v49
  v_lshlrev_b32 v64, 16, v69
  v_lshlrev_b32 v84, 16, v89
  v_and_b32 v45, 0xffff0000, v49
  v_and_b32 v65, 0xffff0000, v69
  v_and_b32 v85, 0xffff0000, v89
  v_cvt_pk_bf16_f32 v49, v46, v47
  v_cvt_pk_bf16_f32 v69, v66, v67
  v_cvt_pk_bf16_f32 v89, v86, v87
  v_lshlrev_b32 v46, 16, v49
  v_lshlrev_b32 v66, 16, v69
  v_lshlrev_b32 v86, 16, v89
  v_and_b32 v47, 0xffff0000, v49
  v_and_b32 v67, 0xffff0000, v69
  v_and_b32 v87, 0xffff0000, v89
  v_mul_f32 v40, v40, v50
  v_mul_f32 v60, v60, v70
  v_mul_f32 v80, v80, v90
  v_mul_f32 v41, v41, v50
  v_mul_f32 v61, v61, v70
  v_mul_f32 v81, v81, v90
  v_mul_f32 v42, v42, v50
  v_mul_f32 v62, v62, v70
  v_mul_f32 v82, v82, v90
  v_mul_f32 v43, v43, v50
  v_mul_f32 v63, v63, v70
  v_mul_f32 v83, v83, v90
  v_mul_f32 v44, v44, v50
  v_mul_f32 v64, v64, v70
  v_mul_f32 v84, v84, v90
  v_mul_f32 v45, v45, v50
  v_mul_f32 v65, v65, v70
  v_mul_f32 v85, v85, v90
  v_mul_f32 v46, v46, v50
  v_mul_f32 v66, v66, v70
  v_mul_f32 v86, v86, v90
  v_mul_f32 v47, v47, v50
  v_mul_f32 v67, v67, v70
  v_mul_f32 v87, v87, v90
  v_cvt_pk_bf16_f32 v49, v40, v41
  v_cvt_pk_bf16_f32 v69, v60, v61
  v_cvt_pk_bf16_f32 v89, v80, v81
  v_lshlrev_b32 v40, 16, v49
  v_lshlrev_b32 v60, 16, v69
  v_lshlrev_b32 v80, 16, v89
  v_and_b32 v41, 0xffff0000, v49
  v_and_b32 v61, 0xffff0000, v69
  v_and_b32 v81, 0xffff0000, v89
  v_cvt_pk_bf16_f32 v49, v42, v43
  v_cvt_pk_bf16_f32 v69, v62, v63
  v_cvt_pk_bf16_f32 v89, v82, v83
  v_lshlrev_b32 v42, 16, v49
  v_lshlrev_b32 v62, 16, v69
  v_lshlrev_b32 v82, 16, v89
  v_and_b32 v43, 0xffff0000, v49
  v_and_b32 v63, 0xffff0000, v69
  v_and_b32 v83, 0xffff0000, v89
  v_cvt_pk_bf16_f32 v49, v44, v45
  v_cvt_pk_bf16_f32 v69, v64, v65
  v_cvt_pk_bf16_f32 v89, v84, v85
  v_lshlrev_b32 v44, 16, v49
  v_lshlrev_b32 v64, 16, v69
  v_lshlrev_b32 v84, 16, v89
  v_and_b32 v45, 0xffff0000, v49
  v_and_b32 v65, 0xffff0000, v69
  v_and_b32 v85, 0xffff0000, v89
  v_cvt_pk_bf16_f32 v49, v46, v47
  v_cvt_pk_bf16_f32 v69, v66, v67
  v_cvt_pk_bf16_f32 v89, v86, v87
  v_lshlrev_b32 v46, 16, v49
  v_lshlrev_b32 v66, 16, v69
  v_lshlrev_b32 v86, 16, v89
  v_and_b32 v47, 0xffff0000, v49
  v_and_b32 v67, 0xffff0000, v69
  v_and_b32 v87, 0xffff0000, v89
  v_mul_f32 v40, v40, v24
  v_mul_f32 v60, v60, v24
  v_mul_f32 v80, v80, v24
  v_mul_f32 v41, v41, v25
  v_mul_f32 v61, v61, v25
  v_mul_f32 v81, v81, v25
  v_mul_f32 v42, v42, v26
  v_mul_f32 v62, v62, v26
  v_mul_f32 v82, v82, v26
  v_mul_f32 v43, v43, v27
  v_mul_f32 v63, v63, v27
  v_mul_f32 v83, v83, v27
  v_mul_f32 v44, v44, v28
  v_mul_f32 v64, v64, v28
  v_mul_f32 v84, v84, v28
  v_mul_f32 v45, v45, v29
  v_mul_f32 v65, v65, v29
  v_mul_f32 v85, v85, v29
  v_mul_f32 v46, v46, v30
  v_mul_f32 v66, v66, v30
  v_mul_f32 v86, v86, v30
  v_mul_f32 v47, v47, v31
  v_mul_f32 v67, v67, v31
  v_mul_f32 v87, v87, v31
  v_cvt_pk_bf16_f32 v49, v40, v41
  v_cvt_pk_bf16_f32 v69, v60, v61
  v_cvt_pk_bf16_f32 v89, v80, v81
  v_lshlrev_b32 v40, 16, v49
  v_lshlrev_b32 v60, 16, v69
  v_lshlrev_b32 v80, 16, v89
  v_and_b32 v41, 0xffff0000, v49
  v_and_b32 v61, 0xffff0000, v69
  v_and_b32 v81, 0xffff0000, v89
  v_cvt_pk_bf16_f32 v49, v42, v43
  v_cvt_pk_bf16_f32 v69, v62, v63
  v_cvt_pk_bf16_f32 v89, v82, v83
  v_lshlrev_b32 v42, 16, v49
  v_lshlrev_b32 v62, 16, v69
  v_lshlrev_b32 v82, 16, v89
  v_and_b32 v43, 0xffff0000, v49
  v_and_b32 v63, 0xffff0000, v69
  v_and_b32 v83, 0xffff0000, v89
  v_cvt_pk_bf16_f32 v49, v44, v45
  v_cvt_pk_bf16_f32 v69, v64, v65
  v_cvt_pk_bf16_f32 v89, v84, v85
  v_lshlrev_b32 v44, 16, v49
  v_lshlrev_b32 v64, 16, v69
  v_lshlrev_b32 v84, 16, v89
  v_and_b32 v45, 0xffff0000, v49
  v_and_b32 v65, 0xffff0000, v69
  v_and_b32 v85, 0xffff0000, v89
  v_cvt_pk_bf16_f32 v49, v46, v47
  v_cvt_pk_bf16_f32 v69, v66, v67
  v_cvt_pk_bf16_f32 v89, v86, v87
  v_lshlrev_b32 v46, 16, v49
  v_lshlrev_b32 v66, 16, v69
  v_lshlrev_b32 v86, 16, v89
  v_and_b32 v47, 0xffff0000, v49
  v_and_b32 v67, 0xffff0000, v69
  v_and_b32 v87, 0xffff0000, v89
  v_add_f32 v40, v40, v16
  v_add_f32 v60, v60, v16
  v_add_f32 v80, v80, v16
  v_add_f32 v41, v41, v17
  v_add_f32 v61, v61, v17
  v_add_f32 v81, v81, v17
  v_add_f32 v42, v42, v18
  v_add_f32 v62, v62, v18
  v_add_f32 v82, v82, v18
  v_add_f32 v43, v43, v19
  v_add_f32 v63, v63, v19
  v_add_f32 v83, v83, v19
  v_add_f32 v44, v44, v20
  v_add_f32 v64, v64, v20
  v_add_f32 v84, v84, v20
  v_add_f32 v45, v45, v21
  v_add_f32 v65, v65, v21
  v_add_f32 v85, v85, v21
  v_add_f32 v46, v46, v22
  v_add_f32 v66, v66, v22
  v_add_f32 v86, v86, v22
  v_add_f32 v47, v47, v23
  v_add_f32 v67, v67, v23
  v_add_f32 v87, v87, v23
  v_cvt_pk_bf16_f32 v100, v40, v41
  v_cvt_pk_bf16_f32 v104, v60, v61
  v_cvt_pk_bf16_f32 v108, v80, v81
  v_cvt_pk_bf16_f32 v101, v42, v43
  v_cvt_pk_bf16_f32 v105, v62, v63
  v_cvt_pk_bf16_f32 v109, v82, v83
  v_cvt_pk_bf16_f32 v102, v44, v45
  v_cvt_pk_bf16_f32 v106, v64, v65
  v_cvt_pk_bf16_f32 v110, v84, v85
  v_cvt_pk_bf16_f32 v103, v46, v47
  v_cvt_pk_bf16_f32 v107, v66, v67
  v_cvt_pk_bf16_f32 v111, v86, v87
  s_cmp_ge_u32 s20, 64
  s_cbranch_scc1 ln1skip_14
  s_lshl_b32 s21, s20, 15
  s_add_u32 s21, s21, 1048576
  s_cmp_eq_u32 s81, 0
  s_cbranch_scc1 gs_15_s
  buffer_store_dwordx4 v[100:103], v125, s[4:7], s21 offen
  s_branch gs_15_e
gs_15_s:
  buffer_store_dwordx4 v[100:103], v125, s[4:7], s21 offen sc1
gs_15_e:
ln1skip_14:
  s_add_u32 s20, s20, 28
  s_cmp_ge_u32 s20, 64
  s_cbranch_scc1 ln1skip_16
  s_lshl_b32 s21, s20, 15
  s_add_u32 s21, s21, 1048576
  s_cmp_eq_u32 s81, 0
  s_cbranch_scc1 gs_17_s
  buffer_store_dwordx4 v[104:107], v125, s[4:7], s21 offen
  s_branch gs_17_e
gs_17_s:
  buffer_store_dwordx4 v[104:107], v125, s[4:7], s21 offen sc1
gs_17_e:
ln1skip_16:
  s_add_u32 s20, s20, 28
  s_cmp_ge_u32 s20, 64
  s_cbranch_scc1 ln1skip_18
  s_lshl_b32 s21, s20, 15
  s_add_u32 s21, s21, 1048576
  s_cmp_eq_u32 s81, 0
  s_cbranch_scc1 gs_19_s
  buffer_store_dwordx4 v[108:111], v125, s[4:7], s21 offen
  s_branch gs_19_e
gs_19_s:
  buffer_store_dwordx4 v[108:111], v125, s[4:7], s21 offen sc1
gs_19_e:
ln1skip_18:
  s_add_u32 s20, s20, 28
  ds_read_b64_tr_b16 a[0:1], v114 offset:0
  ds_read_b64_tr_b16 a[2:3], v114 offset:256
  ds_read_b64_tr_b16 a[4:5], v114 offset:1024
  ds_read_b64_tr_b16 a[6:7], v114 offset:1280
  ds_read_b64_tr_b16 a[8:9], v114 offset:2048
  ds_read_b64_tr_b16 a[10:11], v114 offset:2304
  s_waitcnt lgkmcnt(4)
  s_add_u32 m0, s32, 0
  s_mov_b32 s80, 2097152
  buffer_load_dwordx4 v126, s[28:31], s80 offen  lds
  ds_read_b64_tr_b16 a[12:13], v114 offset:3072
  ds_read_b64_tr_b16 a[14:15], v114 offset:3328
  s_waitcnt lgkmcnt(4)
  s_add_u32 m0, s32, 1024
  s_mov_b32 s80, 2228224
  buffer_load_dwordx4 v126, s[28:31], s80 offen  lds
  ds_read_b64_tr_b16 a[16:17], v114 offset:4096
  ds_read_b64_tr_b16 a[18:19], v114 offset:4352
  s_waitcnt lgkmcnt(4)
  s_add_u32 m0, s32, 2048
  s_mov_b32 s80, 2359296
  buffer_load_dwordx4 v126, s[28:31], s80 offen  lds
  ds_read_b64_tr_b16 a[20:21], v114 offset:5120
  ds_read_b64_tr_b16 a[22:23], v114 offset:5376
  s_waitcnt lgkmcnt(4)
  s_add_u32 m0, s32, 3072
  s_mov_b32 s80, 2490368
  buffer_load_dwordx4 v126, s[28:31], s80 offen  lds
  ds_read_b64_tr_b16 a[24:25], v114 offset:6144
  ds_read_b64_tr_b16 a[26:27], v114 offset:6400
  s_waitcnt lgkmcnt(4)
  s_add_u32 m0, s32, 4096
  s_mov_b32 s80, 2621440
  buffer_load_dwordx4 v126, s[28:31], s80 offen  lds
  ds_read_b64_tr_b16 a[28:29], v114 offset:7168
  ds_read_b64_tr_b16 a[30:31], v114 offset:7424
  s_waitcnt lgkmcnt(4)
  s_add_u32 m0, s32, 5120
  s_mov_b32 s80, 2752512
  buffer_load_dwordx4 v126, s[28:31], s80 offen  lds
  ds_read_b64_tr_b16 a[32:33], v114 offset:8192
  ds_read_b64_tr_b16 a[34:35], v114 offset:8448
  s_waitcnt lgkmcnt(4)
  s_add_u32 m0, s32, 6144
  s_mov_b32 s80, 2883584
  buffer_load_dwordx4 v126, s[28:31], s80 offen  lds
  ds_read_b64_tr_b16 a[36:37], v114 offset:9216
  ds_read_b64_tr_b16 a[38:39], v114 offset:9472
  s_waitcnt lgkmcnt(4)
  s_add_u32 m0, s32, 7168
  s_mov_b32 s80, 3014656
  buffer_load_dwordx4 v126, s[28:31], s80 offen  lds
  ds_read_b64_tr_b16 a[40:41], v114 offset:10240
  ds_read_b64_tr_b16 a[42:43], v114 offset:10496
  s_waitcnt lgkmcnt(4)
  s_add_u32 m0, s32, 8192
  s_mov_b32 s80, 3145728
  buffer_load_dwordx4 v126, s[28:31], s80 offen  lds
  ds_read_b64_tr_b16 a[44:45], v114 offset:11264
  ds_read_b64_tr_b16 a[46:47], v114 offset:11520
  s_waitcnt lgkmcnt(4)
  s_add_u32 m0, s32, 9216
  s_mov_b32 s80, 3276800
  buffer_load_dwordx4 v126, s[28:31], s80 offen  lds
  ds_read_b64_tr_b16 a[48:49], v114 offset:12288
  ds_read_b64_tr_b16 a[50:51], v114 offset:12544
  s_waitcnt lgkmcnt(4)
  s_add_u32 m0, s32, 10240
  s_mov_b32 s80, 3407872
  buffer_load_dwordx4 v126, s[28:31], s80 offen  lds
  ds_read_b64_tr_b16 a[52:53], v114 offset:13312
  ds_read_b64_tr_b16 a[54:55], v114 offset:13568
  s_waitcnt lgkmcnt(4)
  s_add_u32 m0, s32, 11264
  s_mov_b32 s80, 3538944
  buffer_load_dwordx4 v126, s[28:31], s80 offen  lds
  ds_read_b64_tr_b16 a[56:57], v114 offset:14336
  ds_read_b64_tr_b16 a[58:59], v114 offset:14592
  s_waitcnt lgkmcnt(4)
  s_add_u32 m0, s32, 12288
  s_mov_b32 s80, 3670016
  buffer_load_dwordx4 v126, s[28:31], s80 offen  lds
  ds_read_b64_tr_b16 a[60:61], v114 offset:15360
  ds_read_b64_tr_b16 a[62:63], v114 offset:15616
  s_waitcnt lgkmcnt(4)
  s_add_u32 m0, s32, 13312
  s_mov_b32 s80, 3801088
  buffer_load_dwordx4 v126, s[28:31], s80 offen  lds
  s_waitcnt lgkmcnt(0)
  s_add_u32 m0, s32, 14336
  s_mov_b32 s80, 3932160
  buffer_load_dwordx4 v126, s[28:31], s80 offen  lds
  s_add_u32 m0, s32, 15360
  s_mov_b32 s80, 4063232
  buffer_load_dwordx4 v126, s[28:31], s80 offen  lds
  s_waitcnt vmcnt(16)
  s_barrier
  s_cmp_lg_u32 s18, 0
  s_cbranch_scc1 gf_20
  s_lshl_b32 s22, s19, 10
  s_lshl_b32 s23, s17, 2
  s_add_u32 s22, s22, s23
  s_add_u32 s22, s22, 49408
  v_mov_b32 v0, 1
  s_mov_b64 exec, 1
  buffer_store_dword v0, off, s[4:7], s22 sc1
  s_mov_b64 exec, -1
gf_20:
  s_waitcnt vmcnt(15)
  ds_read_b64_tr_b16 a[64:65], v114 offset:0
  ds_read_b64_tr_b16 a[66:67], v114 offset:256
  s_waitcnt vmcnt(14)
  ds_read_b64_tr_b16 a[68:69], v114 offset:1024
  ds_read_b64_tr_b16 a[70:71], v114 offset:1280
  s_waitcnt vmcnt(13)
  ds_read_b64_tr_b16 a[72:73], v114 offset:2048
  ds_read_b64_tr_b16 a[74:75], v114 offset:2304
  s_waitcnt lgkmcnt(4)
  s_load_dwordx2 s[28:29], s[0:1], 32
  s_mov_b32 s30, 0x400000
  s_mov_b32 s31, 0x00020000
  s_waitcnt lgkmcnt(0)
  s_add_u32 m0, s32, 0
  s_mov_b32 s80, 0
  buffer_load_dwordx4 v126, s[28:31], s80 offen  lds
  s_waitcnt vmcnt(13)
  ds_read_b64_tr_b16 a[76:77], v114 offset:3072
  ds_read_b64_tr_b16 a[78:79], v114 offset:3328
  s_add_u32 m0, s32, 1024
  s_mov_b32 s80, 131072
  buffer_load_dwordx4 v126, s[28:31], s80 offen  lds
  s_waitcnt vmcnt(13)
  ds_read_b64_tr_b16 a[80:81], v114 offset:4096
  ds_read_b64_tr_b16 a[82:83], v114 offset:4352
  s_add_u32 m0, s32, 2048
  s_mov_b32 s80, 262144
  buffer_load_dwordx4 v126, s[28:31], s80 offen  lds
  s_waitcnt vmcnt(13)
  ds_read_b64_tr_b16 a[84:85], v114 offset:5120
  ds_read_b64_tr_b16 a[86:87], v114 offset:5376
  s_waitcnt lgkmcnt(4)
  s_add_u32 m0, s32, 3072
  s_mov_b32 s80, 393216
  buffer_load_dwordx4 v126, s[28:31], s80 offen  lds
  s_waitcnt vmcnt(13)
  ds_read_b64_tr_b16 a[88:89], v114 offset:6144
  ds_read_b64_tr_b16 a[90:91], v114 offset:6400
  s_waitcnt lgkmcnt(4)
  s_add_u32 m0, s32, 4096
  s_mov_b32 s80, 524288
  buffer_load_dwordx4 v126, s[28:31], s80 offen  lds
  s_waitcnt vmcnt(13)
  ds_read_b64_tr_b16 a[92:93], v114 offset:7168
  ds_read_b64_tr_b16 a[94:95], v114 offset:7424
  s_waitcnt lgkmcnt(4)
  s_add_u32 m0, s32, 5120
  s_mov_b32 s80, 655360
  buffer_load_dwordx4 v126, s[28:31], s80 offen  lds
  s_waitcnt vmcnt(13)
  ds_read_b64_tr_b16 a[96:97], v114 offset:8192
  ds_read_b64_tr_b16 a[98:99], v114 offset:8448
  s_waitcnt lgkmcnt(4)
  s_add_u32 m0, s32, 6144
  s_mov_b32 s80, 786432
  buffer_load_dwordx4 v126, s[28:31], s80 offen  lds
  s_waitcnt vmcnt(13)
  ds_read_b64_tr_b16 a[100:101], v114 offset:9216
  ds_read_b64_tr_b16 a[102:103], v114 offset:9472
  s_waitcnt lgkmcnt(4)
  s_add_u32 m0, s32, 7168
  s_mov_b32 s80, 917504
  buffer_load_dwordx4 v126, s[28:31], s80 offen  lds
  s_waitcnt vmcnt(13)
  ds_read_b64_tr_b16 a[104:105], v114 offset:10240
  ds_read_b64_tr_b16 a[106:107], v114 offset:10496
  s_waitcnt lgkmcnt(4)
  s_add_u32 m0, s32, 8192
  s_mov_b32 s80, 1048576
  buffer_load_dwordx4 v126, s[28:31], s80 offen  lds
  s_waitcnt vmcnt(13)
  ds_read_b64_tr_b16 a[108:109], v114 offset:11264
  ds_read_b64_tr_b16 a[110:111], v114 offset:11520
  s_waitcnt lgkmcnt(4)
  s_add_u32 m0, s32, 9216
  s_mov_b32 s80, 1179648
  buffer_load_dwordx4 v126, s[28:31], s80 offen  lds
  s_waitcnt vmcnt(13)
  ds_read_b64_tr_b16 a[112:113], v114 offset:12288
  ds_read_b64_tr_b16 a[114:115], v114 offset:12544
  s_waitcnt lgkmcnt(4)
  s_add_u32 m0, s32, 10240
  s_mov_b32 s80, 1310720
  buffer_load_dwordx4 v126, s[28:31], s80 offen  lds
  s_waitcnt vmcnt(13)
  ds_read_b64_tr_b16 a[116:117], v114 offset:13312
  ds_read_b64_tr_b16 a[118:119], v114 offset:13568
  s_waitcnt lgkmcnt(4)
  s_add_u32 m0, s32, 11264
  s_mov_b32 s80, 1441792
  buffer_load_dwordx4 v126, s[28:31], s80 offen  lds
  s_waitcnt vmcnt(13)
  ds_read_b64_tr_b16 a[120:121], v114 offset:14336
  ds_read_b64_tr_b16 a[122:123], v114 offset:14592
  s_waitcnt lgkmcnt(4)
  s_add_u32 m0, s32, 12288
  s_mov_b32 s80, 1572864
  buffer_load_dwordx4 v126, s[28:31], s80 offen  lds
  s_waitcnt vmcnt(13)
  ds_read_b64_tr_b16 a[124:125], v114 offset:15360
  ds_read_b64_tr_b16 a[126:127], v114 offset:15616
  s_waitcnt lgkmcnt(4)
  s_add_u32 m0, s32, 13312
  s_mov_b32 s80, 1703936
  buffer_load_dwordx4 v126, s[28:31], s80 offen  lds
  s_waitcnt vmcnt(13)
  ds_read_b64_tr_b16 a[128:129], v114 offset:0
  ds_read_b64_tr_b16 a[130:131], v114 offset:256
  s_waitcnt lgkmcnt(4)
  s_add_u32 m0, s32, 14336
  s_mov_b32 s80, 1835008
  buffer_load_dwordx4 v126, s[28:31], s80 offen  lds
  s_waitcnt vmcnt(13)
  ds_read_b64_tr_b16 a[132:133], v114 offset:1024
  ds_read_b64_tr_b16 a[134:135], v114 offset:1280
  s_waitcnt lgkmcnt(4)
  s_add_u32 m0, s32, 15360
  s_mov_b32 s80, 1966080
  buffer_load_dwordx4 v126, s[28:31], s80 offen  lds
  s_waitcnt vmcnt(13)
  ds_read_b64_tr_b16 a[136:137], v114 offset:2048
  ds_read_b64_tr_b16 a[138:139], v114 offset:2304
  s_waitcnt lgkmcnt(4)
  s_add_u32 m0, s32, 0
  s_mov_b32 s80, 2097152
  buffer_load_dwordx4 v126, s[28:31], s80 offen  lds
  s_waitcnt vmcnt(13)
  ds_read_b64_tr_b16 a[140:141], v114 offset:3072
  ds_read_b64_tr_b16 a[142:143], v114 offset:3328
  s_waitcnt lgkmcnt(4)
  s_add_u32 m0, s32, 1024
  s_mov_b32 s80, 2228224
  buffer_load_dwordx4 v126, s[28:31], s80 offen  lds
  s_waitcnt vmcnt(13)
  ds_read_b64_tr_b16 a[144:145], v114 offset:4096
  ds_read_b64_tr_b16 a[146:147], v114 offset:4352
  s_waitcnt lgkmcnt(4)
  s_add_u32 m0, s32, 2048
  s_mov_b32 s80, 2359296
  buffer_load_dwordx4 v126, s[28:31], s80 offen  lds
  s_waitcnt vmcnt(13)
  ds_read_b64_tr_b16 a[148:149], v114 offset:5120
  ds_read_b64_tr_b16 a[150:151], v114 offset:5376
  s_waitcnt lgkmcnt(4)
  s_add_u32 m0, s32, 3072
  s_mov_b32 s80, 2490368
  buffer_load_dwordx4 v126, s[28:31], s80 offen  lds
  s_waitcnt vmcnt(13)
  ds_read_b64_tr_b16 a[152:153], v114 offset:6144
  ds_read_b64_tr_b16 a[154:155], v114 offset:6400
  s_waitcnt lgkmcnt(4)
  s_add_u32 m0, s32, 4096
  s_mov_b32 s80, 2621440
  buffer_load_dwordx4 v126, s[28:31], s80 offen  lds
  s_waitcnt vmcnt(13)
  ds_read_b64_tr_b16 a[156:157], v114 offset:7168
  ds_read_b64_tr_b16 a[158:159], v114 offset:7424
  s_waitcnt lgkmcnt(4)
  s_add_u32 m0, s32, 5120
  s_mov_b32 s80, 2752512
  buffer_load_dwordx4 v126, s[28:31], s80 offen  lds
  s_waitcnt vmcnt(13)
  ds_read_b64_tr_b16 a[160:161], v114 offset:8192
  ds_read_b64_tr_b16 a[162:163], v114 offset:8448
  s_waitcnt lgkmcnt(4)
  s_add_u32 m0, s32, 6144
  s_mov_b32 s80, 2883584
  buffer_load_dwordx4 v126, s[28:31], s80 offen  lds
  s_waitcnt vmcnt(13)
  ds_read_b64_tr_b16 a[164:165], v114 offset:9216
  ds_read_b64_tr_b16 a[166:167], v114 offset:9472
  s_waitcnt lgkmcnt(4)
  s_add_u32 m0, s32, 7168
  s_mov_b32 s80, 3014656
  buffer_load_dwordx4 v126, s[28:31], s80 offen  lds
  s_waitcnt vmcnt(13)
  ds_read_b64_tr_b16 a[168:169], v114 offset:10240
  ds_read_b64_tr_b16 a[170:171], v114 offset:10496
  s_waitcnt lgkmcnt(4)
  s_add_u32 m0, s32, 8192
  s_mov_b32 s80, 3145728
  buffer_load_dwordx4 v126, s[28:31], s80 offen  lds
  s_waitcnt vmcnt(13)
  ds_read_b64_tr_b16 a[172:173], v114 offset:11264
  ds_read_b64_tr_b16 a[174:175], v114 offset:11520
  s_waitcnt lgkmcnt(4)
  s_add_u32 m0, s32, 9216
  s_mov_b32 s80, 3276800
  buffer_load_dwordx4 v126, s[28:31], s80 offen  lds
  s_waitcnt vmcnt(13)
  ds_read_b64_tr_b16 a[176:177], v114 offset:12288
  ds_read_b64_tr_b16 a[178:179], v114 offset:12544
  s_waitcnt lgkmcnt(4)
  s_add_u32 m0, s32, 10240
  s_mov_b32 s80, 3407872
  buffer_load_dwordx4 v126, s[28:31], s80 offen  lds
  s_waitcnt vmcnt(13)
  ds_read_b64_tr_b16 a[180:181], v114 offset:13312
  ds_read_b64_tr_b16 a[182:183], v114 offset:13568
  s_waitcnt lgkmcnt(4)
  s_add_u32 m0, s32, 11264
  s_mov_b32 s80, 3538944
  buffer_load_dwordx4 v126, s[28:31], s80 offen  lds
  s_waitcnt vmcnt(13)
  ds_read_b64_tr_b16 a[184:185], v114 offset:14336
  ds_read_b64_tr_b16 a[186:187], v114 offset:14592
  s_waitcnt lgkmcnt(4)
  s_add_u32 m0, s32, 12288
  s_mov_b32 s80, 3670016
  buffer_load_dwordx4 v126, s[28:31], s80 offen  lds
  s_waitcnt vmcnt(13)
  ds_read_b64_tr_b16 a[188:189], v114 offset:15360
  ds_read_b64_tr_b16 a[190:191], v114 offset:15616
  s_waitcnt lgkmcnt(4)
  s_add_u32 m0, s32, 13312
  s_mov_b32 s80, 3801088
  buffer_load_dwordx4 v126, s[28:31], s80 offen  lds
  s_waitcnt vmcnt(13)
  ds_read_b64_tr_b16 a[192:193], v114 offset:0
  ds_read_b64_tr_b16 a[194:195], v114 offset:256
  s_waitcnt lgkmcnt(4)
  s_add_u32 m0, s32, 14336
  s_mov_b32 s80, 3932160
  buffer_load_dwordx4 v126, s[28:31], s80 offen  lds
  s_waitcnt vmcnt(13)
  ds_read_b64_tr_b16 a[196:197], v114 offset:1024
  ds_read_b64_tr_b16 a[198:199], v114 offset:1280
  s_waitcnt lgkmcnt(4)
  s_add_u32 m0, s32, 15360
  s_mov_b32 s80, 4063232
  buffer_load_dwordx4 v126, s[28:31], s80 offen  lds
  s_waitcnt vmcnt(13)
  ds_read_b64_tr_b16 a[200:201], v114 offset:2048
  ds_read_b64_tr_b16 a[202:203], v114 offset:2304
  s_waitcnt lgkmcnt(4)
  s_waitcnt vmcnt(12)
  ds_read_b64_tr_b16 a[204:205], v114 offset:3072
  ds_read_b64_tr_b16 a[206:207], v114 offset:3328
  s_waitcnt lgkmcnt(4)
  s_waitcnt vmcnt(11)
  ds_read_b64_tr_b16 a[208:209], v114 offset:4096
  ds_read_b64_tr_b16 a[210:211], v114 offset:4352
  s_waitcnt lgkmcnt(4)
  s_waitcnt vmcnt(10)
  ds_read_b64_tr_b16 a[212:213], v114 offset:5120
  ds_read_b64_tr_b16 a[214:215], v114 offset:5376
  s_waitcnt lgkmcnt(4)
  s_waitcnt vmcnt(9)
  ds_read_b64_tr_b16 a[216:217], v114 offset:6144
  ds_read_b64_tr_b16 a[218:219], v114 offset:6400
  s_waitcnt lgkmcnt(4)
  s_waitcnt vmcnt(8)
  ds_read_b64_tr_b16 a[220:221], v114 offset:7168
  ds_read_b64_tr_b16 a[222:223], v114 offset:7424
  s_waitcnt lgkmcnt(4)
  s_waitcnt vmcnt(7)
  ds_read_b64_tr_b16 a[224:225], v114 offset:8192
  ds_read_b64_tr_b16 a[226:227], v114 offset:8448
  s_waitcnt lgkmcnt(4)
  s_waitcnt vmcnt(6)
  ds_read_b64_tr_b16 a[228:229], v114 offset:9216
  ds_read_b64_tr_b16 a[230:231], v114 offset:9472
  s_waitcnt lgkmcnt(4)
  s_waitcnt vmcnt(5)
  ds_read_b64_tr_b16 a[232:233], v114 offset:10240
  ds_read_b64_tr_b16 a[234:235], v114 offset:10496
  s_waitcnt lgkmcnt(4)
  s_waitcnt vmcnt(4)
  ds_read_b64_tr_b16 a[236:237], v114 offset:11264
  ds_read_b64_tr_b16 a[238:239], v114 offset:11520
  s_waitcnt lgkmcnt(4)
  s_waitcnt vmcnt(3)
  ds_read_b64_tr_b16 a[240:241], v114 offset:12288
  ds_read_b64_tr_b16 a[242:243], v114 offset:12544
  s_waitcnt lgkmcnt(4)
  s_waitcnt vmcnt(2)
  ds_read_b64_tr_b16 a[244:245], v114 offset:13312
  ds_read_b64_tr_b16 a[246:247], v114 offset:13568
  s_waitcnt lgkmcnt(4)
  s_waitcnt vmcnt(1)
  ds_read_b64_tr_b16 a[248:249], v114 offset:14336
  ds_read_b64_tr_b16 a[250:251], v114 offset:14592
  s_waitcnt lgkmcnt(4)
  s_waitcnt vmcnt(0)
  ds_read_b64_tr_b16 a[252:253], v114 offset:15360
  ds_read_b64_tr_b16 a[254:255], v114 offset:15616
  s_waitcnt lgkmcnt(4)
  s_waitcnt lgkmcnt(0)
  s_lshl_b32 s22, s19, 10
  s_add_u32 s22, s22, 49408
  v_mbcnt_lo_u32_b32 v1, -1, 0
  v_lshlrev_b32 v1, 2, v1
  v_and_b32 v1, 127, v1
  s_mov_b32 s24, 0
wg_21:
  buffer_load_dword v0, v1, s[4:7], s22 offen sc1
  s_add_u32 s24, s24, 1
  s_cmp_gt_u32 s24, 4000000
  s_cbranch_scc1 k_exit
  s_waitcnt vmcnt(0)
  v_cmp_eq_u32 vcc, 0, v0
  s_cbranch_vccnz wg_21
  s_mov_b32 s22, 49536
  v_mbcnt_lo_u32_b32 v1, -1, 0
  v_lshlrev_b32 v1, 2, v1
  v_and_b32 v1, 127, v1
  s_mov_b32 s24, 0
wg_22:
  buffer_load_dword v0, v1, s[4:7], s22 offen sc1
  s_add_u32 s24, s24, 1
  s_cmp_gt_u32 s24, 4000000
  s_cbranch_scc1 k_exit
  s_waitcnt vmcnt(0)
  v_cmp_eq_u32 vcc, 0, v0
  s_cbranch_vccnz wg_22
  s_lshl_b32 s77, s19, 10
  s_add_u32 s77, s77, 49152
  s_sub_u32 s20, s19, 1
  s_lshl_b32 s23, s20, 15
  s_add_u32 s23, s23, 1048576
  s_lshl_b32 s21, s18, 13
  s_add_u32 s22, s21, s23
  s_add_u32 m0, s21, 32768
  s_nop 0
  buffer_load_dwordx4 v113, s[4:7], s22 offen offset:0 sc1 lds
  buffer_load_dwordx4 v113, s[4:7], s22 offen offset:1024 sc1 lds
  buffer_load_dwordx4 v113, s[4:7], s22 offen offset:2048 sc1 lds
  buffer_load_dwordx4 v113, s[4:7], s22 offen offset:3072 sc1 lds
  s_add_u32 m0, s21, 36864
  s_add_u32 s22, s22, 4096
  buffer_load_dwordx4 v113, s[4:7], s22 offen offset:0 sc1 lds
  buffer_load_dwordx4 v113, s[4:7], s22 offen offset:1024 sc1 lds
  buffer_load_dwordx4 v113, s[4:7], s22 offen offset:2048 sc1 lds
  buffer_load_dwordx4 v113, s[4:7], s22 offen offset:3072 sc1 lds
  v_mov_b32 v127, v113
  v_bfe_u32 v0, v112, 4, 1
  v_lshlrev_b32 v0, 12, v0
  v_lshrrev_b32 v1, 5, v112
  v_lshl_add_u32 v0, v1, 8, v0
  v_and_b32 v1, 15, v112
  v_lshl_add_u32 v0, v1, 4, v0
  s_lshl_b32 s21, s18, 10
  v_add_u32 v126, s21, v0
  s_mov_b32 s35, 65536
  s_mov_b32 s76, 0
  s_waitcnt vmcnt(0)
  s_barrier
  s_add_u32 s24, s20, 7
  s_cmp_ge_u32 s24, 64
  s_cbranch_scc1 w1nopf_23
  s_lshl_b32 s23, s24, 15
  s_add_u32 s23, s23, 1048576
  s_lshl_b32 s21, s18, 13
  s_add_u32 s22, s21, s23
  s_add_u32 s21, s21, s35
  s_add_u32 m0, s21, 0
  s_add_u32 s80, s22, 0
  buffer_load_dwordx4 v113, s[4:7], s80 offen offset:0 sc1 lds
  buffer_load_dwordx4 v113, s[4:7], s80 offen offset:1024 sc1 lds
  buffer_load_dwordx4 v113, s[4:7], s80 offen offset:2048 sc1 lds
  buffer_load_dwordx4 v113, s[4:7], s80 offen offset:3072 sc1 lds
  s_add_u32 m0, s21, 4096
  s_add_u32 s80, s22, 4096
  buffer_load_dwordx4 v113, s[4:7], s80 offen offset:0 sc1 lds
  buffer_load_dwordx4 v113, s[4:7], s80 offen offset:1024 sc1 lds
  buffer_load_dwordx4 v113, s[4:7], s80 offen offset:2048 sc1 lds
  buffer_load_dwordx4 v113, s[4:7], s80 offen offset:3072 sc1 lds
w1nopf_23:
  ds_read_b128 v[32:35], v127 offset:32768
  ds_read_b128 v[36:39], v127 offset:33792
  ds_read_b128 v[40:43], v127 offset:34816
  ds_read_b128 v[44:47], v127 offset:35840
  ds_read_b128 v[48:51], v127 offset:36864
  ds_read_b128 v[52:55], v127 offset:37888
  ds_read_b128 v[56:59], v127 offset:38912
  ds_read_b128 v[60:63], v127 offset:39936
  s_waitcnt lgkmcnt(7)
  v_mfma_f32_32x32x16_bf16 v[0:15], a[0:3], v[32:35], 0
  v_mfma_f32_32x32x16_bf16 v[16:31], v[32:35], a[128:131], 0
  ds_read_b128 v[32:35], v127 offset:40960
  s_waitcnt lgkmcnt(7)
  v_mfma_f32_32x32x16_bf16 v[0:15], a[4:7], v[36:39], v[0:15]
  v_mfma_f32_32x32x16_bf16 v[16:31], v[36:39], a[132:135], v[16:31]
  ds_read_b128 v[36:39], v127 offset:41984
  s_waitcnt lgkmcnt(7)
  v_mfma_f32_32x32x16_bf16 v[0:15], a[8:11], v[40:43], v[0:15]
  v_mfma_f32_32x32x16_bf16 v[16:31], v[40:43], a[136:139], v[16:31]
  ds_read_b128 v[40:43], v127 offset:43008
  s_waitcnt lgkmcnt(7)
  v_mfma_f32_32x32x16_bf16 v[0:15], a[12:15], v[44:47], v[0:15]
  v_mfma_f32_32x32x16_bf16 v[16:31], v[44:47], a[140:143], v[16:31]
  ds_read_b128 v[44:47], v127 offset:44032
  s_waitcnt lgkmcnt(7)
  v_mfma_f32_32x32x16_bf16 v[0:15], a[16:19], v[48:51], v[0:15]
  v_mfma_f32_32x32x16_bf16 v[16:31], v[48:51], a[144:147], v[16:31]
  ds_read_b128 v[48:51], v127 offset:45056
  s_waitcnt lgkmcnt(7)
  v_mfma_f32_32x32x16_bf16 v[0:15], a[20:23], v[52:55], v[0:15]
  v_mfma_f32_32x32x16_bf16 v[16:31], v[52:55], a[148:151], v[16:31]
  ds_read_b128 v[52:55], v127 offset:46080
  s_waitcnt lgkmcnt(7)
  v_mfma_f32_32x32x16_bf16 v[0:15], a[24:27], v[56:59], v[0:15]
  v_mfma_f32_32x32x16_bf16 v[16:31], v[56:59], a[152:155], v[16:31]
  ds_read_b128 v[56:59], v127 offset:47104
  s_waitcnt lgkmcnt(7)
  v_mfma_f32_32x32x16_bf16 v[0:15], a[28:31], v[60:63], v[0:15]
  v_mfma_f32_32x32x16_bf16 v[16:31], v[60:63], a[156:159], v[16:31]
  ds_read_b128 v[60:63], v127 offset:48128
  s_waitcnt lgkmcnt(7)
  v_mfma_f32_32x32x16_bf16 v[0:15], a[32:35], v[32:35], v[0:15]
  v_mfma_f32_32x32x16_bf16 v[16:31], v[32:35], a[160:163], v[16:31]
  ds_read_b128 v[32:35], v127 offset:49152
  s_waitcnt lgkmcnt(7)
  v_mfma_f32_32x32x16_bf16 v[0:15], a[36:39], v[36:39], v[0:15]
  v_mfma_f32_32x32x16_bf16 v[16:31], v[36:39], a[164:167], v[16:31]
  ds_read_b128 v[36:39], v127 offset:50176
  s_waitcnt lgkmcnt(7)
  v_mfma_f32_32x32x16_bf16 v[0:15], a[40:43], v[40:43], v[0:15]
  v_mfma_f32_32x32x16_bf16 v[16:31], v[40:43], a[168:171], v[16:31]
  ds_read_b128 v[40:43], v127 offset:51200
  s_waitcnt lgkmcnt(7)
  v_mfma_f32_32x32x16_bf16 v[0:15], a[44:47], v[44:47], v[0:15]
  v_mfma_f32_32x32x16_bf16 v[16:31], v[44:47], a[172:175], v[16:31]
  ds_read_b128 v[44:47], v127 offset:52224
  s_waitcnt lgkmcnt(7)
  v_mfma_f32_32x32x16_bf16 v[0:15], a[48:51], v[48:51], v[0:15]
  v_mfma_f32_32x32x16_bf16 v[16:31], v[48:51], a[176:179], v[16:31]
  ds_read_b128 v[48:51], v127 offset:53248
  s_waitcnt lgkmcnt(7)
  v_mfma_f32_32x32x16_bf16 v[0:15], a[52:55], v[52:55], v[0:15]
  v_mfma_f32_32x32x16_bf16 v[16:31], v[52:55], a[180:183], v[16:31]
  ds_read_b128 v[52:55], v127 offset:54272
  s_waitcnt lgkmcnt(7)
  v_mfma_f32_32x32x16_bf16 v[0:15], a[56:59], v[56:59], v[0:15]
  v_mfma_f32_32x32x16_bf16 v[16:31], v[56:59], a[184:187], v[16:31]
  ds_read_b128 v[56:59], v127 offset:55296
  s_waitcnt lgkmcnt(7)
  v_mfma_f32_32x32x16_bf16 v[0:15], a[60:63], v[60:63], v[0:15]
  v_mfma_f32_32x32x16_bf16 v[16:31], v[60:63], a[188:191], v[16:31]
  ds_read_b128 v[60:63], v127 offset:56320
  s_waitcnt lgkmcnt(7)
  v_mfma_f32_32x32x16_bf16 v[0:15], a[64:67], v[32:35], v[0:15]
  v_mfma_f32_32x32x16_bf16 v[16:31], v[32:35], a[192:195], v[16:31]
  ds_read_b128 v[32:35], v127 offset:57344
  s_waitcnt lgkmcnt(7)
  v_mfma_f32_32x32x16_bf16 v[0:15], a[68:71], v[36:39], v[0:15]
  v_mfma_f32_32x32x16_bf16 v[16:31], v[36:39], a[196:199], v[16:31]
  ds_read_b128 v[36:39], v127 offset:58368
  s_waitcnt lgkmcnt(7)
  v_mfma_f32_32x32x16_bf16 v[0:15], a[72:75], v[40:43], v[0:15]
  v_mfma_f32_32x32x16_bf16 v[16:31], v[40:43], a[200:203], v[16:31]
  ds_read_b128 v[40:43], v127 offset:59392
  s_waitcnt lgkmcnt(7)
  v_mfma_f32_32x32x16_bf16 v[0:15], a[76:79], v[44:47], v[0:15]
  v_mfma_f32_32x32x16_bf16 v[16:31], v[44:47], a[204:207], v[16:31]
  ds_read_b128 v[44:47], v127 offset:60416
  s_waitcnt lgkmcnt(7)
  v_mfma_f32_32x32x16_bf16 v[0:15], a[80:83], v[48:51], v[0:15]
  v_mfma_f32_32x32x16_bf16 v[16:31], v[48:51], a[208:211], v[16:31]
  ds_read_b128 v[48:51], v127 offset:61440
  s_waitcnt lgkmcnt(7)
  v_mfma_f32_32x32x16_bf16 v[0:15], a[84:87], v[52:55], v[0:15]
  v_mfma_f32_32x32x16_bf16 v[16:31], v[52:55], a[212:215], v[16:31]
  ds_read_b128 v[52:55], v127 offset:62464
  s_waitcnt lgkmcnt(7)
  v_mfma_f32_32x32x16_bf16 v[0:15], a[88:91], v[56:59], v[0:15]
  v_mfma_f32_32x32x16_bf16 v[16:31], v[56:59], a[216:219], v[16:31]
  ds_read_b128 v[56:59], v127 offset:63488
  s_waitcnt lgkmcnt(7)
  v_mfma_f32_32x32x16_bf16 v[0:15], a[92:95], v[60:63], v[0:15]
  v_mfma_f32_32x32x16_bf16 v[16:31], v[60:63], a[220:223], v[16:31]
  ds_read_b128 v[60:63], v127 offset:64512
  s_waitcnt lgkmcnt(7)
  v_mfma_f32_32x32x16_bf16 v[0:15], a[96:99], v[32:35], v[0:15]
  v_mfma_f32_32x32x16_bf16 v[16:31], v[32:35], a[224:227], v[16:31]
  s_waitcnt lgkmcnt(6)
  v_mfma_f32_32x32x16_bf16 v[0:15], a[100:103], v[36:39], v[0:15]
  v_mfma_f32_32x32x16_bf16 v[16:31], v[36:39], a[228:231], v[16:31]
  s_waitcnt lgkmcnt(5)
  v_mfma_f32_32x32x16_bf16 v[0:15], a[104:107], v[40:43], v[0:15]
  v_mfma_f32_32x32x16_bf16 v[16:31], v[40:43], a[232:235], v[16:31]
  s_waitcnt lgkmcnt(4)
  v_mfma_f32_32x32x16_bf16 v[0:15], a[108:111], v[44:47], v[0:15]
  v_mfma_f32_32x32x16_bf16 v[16:31], v[44:47], a[236:239], v[16:31]
  s_waitcnt lgkmcnt(3)
  v_mfma_f32_32x32x16_bf16 v[0:15], a[112:115], v[48:51], v[0:15]
  v_mfma_f32_32x32x16_bf16 v[16:31], v[48:51], a[240:243], v[16:31]
  s_waitcnt lgkmcnt(2)
  v_mfma_f32_32x32x16_bf16 v[0:15], a[116:119], v[52:55], v[0:15]
  v_mfma_f32_32x32x16_bf16 v[16:31], v[52:55], a[244:247], v[16:31]
  s_waitcnt lgkmcnt(1)
  v_mfma_f32_32x32x16_bf16 v[0:15], a[120:123], v[56:59], v[0:15]
  v_mfma_f32_32x32x16_bf16 v[16:31], v[56:59], a[248:251], v[16:31]
  s_waitcnt lgkmcnt(0)
  v_mfma_f32_32x32x16_bf16 v[0:15], a[124:127], v[60:63], v[0:15]
  v_mfma_f32_32x32x16_bf16 v[16:31], v[60:63], a[252:255], v[16:31]
  s_lshl_b32 s21, s20, 5
  s_add_u32 s21, s21, s17
  s_lshl_b32 s21, s21, 13
  s_add_u32 s22, s21, 20971520
  s_add_u32 s21, s21, 4194304
  s_lshl_b32 s23, s17, 6
  s_add_u32 s23, s23, s20
  s_lshl_b32 s23, s23, 2
  s_add_u32 s23, s23, 8192
  v_xor_b32 v127, 32768, v127
  s_xor_b32 s35, s35, 98304
  s_nop 7
  v_cvt_pk_bf16_f32 v64, v0, v1
  v_cvt_pk_bf16_f32 v65, v2, v3
  v_cvt_pk_bf16_f32 v66, v4, v5
  v_cvt_pk_bf16_f32 v67, v6, v7
  v_cvt_pk_bf16_f32 v68, v8, v9
  v_cvt_pk_bf16_f32 v69, v10, v11
  v_cvt_pk_bf16_f32 v70, v12, v13
  v_cvt_pk_bf16_f32 v71, v14, v15
  v_cvt_pk_bf16_f32 v72, v16, v17
  v_cvt_pk_bf16_f32 v73, v18, v19
  v_cvt_pk_bf16_f32 v74, v24, v25
  v_cvt_pk_bf16_f32 v75, v26, v27
  v_cvt_pk_bf16_f32 v76, v20, v21
  v_cvt_pk_bf16_f32 v77, v22, v23
  v_cvt_pk_bf16_f32 v78, v28, v29
  v_cvt_pk_bf16_f32 v79, v30, v31
  s_waitcnt vmcnt(0)
  s_barrier
  s_cmp_eq_u32 s76, 0
  s_cselect_b32 s80, 1, s18
  s_cmp_lg_u32 s80, 0
  s_cbranch_scc1 w1pf_24
  v_mov_b32 v80, 1
  s_mov_b64 exec, 1
  buffer_store_dword v80, off, s[4:7], s76 sc1
  s_mov_b64 exec, -1
w1pf_24:
  buffer_store_dwordx4 v[64:67], v126, s[4:7], s21 offen sc1
  buffer_store_dwordx4 v[68:71], v126, s[4:7], s21 offen offset:512 sc1
  buffer_store_dwordx4 v[72:75], v120, s[4:7], s22 offen sc1
  buffer_store_dwordx4 v[76:79], v120, s[4:7], s22 offen offset:512 sc1
  s_mov_b32 s76, s23
  s_waitcnt vmcnt(0)
  s_barrier
  s_cmp_eq_u32 s76, 0
  s_cselect_b32 s80, 1, s18
  s_cmp_lg_u32 s80, 0
  s_cbranch_scc1 w1pf_25
  v_mov_b32 v80, 1
  s_mov_b64 exec, 1
  buffer_store_dword v80, off, s[4:7], s76 sc1
  s_mov_b64 exec, -1
w1pf_25:
  s_mov_b32 s76, 0
  s_add_u32 s20, s20, 7
  v_lshrrev_b32 v96, 2, v112
  v_and_b32 v97, 3, v112
  v_lshlrev_b32 v97, 4, v97
  v_lshl_add_u32 v100, v96, 13, v97
  v_lshl_add_u32 v101, v96, 10, v97
  s_lshl_b32 s21, s17, 8
  s_lshl_b32 s22, s18, 6
  s_add_u32 s21, s21, s22
  v_add_u32 v100, s21, v100
  s_and_b32 s21, s17, 3
  s_lshl_b32 s21, s21, 8
  s_add_u32 s21, s21, s22
  v_add_u32 v101, s21, v101
  s_lshr_b32 s21, s17, 2
  s_lshl_b32 s68, s21, 19
  s_lshl_b32 s69, s21, 18
  v_lshrrev_b32 v96, 1, v112
  v_mul_u32_u24 v96, 3584, v96
  v_and_b32 v97, 1, v112
  v_lshl_add_u32 v96, v97, 4, v96
  s_lshl_b32 s21, s17, 7
  s_lshl_b32 s22, s18, 5
  s_add_u32 s21, s21, s22
  v_add_u32 v102, s21, v96
  v_lshrrev_b32 v96, 4, v112
  v_lshlrev_b32 v96, 8, v96
  v_bfe_u32 v97, v112, 2, 2
  v_lshl_add_u32 v96, v97, 5, v96
  v_and_b32 v97, 3, v112
  v_lshl_add_u32 v96, v97, 3, v96
  v_add_u32 v103, s32, v96
  s_load_dwordx2 s[36:37], s[0:1], 16
  s_load_dwordx2 s[38:39], s[0:1], 40
  s_load_dwordx2 s[40:41], s[0:1], 64
  s_load_dwordx2 s[42:43], s[0:1], 80
  s_mov_b32 s31, 0x00020000
  s_waitcnt lgkmcnt(0)
  s_add_u32 s24, s20, 7
  s_cmp_ge_u32 s24, 64
  s_cbranch_scc1 w1nopf_27
  s_lshl_b32 s23, s24, 15
  s_add_u32 s23, s23, 1048576
  s_lshl_b32 s21, s18, 13
  s_add_u32 s22, s21, s23
  s_add_u32 s21, s21, s35
  s_add_u32 m0, s21, 0
  s_add_u32 s80, s22, 0
  buffer_load_dwordx4 v113, s[4:7], s80 offen offset:0 sc1 lds
  buffer_load_dwordx4 v113, s[4:7], s80 offen offset:1024 sc1 lds
  buffer_load_dwordx4 v113, s[4:7], s80 offen offset:2048 sc1 lds
  buffer_load_dwordx4 v113, s[4:7], s80 offen offset:3072 sc1 lds
  s_add_u32 m0, s21, 4096
  s_add_u32 s80, s22, 4096
  buffer_load_dwordx4 v113, s[4:7], s80 offen offset:0 sc1 lds
  buffer_load_dwordx4 v113, s[4:7], s80 offen offset:1024 sc1 lds
  buffer_load_dwordx4 v113, s[4:7], s80 offen offset:2048 sc1 lds
  buffer_load_dwordx4 v113, s[4:7], s80 offen offset:3072 sc1 lds
w1nopf_27:
  ds_read_b128 v[32:35], v127 offset:32768
  ds_read_b128 v[36:39], v127 offset:33792
  ds_read_b128 v[40:43], v127 offset:34816
  ds_read_b128 v[44:47], v127 offset:35840
  ds_read_b128 v[48:51], v127 offset:36864
  ds_read_b128 v[52:55], v127 offset:37888
  ds_read_b128 v[56:59], v127 offset:38912
  ds_read_b128 v[60:63], v127 offset:39936
  s_waitcnt lgkmcnt(7)
  v_mfma_f32_32x32x16_bf16 v[0:15], a[0:3], v[32:35], 0
  s_mov_b32 s28, s40
  s_mov_b32 s29, s41
  s_mov_b32 s30, 0x1c0000
  s_add_u32 m0, s32, 0
  s_mov_b32 s80, 0
  buffer_load_dwordx4 v102, s[28:31], s80 offen  lds
  v_mfma_f32_32x32x16_bf16 v[16:31], v[32:35], a[128:131], 0
  ds_read_b128 v[32:35], v127 offset:40960
  s_waitcnt lgkmcnt(7)
  v_mfma_f32_32x32x16_bf16 v[0:15], a[4:7], v[36:39], v[0:15]
  v_mfma_f32_32x32x16_bf16 v[16:31], v[36:39], a[132:135], v[16:31]
  ds_read_b128 v[36:39], v127 offset:41984
  s_waitcnt lgkmcnt(7)
  v_mfma_f32_32x32x16_bf16 v[0:15], a[8:11], v[40:43], v[0:15]
  s_add_u32 m0, s32, 1024
  s_mov_b32 s80, 114688
  buffer_load_dwordx4 v102, s[28:31], s80 offen  lds
  v_mfma_f32_32x32x16_bf16 v[16:31], v[40:43], a[136:139], v[16:31]
  ds_read_b128 v[40:43], v127 offset:43008
  s_waitcnt lgkmcnt(7)
  v_mfma_f32_32x32x16_bf16 v[0:15], a[12:15], v[44:47], v[0:15]
  v_mfma_f32_32x32x16_bf16 v[16:31], v[44:47], a[140:143], v[16:31]
  ds_read_b128 v[44:47], v127 offset:44032
  s_waitcnt lgkmcnt(7)
  v_mfma_f32_32x32x16_bf16 v[0:15], a[16:19], v[48:51], v[0:15]
  s_add_u32 m0, s32, 2048
  s_mov_b32 s80, 229376
  buffer_load_dwordx4 v102, s[28:31], s80 offen  lds
  v_mfma_f32_32x32x16_bf16 v[16:31], v[48:51], a[144:147], v[16:31]
  ds_read_b128 v[48:51], v127 offset:45056
  s_waitcnt lgkmcnt(7)
  v_mfma_f32_32x32x16_bf16 v[0:15], a[20:23], v[52:55], v[0:15]
  v_mfma_f32_32x32x16_bf16 v[16:31], v[52:55], a[148:151], v[16:31]
  ds_read_b128 v[52:55], v127 offset:46080
  s_waitcnt lgkmcnt(7)
  v_mfma_f32_32x32x16_bf16 v[0:15], a[24:27], v[56:59], v[0:15]
  s_add_u32 m0, s32, 3072
  s_mov_b32 s80, 344064
  buffer_load_dwordx4 v102, s[28:31], s80 offen  lds
  v_mfma_f32_32x32x16_bf16 v[16:31], v[56:59], a[152:155], v[16:31]
  ds_read_b128 v[56:59], v127 offset:47104
  s_waitcnt lgkmcnt(7)
  v_mfma_f32_32x32x16_bf16 v[0:15], a[28:31], v[60:63], v[0:15]
  v_mfma_f32_32x32x16_bf16 v[16:31], v[60:63], a[156:159], v[16:31]
  ds_read_b128 v[60:63], v127 offset:48128
  s_waitcnt lgkmcnt(7)
  v_mfma_f32_32x32x16_bf16 v[0:15], a[32:35], v[32:35], v[0:15]
  s_add_u32 m0, s32, 4096
  s_mov_b32 s80, 458752
  buffer_load_dwordx4 v102, s[28:31], s80 offen  lds
  v_mfma_f32_32x32x16_bf16 v[16:31], v[32:35], a[160:163], v[16:31]
  ds_read_b128 v[32:35], v127 offset:49152
  s_waitcnt lgkmcnt(7)
  v_mfma_f32_32x32x16_bf16 v[0:15], a[36:39], v[36:39], v[0:15]
  v_mfma_f32_32x32x16_bf16 v[16:31], v[36:39], a[164:167], v[16:31]
  ds_read_b128 v[36:39], v127 offset:50176
  s_waitcnt lgkmcnt(7)
  v_mfma_f32_32x32x16_bf16 v[0:15], a[40:43], v[40:43], v[0:15]
  s_add_u32 m0, s32, 5120
  s_mov_b32 s80, 573440
  buffer_load_dwordx4 v102, s[28:31], s80 offen  lds
  v_mfma_f32_32x32x16_bf16 v[16:31], v[40:43], a[168:171], v[16:31]
  ds_read_b128 v[40:43], v127 offset:51200
  s_waitcnt lgkmcnt(7)
  v_mfma_f32_32x32x16_bf16 v[0:15], a[44:47], v[44:47], v[0:15]
  v_mfma_f32_32x32x16_bf16 v[16:31], v[44:47], a[172:175], v[16:31]
  ds_read_b128 v[44:47], v127 offset:52224
  s_waitcnt lgkmcnt(7)
  v_mfma_f32_32x32x16_bf16 v[0:15], a[48:51], v[48:51], v[0:15]
  s_add_u32 m0, s32, 6144
  s_mov_b32 s80, 688128
  buffer_load_dwordx4 v102, s[28:31], s80 offen  lds
  v_mfma_f32_32x32x16_bf16 v[16:31], v[48:51], a[176:179], v[16:31]
  ds_read_b128 v[48:51], v127 offset:53248
  s_waitcnt lgkmcnt(7)
  v_mfma_f32_32x32x16_bf16 v[0:15], a[52:55], v[52:55], v[0:15]
  v_mfma_f32_32x32x16_bf16 v[16:31], v[52:55], a[180:183], v[16:31]
  ds_read_b128 v[52:55], v127 offset:54272
  s_waitcnt lgkmcnt(7)
  v_mfma_f32_32x32x16_bf16 v[0:15], a[56:59], v[56:59], v[0:15]
  s_add_u32 m0, s32, 7168
  s_mov_b32 s80, 802816
  buffer_load_dwordx4 v102, s[28:31], s80 offen  lds
  v_mfma_f32_32x32x16_bf16 v[16:31], v[56:59], a[184:187], v[16:31]
  ds_read_b128 v[56:59], v127 offset:55296
  s_waitcnt lgkmcnt(7)
  v_mfma_f32_32x32x16_bf16 v[0:15], a[60:63], v[60:63], v[0:15]
  v_mfma_f32_32x32x16_bf16 v[16:31], v[60:63], a[188:191], v[16:31]
  ds_read_b128 v[60:63], v127 offset:56320
  s_waitcnt lgkmcnt(7)
  v_mfma_f32_32x32x16_bf16 v[0:15], a[64:67], v[32:35], v[0:15]
  v_mfma_f32_32x32x16_bf16 v[16:31], v[32:35], a[192:195], v[16:31]
  ds_read_b128 v[32:35], v127 offset:57344
  s_waitcnt lgkmcnt(7)
  v_mfma_f32_32x32x16_bf16 v[0:15], a[68:71], v[36:39], v[0:15]
  v_mfma_f32_32x32x16_bf16 v[16:31], v[36:39], a[196:199], v[16:31]
  ds_read_b128 v[36:39], v127 offset:58368
  s_waitcnt lgkmcnt(7)
  v_mfma_f32_32x32x16_bf16 v[0:15], a[72:75], v[40:43], v[0:15]
  v_mfma_f32_32x32x16_bf16 v[16:31], v[40:43], a[200:203], v[16:31]
  ds_read_b128 v[40:43], v127 offset:59392
  s_waitcnt lgkmcnt(7)
  v_mfma_f32_32x32x16_bf16 v[0:15], a[76:79], v[44:47], v[0:15]
  v_mfma_f32_32x32x16_bf16 v[16:31], v[44:47], a[204:207], v[16:31]
  ds_read_b128 v[44:47], v127 offset:60416
  s_waitcnt lgkmcnt(7)
  v_mfma_f32_32x32x16_bf16 v[0:15], a[80:83], v[48:51], v[0:15]
  v_mfma_f32_32x32x16_bf16 v[16:31], v[48:51], a[208:211], v[16:31]
  ds_read_b128 v[48:51], v127 offset:61440
  s_waitcnt lgkmcnt(7)
  v_mfma_f32_32x32x16_bf16 v[0:15], a[84:87], v[52:55], v[0:15]
  v_mfma_f32_32x32x16_bf16 v[16:31], v[52:55], a[212:215], v[16:31]
  ds_read_b128 v[52:55], v127 offset:62464
  s_waitcnt lgkmcnt(7)
  v_mfma_f32_32x32x16_bf16 v[0:15], a[88:91], v[56:59], v[0:15]
  v_mfma_f32_32x32x16_bf16 v[16:31], v[56:59], a[216:219], v[16:31]
  ds_read_b128 v[56:59], v127 offset:63488
  s_waitcnt lgkmcnt(7)
  v_mfma_f32_32x32x16_bf16 v[0:15], a[92:95], v[60:63], v[0:15]
  v_mfma_f32_32x32x16_bf16 v[16:31], v[60:63], a[220:223], v[16:31]
  ds_read_b128 v[60:63], v127 offset:64512
  s_waitcnt lgkmcnt(7)
  v_mfma_f32_32x32x16_bf16 v[0:15], a[96:99], v[32:35], v[0:15]
  v_mfma_f32_32x32x16_bf16 v[16:31], v[32:35], a[224:227], v[16:31]
  s_waitcnt lgkmcnt(6)
  v_mfma_f32_32x32x16_bf16 v[0:15], a[100:103], v[36:39], v[0:15]
  v_mfma_f32_32x32x16_bf16 v[16:31], v[36:39], a[228:231], v[16:31]
  s_waitcnt lgkmcnt(5)
  v_mfma_f32_32x32x16_bf16 v[0:15], a[104:107], v[40:43], v[0:15]
  v_mfma_f32_32x32x16_bf16 v[16:31], v[40:43], a[232:235], v[16:31]
  s_waitcnt lgkmcnt(4)
  v_mfma_f32_32x32x16_bf16 v[0:15], a[108:111], v[44:47], v[0:15]
  v_mfma_f32_32x32x16_bf16 v[16:31], v[44:47], a[236:239], v[16:31]
  s_waitcnt lgkmcnt(3)
  v_mfma_f32_32x32x16_bf16 v[0:15], a[112:115], v[48:51], v[0:15]
  v_mfma_f32_32x32x16_bf16 v[16:31], v[48:51], a[240:243], v[16:31]
  s_waitcnt lgkmcnt(2)
  v_mfma_f32_32x32x16_bf16 v[0:15], a[116:119], v[52:55], v[0:15]
  v_mfma_f32_32x32x16_bf16 v[16:31], v[52:55], a[244:247], v[16:31]
  s_waitcnt lgkmcnt(1)
  v_mfma_f32_32x32x16_bf16 v[0:15], a[120:123], v[56:59], v[0:15]
  v_mfma_f32_32x32x16_bf16 v[16:31], v[56:59], a[248:251], v[16:31]
  s_waitcnt lgkmcnt(0)
  v_mfma_f32_32x32x16_bf16 v[0:15], a[124:127], v[60:63], v[0:15]
  v_mfma_f32_32x32x16_bf16 v[16:31], v[60:63], a[252:255], v[16:31]
  s_lshl_b32 s21, s20, 5
  s_add_u32 s21, s21, s17
  s_lshl_b32 s21, s21, 13
  s_add_u32 s22, s21, 20971520
  s_add_u32 s21, s21, 4194304
  s_lshl_b32 s23, s17, 6
  s_add_u32 s23, s23, s20
  s_lshl_b32 s23, s23, 2
  s_add_u32 s23, s23, 8192
  v_xor_b32 v127, 32768, v127
  s_xor_b32 s35, s35, 98304
  s_nop 7
  v_cvt_pk_bf16_f32 v64, v0, v1
  v_cvt_pk_bf16_f32 v65, v2, v3
  v_cvt_pk_bf16_f32 v66, v4, v5
  v_cvt_pk_bf16_f32 v67, v6, v7
  v_cvt_pk_bf16_f32 v68, v8, v9
  v_cvt_pk_bf16_f32 v69, v10, v11
  v_cvt_pk_bf16_f32 v70, v12, v13
  v_cvt_pk_bf16_f32 v71, v14, v15
  v_cvt_pk_bf16_f32 v72, v16, v17
  v_cvt_pk_bf16_f32 v73, v18, v19
  v_cvt_pk_bf16_f32 v74, v24, v25
  v_cvt_pk_bf16_f32 v75, v26, v27
  v_cvt_pk_bf16_f32 v76, v20, v21
  v_cvt_pk_bf16_f32 v77, v22, v23
  v_cvt_pk_bf16_f32 v78, v28, v29
  v_cvt_pk_bf16_f32 v79, v30, v31
  s_waitcnt vmcnt(0)
  s_barrier
  s_cmp_eq_u32 s76, 0
  s_cselect_b32 s80, 1, s18
  s_cmp_lg_u32 s80, 0
  s_cbranch_scc1 w1pf_28
  v_mov_b32 v80, 1
  s_mov_b64 exec, 1
  buffer_store_dword v80, off, s[4:7], s76 sc1
  s_mov_b64 exec, -1
w1pf_28:
  buffer_store_dwordx4 v[64:67], v126, s[4:7], s21 offen sc1
  buffer_store_dwordx4 v[68:71], v126, s[4:7], s21 offen offset:512 sc1
  buffer_store_dwordx4 v[72:75], v120, s[4:7], s22 offen sc1
  buffer_store_dwordx4 v[76:79], v120, s[4:7], s22 offen offset:512 sc1
  s_mov_b32 s76, s23
  ds_read_b64_tr_b16 v[128:129], v103 offset:0
  ds_read_b64_tr_b16 v[130:131], v103 offset:128
  ds_read_b64_tr_b16 v[132:133], v103 offset:1024
  ds_read_b64_tr_b16 v[134:135], v103 offset:1152
  ds_read_b64_tr_b16 v[136:137], v103 offset:2048
  ds_read_b64_tr_b16 v[138:139], v103 offset:2176
  ds_read_b64_tr_b16 v[140:141], v103 offset:3072
  ds_read_b64_tr_b16 v[142:143], v103 offset:3200
  ds_read_b64_tr_b16 v[144:145], v103 offset:4096
  ds_read_b64_tr_b16 v[146:147], v103 offset:4224
  ds_read_b64_tr_b16 v[148:149], v103 offset:5120
  ds_read_b64_tr_b16 v[150:151], v103 offset:5248
  ds_read_b64_tr_b16 v[152:153], v103 offset:6144
  ds_read_b64_tr_b16 v[154:155], v103 offset:6272
  ds_read_b64_tr_b16 v[156:157], v103 offset:7168
  ds_read_b64_tr_b16 v[158:159], v103 offset:7296
  s_waitcnt lgkmcnt(0)
  s_add_u32 s20, s20, 7
  s_add_u32 s24, s20, 7
  s_cmp_ge_u32 s24, 64
  s_cbranch_scc1 w1nopf_29
  s_lshl_b32 s23, s24, 15
  s_add_u32 s23, s23, 1048576
  s_lshl_b32 s21, s18, 13
  s_add_u32 s22, s21, s23
  s_add_u32 s21, s21, s35
  s_add_u32 m0, s21, 0
  s_add_u32 s80, s22, 0
  buffer_load_dwordx4 v113, s[4:7], s80 offen offset:0 sc1 lds
  buffer_load_dwordx4 v113, s[4:7], s80 offen offset:1024 sc1 lds
  buffer_load_dwordx4 v113, s[4:7], s80 offen offset:2048 sc1 lds
  buffer_load_dwordx4 v113, s[4:7], s80 offen offset:3072 sc1 lds
  s_add_u32 m0, s21, 4096
  s_add_u32 s80, s22, 4096
  buffer_load_dwordx4 v113, s[4:7], s80 offen offset:0 sc1 lds
  buffer_load_dwordx4 v113, s[4:7], s80 offen offset:1024 sc1 lds
  buffer_load_dwordx4 v113, s[4:7], s80 offen offset:2048 sc1 lds
  buffer_load_dwordx4 v113, s[4:7], s80 offen offset:3072 sc1 lds
w1nopf_29:
  ds_read_b128 v[32:35], v127 offset:32768
  ds_read_b128 v[36:39], v127 offset:33792
  ds_read_b128 v[40:43], v127 offset:34816
  ds_read_b128 v[44:47], v127 offset:35840
  ds_read_b128 v[48:51], v127 offset:36864
  ds_read_b128 v[52:55], v127 offset:37888
  ds_read_b128 v[56:59], v127 offset:38912
  ds_read_b128 v[60:63], v127 offset:39936
  s_waitcnt lgkmcnt(7)
  v_mfma_f32_32x32x16_bf16 v[0:15], a[0:3], v[32:35], 0
  s_add_u32 m0, s32, 8192
  s_mov_b32 s80, 917504
  buffer_load_dwordx4 v102, s[28:31], s80 offen  lds
  v_mfma_f32_32x32x16_bf16 v[16:31], v[32:35], a[128:131], 0
  ds_read_b128 v[32:35], v127 offset:40960
  s_waitcnt lgkmcnt(7)
  v_mfma_f32_32x32x16_bf16 v[0:15], a[4:7], v[36:39], v[0:15]
  v_mfma_f32_32x32x16_bf16 v[16:31], v[36:39], a[132:135], v[16:31]
  ds_read_b128 v[36:39], v127 offset:41984
  s_waitcnt lgkmcnt(7)
  v_mfma_f32_32x32x16_bf16 v[0:15], a[8:11], v[40:43], v[0:15]
  s_add_u32 m0, s32, 9216
  s_mov_b32 s80, 1032192
  buffer_load_dwordx4 v102, s[28:31], s80 offen  lds
  v_mfma_f32_32x32x16_bf16 v[16:31], v[40:43], a[136:139], v[16:31]
  ds_read_b128 v[40:43], v127 offset:43008
  s_waitcnt lgkmcnt(7)
  v_mfma_f32_32x32x16_bf16 v[0:15], a[12:15], v[44:47], v[0:15]
  v_mfma_f32_32x32x16_bf16 v[16:31], v[44:47], a[140:143], v[16:31]
  ds_read_b128 v[44:47], v127 offset:44032
  s_waitcnt lgkmcnt(7)
  v_mfma_f32_32x32x16_bf16 v[0:15], a[16:19], v[48:51], v[0:15]
  s_add_u32 m0, s32, 10240
  s_mov_b32 s80, 1146880
  buffer_load_dwordx4 v102, s[28:31], s80 offen  lds
  v_mfma_f32_32x32x16_bf16 v[16:31], v[48:51], a[144:147], v[16:31]
  ds_read_b128 v[48:51], v127 offset:45056
  s_waitcnt lgkmcnt(7)
  v_mfma_f32_32x32x16_bf16 v[0:15], a[20:23], v[52:55], v[0:15]
  v_mfma_f32_32x32x16_bf16 v[16:31], v[52:55], a[148:151], v[16:31]
  ds_read_b128 v[52:55], v127 offset:46080
  s_waitcnt lgkmcnt(7)
  v_mfma_f32_32x32x16_bf16 v[0:15], a[24:27], v[56:59], v[0:15]
  s_add_u32 m0, s32, 11264
  s_mov_b32 s80, 1261568
  buffer_load_dwordx4 v102, s[28:31], s80 offen  lds
  v_mfma_f32_32x32x16_bf16 v[16:31], v[56:59], a[152:155], v[16:31]
  ds_read_b128 v[56:59], v127 offset:47104
  s_waitcnt lgkmcnt(7)
  v_mfma_f32_32x32x16_bf16 v[0:15], a[28:31], v[60:63], v[0:15]
  v_mfma_f32_32x32x16_bf16 v[16:31], v[60:63], a[156:159], v[16:31]
  ds_read_b128 v[60:63], v127 offset:48128
  s_waitcnt lgkmcnt(7)
  v_mfma_f32_32x32x16_bf16 v[0:15], a[32:35], v[32:35], v[0:15]
  s_add_u32 m0, s32, 12288
  s_mov_b32 s80, 1376256
  buffer_load_dwordx4 v102, s[28:31], s80 offen  lds
  v_mfma_f32_32x32x16_bf16 v[16:31], v[32:35], a[160:163], v[16:31]
  ds_read_b128 v[32:35], v127 offset:49152
  s_waitcnt lgkmcnt(7)
  v_mfma_f32_32x32x16_bf16 v[0:15], a[36:39], v[36:39], v[0:15]
  v_mfma_f32_32x32x16_bf16 v[16:31], v[36:39], a[164:167], v[16:31]
  ds_read_b128 v[36:39], v127 offset:50176
  s_waitcnt lgkmcnt(7)
  v_mfma_f32_32x32x16_bf16 v[0:15], a[40:43], v[40:43], v[0:15]
  s_add_u32 m0, s32, 13312
  s_mov_b32 s80, 1490944
  buffer_load_dwordx4 v102, s[28:31], s80 offen  lds
  v_mfma_f32_32x32x16_bf16 v[16:31], v[40:43], a[168:171], v[16:31]
  ds_read_b128 v[40:43], v127 offset:51200
  s_waitcnt lgkmcnt(7)
  v_mfma_f32_32x32x16_bf16 v[0:15], a[44:47], v[44:47], v[0:15]
  v_mfma_f32_32x32x16_bf16 v[16:31], v[44:47], a[172:175], v[16:31]
  ds_read_b128 v[44:47], v127 offset:52224
  s_waitcnt lgkmcnt(7)
  v_mfma_f32_32x32x16_bf16 v[0:15], a[48:51], v[48:51], v[0:15]
  s_add_u32 m0, s32, 14336
  s_mov_b32 s80, 1605632
  buffer_load_dwordx4 v102, s[28:31], s80 offen  lds
  v_mfma_f32_32x32x16_bf16 v[16:31], v[48:51], a[176:179], v[16:31]
  ds_read_b128 v[48:51], v127 offset:53248
  s_waitcnt lgkmcnt(7)
  v_mfma_f32_32x32x16_bf16 v[0:15], a[52:55], v[52:55], v[0:15]
  v_mfma_f32_32x32x16_bf16 v[16:31], v[52:55], a[180:183], v[16:31]
  ds_read_b128 v[52:55], v127 offset:54272
  s_waitcnt lgkmcnt(7)
  v_mfma_f32_32x32x16_bf16 v[0:15], a[56:59], v[56:59], v[0:15]
  s_add_u32 m0, s32, 15360
  s_mov_b32 s80, 1720320
  buffer_load_dwordx4 v102, s[28:31], s80 offen  lds
  v_mfma_f32_32x32x16_bf16 v[16:31], v[56:59], a[184:187], v[16:31]
  ds_read_b128 v[56:59], v127 offset:55296
  s_waitcnt lgkmcnt(7)
  v_mfma_f32_32x32x16_bf16 v[0:15], a[60:63], v[60:63], v[0:15]
  v_mfma_f32_32x32x16_bf16 v[16:31], v[60:63], a[188:191], v[16:31]
  ds_read_b128 v[60:63], v127 offset:56320
  s_waitcnt lgkmcnt(7)
  v_mfma_f32_32x32x16_bf16 v[0:15], a[64:67], v[32:35], v[0:15]
  v_mfma_f32_32x32x16_bf16 v[16:31], v[32:35], a[192:195], v[16:31]
  ds_read_b128 v[32:35], v127 offset:57344
  s_waitcnt lgkmcnt(7)
  v_mfma_f32_32x32x16_bf16 v[0:15], a[68:71], v[36:39], v[0:15]
  v_mfma_f32_32x32x16_bf16 v[16:31], v[36:39], a[196:199], v[16:31]
  ds_read_b128 v[36:39], v127 offset:58368
  s_waitcnt lgkmcnt(7)
  v_mfma_f32_32x32x16_bf16 v[0:15], a[72:75], v[40:43], v[0:15]
  v_mfma_f32_32x32x16_bf16 v[16:31], v[40:43], a[200:203], v[16:31]
  ds_read_b128 v[40:43], v127 offset:59392
  s_waitcnt lgkmcnt(7)
  v_mfma_f32_32x32x16_bf16 v[0:15], a[76:79], v[44:47], v[0:15]
  v_mfma_f32_32x32x16_bf16 v[16:31], v[44:47], a[204:207], v[16:31]
  ds_read_b128 v[44:47], v127 offset:60416
  s_waitcnt lgkmcnt(7)
  v_mfma_f32_32x32x16_bf16 v[0:15], a[80:83], v[48:51], v[0:15]
  v_mfma_f32_32x32x16_bf16 v[16:31], v[48:51], a[208:211], v[16:31]
  ds_read_b128 v[48:51], v127 offset:61440
  s_waitcnt lgkmcnt(7)
  v_mfma_f32_32x32x16_bf16 v[0:15], a[84:87], v[52:55], v[0:15]
  v_mfma_f32_32x32x16_bf16 v[16:31], v[52:55], a[212:215], v[16:31]
  ds_read_b128 v[52:55], v127 offset:62464
  s_waitcnt lgkmcnt(7)
  v_mfma_f32_32x32x16_bf16 v[0:15], a[88:91], v[56:59], v[0:15]
  v_mfma_f32_32x32x16_bf16 v[16:31], v[56:59], a[216:219], v[16:31]
  ds_read_b128 v[56:59], v127 offset:63488
  s_waitcnt lgkmcnt(7)
  v_mfma_f32_32x32x16_bf16 v[0:15], a[92:95], v[60:63], v[0:15]
  v_mfma_f32_32x32x16_bf16 v[16:31], v[60:63], a[220:223], v[16:31]
  ds_read_b128 v[60:63], v127 offset:64512
  s_waitcnt lgkmcnt(7)
  v_mfma_f32_32x32x16_bf16 v[0:15], a[96:99], v[32:35], v[0:15]
  v_mfma_f32_32x32x16_bf16 v[16:31], v[32:35], a[224:227], v[16:31]
  s_waitcnt lgkmcnt(6)
  v_mfma_f32_32x32x16_bf16 v[0:15], a[100:103], v[36:39], v[0:15]
  v_mfma_f32_32x32x16_bf16 v[16:31], v[36:39], a[228:231], v[16:31]
  s_waitcnt lgkmcnt(5)
  v_mfma_f32_32x32x16_bf16 v[0:15], a[104:107], v[40:43], v[0:15]
  v_mfma_f32_32x32x16_bf16 v[16:31], v[40:43], a[232:235], v[16:31]
  s_waitcnt lgkmcnt(4)
  v_mfma_f32_32x32x16_bf16 v[0:15], a[108:111], v[44:47], v[0:15]
  v_mfma_f32_32x32x16_bf16 v[16:31], v[44:47], a[236:239], v[16:31]
  s_waitcnt lgkmcnt(3)
  v_mfma_f32_32x32x16_bf16 v[0:15], a[112:115], v[48:51], v[0:15]
  v_mfma_f32_32x32x16_bf16 v[16:31], v[48:51], a[240:243], v[16:31]
  s_waitcnt lgkmcnt(2)
  v_mfma_f32_32x32x16_bf16 v[0:15], a[116:119], v[52:55], v[0:15]
  v_mfma_f32_32x32x16_bf16 v[16:31], v[52:55], a[244:247], v[16:31]
  s_waitcnt lgkmcnt(1)
  v_mfma_f32_32x32x16_bf16 v[0:15], a[120:123], v[56:59], v[0:15]
  v_mfma_f32_32x32x16_bf16 v[16:31], v[56:59], a[248:251], v[16:31]
  s_waitcnt lgkmcnt(0)
  v_mfma_f32_32x32x16_bf16 v[0:15], a[124:127], v[60:63], v[0:15]
  v_mfma_f32_32x32x16_bf16 v[16:31], v[60:63], a[252:255], v[16:31]
  s_lshl_b32 s21, s20, 5
  s_add_u32 s21, s21, s17
  s_lshl_b32 s21, s21, 13
  s_add_u32 s22, s21, 20971520
  s_add_u32 s21, s21, 4194304
  s_lshl_b32 s23, s17, 6
  s_add_u32 s23, s23, s20
  s_lshl_b32 s23, s23, 2
  s_add_u32 s23, s23, 8192
  v_xor_b32 v127, 32768, v127
  s_xor_b32 s35, s35, 98304
  s_nop 7
  v_cvt_pk_bf16_f32 v64, v0, v1
  v_cvt_pk_bf16_f32 v65, v2, v3
  v_cvt_pk_bf16_f32 v66, v4, v5
  v_cvt_pk_bf16_f32 v67, v6, v7
  v_cvt_pk_bf16_f32 v68, v8, v9
  v_cvt_pk_bf16_f32 v69, v10, v11
  v_cvt_pk_bf16_f32 v70, v12, v13
  v_cvt_pk_bf16_f32 v71, v14, v15
  v_cvt_pk_bf16_f32 v72, v16, v17
  v_cvt_pk_bf16_f32 v73, v18, v19
  v_cvt_pk_bf16_f32 v74, v24, v25
  v_cvt_pk_bf16_f32 v75, v26, v27
  v_cvt_pk_bf16_f32 v76, v20, v21
  v_cvt_pk_bf16_f32 v77, v22, v23
  v_cvt_pk_bf16_f32 v78, v28, v29
  v_cvt_pk_bf16_f32 v79, v30, v31
  s_waitcnt vmcnt(0)
  s_barrier
  s_cmp_eq_u32 s76, 0
  s_cselect_b32 s80, 1, s18
  s_cmp_lg_u32 s80, 0
  s_cbranch_scc1 w1pf_30
  v_mov_b32 v80, 1
  s_mov_b64 exec, 1
  buffer_store_dword v80, off, s[4:7], s76 sc1
  s_mov_b64 exec, -1
w1pf_30:
  buffer_store_dwordx4 v[64:67], v126, s[4:7], s21 offen sc1
  buffer_store_dwordx4 v[68:71], v126, s[4:7], s21 offen offset:512 sc1
  buffer_store_dwordx4 v[72:75], v120, s[4:7], s22 offen sc1
  buffer_store_dwordx4 v[76:79], v120, s[4:7], s22 offen offset:512 sc1
  s_mov_b32 s76, s23
  ds_read_b64_tr_b16 v[160:161], v103 offset:8192
  ds_read_b64_tr_b16 v[162:163], v103 offset:8320
  ds_read_b64_tr_b16 v[164:165], v103 offset:9216
  ds_read_b64_tr_b16 v[166:167], v103 offset:9344
  ds_read_b64_tr_b16 v[168:169], v103 offset:10240
  ds_read_b64_tr_b16 v[170:171], v103 offset:10368
  ds_read_b64_tr_b16 v[172:173], v103 offset:11264
  ds_read_b64_tr_b16 v[174:175], v103 offset:11392
  ds_read_b64_tr_b16 v[176:177], v103 offset:12288
  ds_read_b64_tr_b16 v[178:179], v103 offset:12416
  ds_read_b64_tr_b16 v[180:181], v103 offset:13312
  ds_read_b64_tr_b16 v[182:183], v103 offset:13440
  ds_read_b64_tr_b16 v[184:185], v103 offset:14336
  ds_read_b64_tr_b16 v[186:187], v103 offset:14464
  ds_read_b64_tr_b16 v[188:189], v103 offset:15360
  ds_read_b64_tr_b16 v[190:191], v103 offset:15488
  s_waitcnt lgkmcnt(0)
  s_add_u32 s20, s20, 7
  s_add_u32 s24, s20, 7
  s_cmp_ge_u32 s24, 64
  s_cbranch_scc1 w1nopf_31
  s_lshl_b32 s23, s24, 15
  s_add_u32 s23, s23, 1048576
  s_lshl_b32 s21, s18, 13
  s_add_u32 s22, s21, s23
  s_add_u32 s21, s21, s35
  s_add_u32 m0, s21, 0
  s_add_u32 s80, s22, 0
  buffer_load_dwordx4 v113, s[4:7], s80 offen offset:0 sc1 lds
  buffer_load_dwordx4 v113, s[4:7], s80 offen offset:1024 sc1 lds
  buffer_load_dwordx4 v113, s[4:7], s80 offen offset:2048 sc1 lds
  buffer_load_dwordx4 v113, s[4:7], s80 offen offset:3072 sc1 lds
  s_add_u32 m0, s21, 4096
  s_add_u32 s80, s22, 4096
  buffer_load_dwordx4 v113, s[4:7], s80 offen offset:0 sc1 lds
  buffer_load_dwordx4 v113, s[4:7], s80 offen offset:1024 sc1 lds
  buffer_load_dwordx4 v113, s[4:7], s80 offen offset:2048 sc1 lds
  buffer_load_dwordx4 v113, s[4:7], s80 offen offset:3072 sc1 lds
w1nopf_31:
  ds_read_b128 v[32:35], v127 offset:32768
  ds_read_b128 v[36:39], v127 offset:33792
  ds_read_b128 v[40:43], v127 offset:34816
  ds_read_b128 v[44:47], v127 offset:35840
  ds_read_b128 v[48:51], v127 offset:36864
  ds_read_b128 v[52:55], v127 offset:37888
  ds_read_b128 v[56:59], v127 offset:38912
  ds_read_b128 v[60:63], v127 offset:39936
  s_waitcnt lgkmcnt(7)
  v_mfma_f32_32x32x16_bf16 v[0:15], a[0:3], v[32:35], 0
  s_mov_b32 s28, s42
  s_mov_b32 s29, s43
  s_mov_b32 s30, 0x1c0000
  s_add_u32 m0, s32, 0
  s_add_u32 s80, s69, 0
  buffer_load_dwordx4 v101, s[28:31], s80 offen  lds
  v_mfma_f32_32x32x16_bf16 v[16:31], v[32:35], a[128:131], 0
  ds_read_b128 v[32:35], v127 offset:40960
  s_waitcnt lgkmcnt(7)
  v_mfma_f32_32x32x16_bf16 v[0:15], a[4:7], v[36:39], v[0:15]
  v_mfma_f32_32x32x16_bf16 v[16:31], v[36:39], a[132:135], v[16:31]
  ds_read_b128 v[36:39], v127 offset:41984
  s_waitcnt lgkmcnt(7)
  v_mfma_f32_32x32x16_bf16 v[0:15], a[8:11], v[40:43], v[0:15]
  s_add_u32 m0, s32, 1024
  s_add_u32 s80, s69, 16384
  buffer_load_dwordx4 v101, s[28:31], s80 offen  lds
  v_mfma_f32_32x32x16_bf16 v[16:31], v[40:43], a[136:139], v[16:31]
  ds_read_b128 v[40:43], v127 offset:43008
  s_waitcnt lgkmcnt(7)
  v_mfma_f32_32x32x16_bf16 v[0:15], a[12:15], v[44:47], v[0:15]
  v_mfma_f32_32x32x16_bf16 v[16:31], v[44:47], a[140:143], v[16:31]
  ds_read_b128 v[44:47], v127 offset:44032
  s_waitcnt lgkmcnt(7)
  v_mfma_f32_32x32x16_bf16 v[0:15], a[16:19], v[48:51], v[0:15]
  s_add_u32 m0, s32, 2048
  s_add_u32 s80, s69, 32768
  buffer_load_dwordx4 v101, s[28:31], s80 offen  lds
  v_mfma_f32_32x32x16_bf16 v[16:31], v[48:51], a[144:147], v[16:31]
  ds_read_b128 v[48:51], v127 offset:45056
  s_waitcnt lgkmcnt(7)
  v_mfma_f32_32x32x16_bf16 v[0:15], a[20:23], v[52:55], v[0:15]
  v_mfma_f32_32x32x16_bf16 v[16:31], v[52:55], a[148:151], v[16:31]
  ds_read_b128 v[52:55], v127 offset:46080
  s_waitcnt lgkmcnt(7)
  v_mfma_f32_32x32x16_bf16 v[0:15], a[24:27], v[56:59], v[0:15]
  s_add_u32 m0, s32, 3072
  s_add_u32 s80, s69, 49152
  buffer_load_dwordx4 v101, s[28:31], s80 offen  lds
  v_mfma_f32_32x32x16_bf16 v[16:31], v[56:59], a[152:155], v[16:31]
  ds_read_b128 v[56:59], v127 offset:47104
  s_waitcnt lgkmcnt(7)
  v_mfma_f32_32x32x16_bf16 v[0:15], a[28:31], v[60:63], v[0:15]
  v_mfma_f32_32x32x16_bf16 v[16:31], v[60:63], a[156:159], v[16:31]
  ds_read_b128 v[60:63], v127 offset:48128
  s_waitcnt lgkmcnt(7)
  v_mfma_f32_32x32x16_bf16 v[0:15], a[32:35], v[32:35], v[0:15]
  s_add_u32 m0, s32, 4096
  s_add_u32 s80, s69, 65536
  buffer_load_dwordx4 v101, s[28:31], s80 offen  lds
  v_mfma_f32_32x32x16_bf16 v[16:31], v[32:35], a[160:163], v[16:31]
  ds_read_b128 v[32:35], v127 offset:49152
  s_waitcnt lgkmcnt(7)
  v_mfma_f32_32x32x16_bf16 v[0:15], a[36:39], v[36:39], v[0:15]
  v_mfma_f32_32x32x16_bf16 v[16:31], v[36:39], a[164:167], v[16:31]
  ds_read_b128 v[36:39], v127 offset:50176
  s_waitcnt lgkmcnt(7)
  v_mfma_f32_32x32x16_bf16 v[0:15], a[40:43], v[40:43], v[0:15]
  s_add_u32 m0, s32, 5120
  s_add_u32 s80, s69, 81920
  buffer_load_dwordx4 v101, s[28:31], s80 offen  lds
  v_mfma_f32_32x32x16_bf16 v[16:31], v[40:43], a[168:171], v[16:31]
  ds_read_b128 v[40:43], v127 offset:51200
  s_waitcnt lgkmcnt(7)
  v_mfma_f32_32x32x16_bf16 v[0:15], a[44:47], v[44:47], v[0:15]
  v_mfma_f32_32x32x16_bf16 v[16:31], v[44:47], a[172:175], v[16:31]
  ds_read_b128 v[44:47], v127 offset:52224
  s_waitcnt lgkmcnt(7)
  v_mfma_f32_32x32x16_bf16 v[0:15], a[48:51], v[48:51], v[0:15]
  s_add_u32 m0, s32, 6144
  s_add_u32 s80, s69, 98304
  buffer_load_dwordx4 v101, s[28:31], s80 offen  lds
  v_mfma_f32_32x32x16_bf16 v[16:31], v[48:51], a[176:179], v[16:31]
  ds_read_b128 v[48:51], v127 offset:53248
  s_waitcnt lgkmcnt(7)
  v_mfma_f32_32x32x16_bf16 v[0:15], a[52:55], v[52:55], v[0:15]
  v_mfma_f32_32x32x16_bf16 v[16:31], v[52:55], a[180:183], v[16:31]
  ds_read_b128 v[52:55], v127 offset:54272
  s_waitcnt lgkmcnt(7)
  v_mfma_f32_32x32x16_bf16 v[0:15], a[56:59], v[56:59], v[0:15]
  s_add_u32 m0, s32, 7168
  s_add_u32 s80, s69, 114688
  buffer_load_dwordx4 v101, s[28:31], s80 offen  lds
  v_mfma_f32_32x32x16_bf16 v[16:31], v[56:59], a[184:187], v[16:31]
  ds_read_b128 v[56:59], v127 offset:55296
  s_waitcnt lgkmcnt(7)
  v_mfma_f32_32x32x16_bf16 v[0:15], a[60:63], v[60:63], v[0:15]
  v_mfma_f32_32x32x16_bf16 v[16:31], v[60:63], a[188:191], v[16:31]
  ds_read_b128 v[60:63], v127 offset:56320
  s_waitcnt lgkmcnt(7)
  v_mfma_f32_32x32x16_bf16 v[0:15], a[64:67], v[32:35], v[0:15]
  v_mfma_f32_32x32x16_bf16 v[16:31], v[32:35], a[192:195], v[16:31]
  ds_read_b128 v[32:35], v127 offset:57344
  s_waitcnt lgkmcnt(7)
  v_mfma_f32_32x32x16_bf16 v[0:15], a[68:71], v[36:39], v[0:15]
  v_mfma_f32_32x32x16_bf16 v[16:31], v[36:39], a[196:199], v[16:31]
  ds_read_b128 v[36:39], v127 offset:58368
  s_waitcnt lgkmcnt(7)
  v_mfma_f32_32x32x16_bf16 v[0:15], a[72:75], v[40:43], v[0:15]
  v_mfma_f32_32x32x16_bf16 v[16:31], v[40:43], a[200:203], v[16:31]
  ds_read_b128 v[40:43], v127 offset:59392
  s_waitcnt lgkmcnt(7)
  v_mfma_f32_32x32x16_bf16 v[0:15], a[76:79], v[44:47], v[0:15]
  v_mfma_f32_32x32x16_bf16 v[16:31], v[44:47], a[204:207], v[16:31]
  ds_read_b128 v[44:47], v127 offset:60416
  s_waitcnt lgkmcnt(7)
  v_mfma_f32_32x32x16_bf16 v[0:15], a[80:83], v[48:51], v[0:15]
  v_mfma_f32_32x32x16_bf16 v[16:31], v[48:51], a[208:211], v[16:31]
  ds_read_b128 v[48:51], v127 offset:61440
  s_waitcnt lgkmcnt(7)
  v_mfma_f32_32x32x16_bf16 v[0:15], a[84:87], v[52:55], v[0:15]
  v_mfma_f32_32x32x16_bf16 v[16:31], v[52:55], a[212:215], v[16:31]
  ds_read_b128 v[52:55], v127 offset:62464
  s_waitcnt lgkmcnt(7)
  v_mfma_f32_32x32x16_bf16 v[0:15], a[88:91], v[56:59], v[0:15]
  v_mfma_f32_32x32x16_bf16 v[16:31], v[56:59], a[216:219], v[16:31]
  ds_read_b128 v[56:59], v127 offset:63488
  s_waitcnt lgkmcnt(7)
  v_mfma_f32_32x32x16_bf16 v[0:15], a[92:95], v[60:63], v[0:15]
  v_mfma_f32_32x32x16_bf16 v[16:31], v[60:63], a[220:223], v[16:31]
  ds_read_b128 v[60:63], v127 offset:64512
  s_waitcnt lgkmcnt(7)
  v_mfma_f32_32x32x16_bf16 v[0:15], a[96:99], v[32:35], v[0:15]
  v_mfma_f32_32x32x16_bf16 v[16:31], v[32:35], a[224:227], v[16:31]
  s_waitcnt lgkmcnt(6)
  v_mfma_f32_32x32x16_bf16 v[0:15], a[100:103], v[36:39], v[0:15]
  v_mfma_f32_32x32x16_bf16 v[16:31], v[36:39], a[228:231], v[16:31]
  s_waitcnt lgkmcnt(5)
  v_mfma_f32_32x32x16_bf16 v[0:15], a[104:107], v[40:43], v[0:15]
  v_mfma_f32_32x32x16_bf16 v[16:31], v[40:43], a[232:235], v[16:31]
  s_waitcnt lgkmcnt(4)
  v_mfma_f32_32x32x16_bf16 v[0:15], a[108:111], v[44:47], v[0:15]
  v_mfma_f32_32x32x16_bf16 v[16:31], v[44:47], a[236:239], v[16:31]
  s_waitcnt lgkmcnt(3)
  v_mfma_f32_32x32x16_bf16 v[0:15], a[112:115], v[48:51], v[0:15]
  v_mfma_f32_32x32x16_bf16 v[16:31], v[48:51], a[240:243], v[16:31]
  s_waitcnt lgkmcnt(2)
  v_mfma_f32_32x32x16_bf16 v[0:15], a[116:119], v[52:55], v[0:15]
  v_mfma_f32_32x32x16_bf16 v[16:31], v[52:55], a[244:247], v[16:31]
  s_waitcnt lgkmcnt(1)
  v_mfma_f32_32x32x16_bf16 v[0:15], a[120:123], v[56:59], v[0:15]
  v_mfma_f32_32x32x16_bf16 v[16:31], v[56:59], a[248:251], v[16:31]
  s_waitcnt lgkmcnt(0)
  v_mfma_f32_32x32x16_bf16 v[0:15], a[124:127], v[60:63], v[0:15]
  v_mfma_f32_32x32x16_bf16 v[16:31], v[60:63], a[252:255], v[16:31]
  s_lshl_b32 s21, s20, 5
  s_add_u32 s21, s21, s17
  s_lshl_b32 s21, s21, 13
  s_add_u32 s22, s21, 20971520
  s_add_u32 s21, s21, 4194304
  s_lshl_b32 s23, s17, 6
  s_add_u32 s23, s23, s20
  s_lshl_b32 s23, s23, 2
  s_add_u32 s23, s23, 8192
  v_xor_b32 v127, 32768, v127
  s_xor_b32 s35, s35, 98304
  s_nop 7
  v_cvt_pk_bf16_f32 v64, v0, v1
  v_cvt_pk_bf16_f32 v65, v2, v3
  v_cvt_pk_bf16_f32 v66, v4, v5
  v_cvt_pk_bf16_f32 v67, v6, v7
  v_cvt_pk_bf16_f32 v68, v8, v9
  v_cvt_pk_bf16_f32 v69, v10, v11
  v_cvt_pk_bf16_f32 v70, v12, v13
  v_cvt_pk_bf16_f32 v71, v14, v15
  v_cvt_pk_bf16_f32 v72, v16, v17
  v_cvt_pk_bf16_f32 v73, v18, v19
  v_cvt_pk_bf16_f32 v74, v24, v25
  v_cvt_pk_bf16_f32 v75, v26, v27
  v_cvt_pk_bf16_f32 v76, v20, v21
  v_cvt_pk_bf16_f32 v77, v22, v23
  v_cvt_pk_bf16_f32 v78, v28, v29
  v_cvt_pk_bf16_f32 v79, v30, v31
  s_waitcnt vmcnt(0)
  s_barrier
  s_cmp_eq_u32 s76, 0
  s_cselect_b32 s80, 1, s18
  s_cmp_lg_u32 s80, 0
  s_cbranch_scc1 w1pf_32
  v_mov_b32 v80, 1
  s_mov_b64 exec, 1
  buffer_store_dword v80, off, s[4:7], s76 sc1
  s_mov_b64 exec, -1
w1pf_32:
  buffer_store_dwordx4 v[64:67], v126, s[4:7], s21 offen sc1
  buffer_store_dwordx4 v[68:71], v126, s[4:7], s21 offen offset:512 sc1
  buffer_store_dwordx4 v[72:75], v120, s[4:7], s22 offen sc1
  buffer_store_dwordx4 v[76:79], v120, s[4:7], s22 offen offset:512 sc1
  s_mov_b32 s76, s23
  ds_read_b64_tr_b16 v[192:193], v114 offset:0
  ds_read_b64_tr_b16 v[194:195], v114 offset:256
  ds_read_b64_tr_b16 v[196:197], v114 offset:1024
  ds_read_b64_tr_b16 v[198:199], v114 offset:1280
  ds_read_b64_tr_b16 v[200:201], v114 offset:2048
  ds_read_b64_tr_b16 v[202:203], v114 offset:2304
  ds_read_b64_tr_b16 v[204:205], v114 offset:3072
  ds_read_b64_tr_b16 v[206:207], v114 offset:3328
  ds_read_b64_tr_b16 v[208:209], v114 offset:4096
  ds_read_b64_tr_b16 v[210:211], v114 offset:4352
  ds_read_b64_tr_b16 v[212:213], v114 offset:5120
  ds_read_b64_tr_b16 v[214:215], v114 offset:5376
  ds_read_b64_tr_b16 v[216:217], v114 offset:6144
  ds_read_b64_tr_b16 v[218:219], v114 offset:6400
  ds_read_b64_tr_b16 v[220:221], v114 offset:7168
  ds_read_b64_tr_b16 v[222:223], v114 offset:7424
  s_waitcnt lgkmcnt(0)
  s_add_u32 s20, s20, 7
  s_add_u32 s24, s20, 7
  s_cmp_ge_u32 s24, 64
  s_cbranch_scc1 w1nopf_33
  s_lshl_b32 s23, s24, 15
  s_add_u32 s23, s23, 1048576
  s_lshl_b32 s21, s18, 13
  s_add_u32 s22, s21, s23
  s_add_u32 s21, s21, s35
  s_add_u32 m0, s21, 0
  s_add_u32 s80, s22, 0
  buffer_load_dwordx4 v113, s[4:7], s80 offen offset:0 sc1 lds
  buffer_load_dwordx4 v113, s[4:7], s80 offen offset:1024 sc1 lds
  buffer_load_dwordx4 v113, s[4:7], s80 offen offset:2048 sc1 lds
  buffer_load_dwordx4 v113, s[4:7], s80 offen offset:3072 sc1 lds
  s_add_u32 m0, s21, 4096
  s_add_u32 s80, s22, 4096
  buffer_load_dwordx4 v113, s[4:7], s80 offen offset:0 sc1 lds
  buffer_load_dwordx4 v113, s[4:7], s80 offen offset:1024 sc1 lds
  buffer_load_dwordx4 v113, s[4:7], s80 offen offset:2048 sc1 lds
  buffer_load_dwordx4 v113, s[4:7], s80 offen offset:3072 sc1 lds
w1nopf_33:
  ds_read_b128 v[32:35], v127 offset:32768
  ds_read_b128 v[36:39], v127 offset:33792
  ds_read_b128 v[40:43], v127 offset:34816
  ds_read_b128 v[44:47], v127 offset:35840
  ds_read_b128 v[48:51], v127 offset:36864
  ds_read_b128 v[52:55], v127 offset:37888
  ds_read_b128 v[56:59], v127 offset:38912
  ds_read_b128 v[60:63], v127 offset:39936
  s_waitcnt lgkmcnt(7)
  v_mfma_f32_32x32x16_bf16 v[0:15], a[0:3], v[32:35], 0
  s_add_u32 m0, s32, 8192
  s_add_u32 s80, s69, 131072
  buffer_load_dwordx4 v101, s[28:31], s80 offen  lds
  v_mfma_f32_32x32x16_bf16 v[16:31], v[32:35], a[128:131], 0
  ds_read_b128 v[32:35], v127 offset:40960
  s_waitcnt lgkmcnt(7)
  v_mfma_f32_32x32x16_bf16 v[0:15], a[4:7], v[36:39], v[0:15]
  v_mfma_f32_32x32x16_bf16 v[16:31], v[36:39], a[132:135], v[16:31]
  ds_read_b128 v[36:39], v127 offset:41984
  s_waitcnt lgkmcnt(7)
  v_mfma_f32_32x32x16_bf16 v[0:15], a[8:11], v[40:43], v[0:15]
  s_add_u32 m0, s32, 9216
  s_add_u32 s80, s69, 147456
  buffer_load_dwordx4 v101, s[28:31], s80 offen  lds
  v_mfma_f32_32x32x16_bf16 v[16:31], v[40:43], a[136:139], v[16:31]
  ds_read_b128 v[40:43], v127 offset:43008
  s_waitcnt lgkmcnt(7)
  v_mfma_f32_32x32x16_bf16 v[0:15], a[12:15], v[44:47], v[0:15]
  v_mfma_f32_32x32x16_bf16 v[16:31], v[44:47], a[140:143], v[16:31]
  ds_read_b128 v[44:47], v127 offset:44032
  s_waitcnt lgkmcnt(7)
  v_mfma_f32_32x32x16_bf16 v[0:15], a[16:19], v[48:51], v[0:15]
  s_add_u32 m0, s32, 10240
  s_add_u32 s80, s69, 163840
  buffer_load_dwordx4 v101, s[28:31], s80 offen  lds
  v_mfma_f32_32x32x16_bf16 v[16:31], v[48:51], a[144:147], v[16:31]
  ds_read_b128 v[48:51], v127 offset:45056
  s_waitcnt lgkmcnt(7)
  v_mfma_f32_32x32x16_bf16 v[0:15], a[20:23], v[52:55], v[0:15]
  v_mfma_f32_32x32x16_bf16 v[16:31], v[52:55], a[148:151], v[16:31]
  ds_read_b128 v[52:55], v127 offset:46080
  s_waitcnt lgkmcnt(7)
  v_mfma_f32_32x32x16_bf16 v[0:15], a[24:27], v[56:59], v[0:15]
  s_add_u32 m0, s32, 11264
  s_add_u32 s80, s69, 180224
  buffer_load_dwordx4 v101, s[28:31], s80 offen  lds
  v_mfma_f32_32x32x16_bf16 v[16:31], v[56:59], a[152:155], v[16:31]
  ds_read_b128 v[56:59], v127 offset:47104
  s_waitcnt lgkmcnt(7)
  v_mfma_f32_32x32x16_bf16 v[0:15], a[28:31], v[60:63], v[0:15]
  v_mfma_f32_32x32x16_bf16 v[16:31], v[60:63], a[156:159], v[16:31]
  ds_read_b128 v[60:63], v127 offset:48128
  s_waitcnt lgkmcnt(7)
  v_mfma_f32_32x32x16_bf16 v[0:15], a[32:35], v[32:35], v[0:15]
  s_add_u32 m0, s32, 12288
  s_add_u32 s80, s69, 196608
  buffer_load_dwordx4 v101, s[28:31], s80 offen  lds
  v_mfma_f32_32x32x16_bf16 v[16:31], v[32:35], a[160:163], v[16:31]
  ds_read_b128 v[32:35], v127 offset:49152
  s_waitcnt lgkmcnt(7)
  v_mfma_f32_32x32x16_bf16 v[0:15], a[36:39], v[36:39], v[0:15]
  v_mfma_f32_32x32x16_bf16 v[16:31], v[36:39], a[164:167], v[16:31]
  ds_read_b128 v[36:39], v127 offset:50176
  s_waitcnt lgkmcnt(7)
  v_mfma_f32_32x32x16_bf16 v[0:15], a[40:43], v[40:43], v[0:15]
  s_add_u32 m0, s32, 13312
  s_add_u32 s80, s69, 212992
  buffer_load_dwordx4 v101, s[28:31], s80 offen  lds
  v_mfma_f32_32x32x16_bf16 v[16:31], v[40:43], a[168:171], v[16:31]
  ds_read_b128 v[40:43], v127 offset:51200
  s_waitcnt lgkmcnt(7)
  v_mfma_f32_32x32x16_bf16 v[0:15], a[44:47], v[44:47], v[0:15]
  v_mfma_f32_32x32x16_bf16 v[16:31], v[44:47], a[172:175], v[16:31]
  ds_read_b128 v[44:47], v127 offset:52224
  s_waitcnt lgkmcnt(7)
  v_mfma_f32_32x32x16_bf16 v[0:15], a[48:51], v[48:51], v[0:15]
  s_add_u32 m0, s32, 14336
  s_add_u32 s80, s69, 229376
  buffer_load_dwordx4 v101, s[28:31], s80 offen  lds
  v_mfma_f32_32x32x16_bf16 v[16:31], v[48:51], a[176:179], v[16:31]
  ds_read_b128 v[48:51], v127 offset:53248
  s_waitcnt lgkmcnt(7)
  v_mfma_f32_32x32x16_bf16 v[0:15], a[52:55], v[52:55], v[0:15]
  v_mfma_f32_32x32x16_bf16 v[16:31], v[52:55], a[180:183], v[16:31]
  ds_read_b128 v[52:55], v127 offset:54272
  s_waitcnt lgkmcnt(7)
  v_mfma_f32_32x32x16_bf16 v[0:15], a[56:59], v[56:59], v[0:15]
  s_add_u32 m0, s32, 15360
  s_add_u32 s80, s69, 245760
  buffer_load_dwordx4 v101, s[28:31], s80 offen  lds
  v_mfma_f32_32x32x16_bf16 v[16:31], v[56:59], a[184:187], v[16:31]
  ds_read_b128 v[56:59], v127 offset:55296
  s_waitcnt lgkmcnt(7)
  v_mfma_f32_32x32x16_bf16 v[0:15], a[60:63], v[60:63], v[0:15]
  v_mfma_f32_32x32x16_bf16 v[16:31], v[60:63], a[188:191], v[16:31]
  ds_read_b128 v[60:63], v127 offset:56320
  s_waitcnt lgkmcnt(7)
  v_mfma_f32_32x32x16_bf16 v[0:15], a[64:67], v[32:35], v[0:15]
  v_mfma_f32_32x32x16_bf16 v[16:31], v[32:35], a[192:195], v[16:31]
  ds_read_b128 v[32:35], v127 offset:57344
  s_waitcnt lgkmcnt(7)
  v_mfma_f32_32x32x16_bf16 v[0:15], a[68:71], v[36:39], v[0:15]
  v_mfma_f32_32x32x16_bf16 v[16:31], v[36:39], a[196:199], v[16:31]
  ds_read_b128 v[36:39], v127 offset:58368
  s_waitcnt lgkmcnt(7)
  v_mfma_f32_32x32x16_bf16 v[0:15], a[72:75], v[40:43], v[0:15]
  v_mfma_f32_32x32x16_bf16 v[16:31], v[40:43], a[200:203], v[16:31]
  ds_read_b128 v[40:43], v127 offset:59392
  s_waitcnt lgkmcnt(7)
  v_mfma_f32_32x32x16_bf16 v[0:15], a[76:79], v[44:47], v[0:15]
  v_mfma_f32_32x32x16_bf16 v[16:31], v[44:47], a[204:207], v[16:31]
  ds_read_b128 v[44:47], v127 offset:60416
  s_waitcnt lgkmcnt(7)
  v_mfma_f32_32x32x16_bf16 v[0:15], a[80:83], v[48:51], v[0:15]
  v_mfma_f32_32x32x16_bf16 v[16:31], v[48:51], a[208:211], v[16:31]
  ds_read_b128 v[48:51], v127 offset:61440
  s_waitcnt lgkmcnt(7)
  v_mfma_f32_32x32x16_bf16 v[0:15], a[84:87], v[52:55], v[0:15]
  v_mfma_f32_32x32x16_bf16 v[16:31], v[52:55], a[212:215], v[16:31]
  ds_read_b128 v[52:55], v127 offset:62464
  s_waitcnt lgkmcnt(7)
  v_mfma_f32_32x32x16_bf16 v[0:15], a[88:91], v[56:59], v[0:15]
  v_mfma_f32_32x32x16_bf16 v[16:31], v[56:59], a[216:219], v[16:31]
  ds_read_b128 v[56:59], v127 offset:63488
  s_waitcnt lgkmcnt(7)
  v_mfma_f32_32x32x16_bf16 v[0:15], a[92:95], v[60:63], v[0:15]
  v_mfma_f32_32x32x16_bf16 v[16:31], v[60:63], a[220:223], v[16:31]
  ds_read_b128 v[60:63], v127 offset:64512
  s_waitcnt lgkmcnt(7)
  v_mfma_f32_32x32x16_bf16 v[0:15], a[96:99], v[32:35], v[0:15]
  v_mfma_f32_32x32x16_bf16 v[16:31], v[32:35], a[224:227], v[16:31]
  s_waitcnt lgkmcnt(6)
  v_mfma_f32_32x32x16_bf16 v[0:15], a[100:103], v[36:39], v[0:15]
  v_mfma_f32_32x32x16_bf16 v[16:31], v[36:39], a[228:231], v[16:31]
  s_waitcnt lgkmcnt(5)
  v_mfma_f32_32x32x16_bf16 v[0:15], a[104:107], v[40:43], v[0:15]
  v_mfma_f32_32x32x16_bf16 v[16:31], v[40:43], a[232:235], v[16:31]
  s_waitcnt lgkmcnt(4)
  v_mfma_f32_32x32x16_bf16 v[0:15], a[108:111], v[44:47], v[0:15]
  v_mfma_f32_32x32x16_bf16 v[16:31], v[44:47], a[236:239], v[16:31]
  s_waitcnt lgkmcnt(3)
  v_mfma_f32_32x32x16_bf16 v[0:15], a[112:115], v[48:51], v[0:15]
  v_mfma_f32_32x32x16_bf16 v[16:31], v[48:51], a[240:243], v[16:31]
  s_waitcnt lgkmcnt(2)
  v_mfma_f32_32x32x16_bf16 v[0:15], a[116:119], v[52:55], v[0:15]
  v_mfma_f32_32x32x16_bf16 v[16:31], v[52:55], a[244:247], v[16:31]
  s_waitcnt lgkmcnt(1)
  v_mfma_f32_32x32x16_bf16 v[0:15], a[120:123], v[56:59], v[0:15]
  v_mfma_f32_32x32x16_bf16 v[16:31], v[56:59], a[248:251], v[16:31]
  s_waitcnt lgkmcnt(0)
  v_mfma_f32_32x32x16_bf16 v[0:15], a[124:127], v[60:63], v[0:15]
  v_mfma_f32_32x32x16_bf16 v[16:31], v[60:63], a[252:255], v[16:31]
  s_lshl_b32 s21, s20, 5
  s_add_u32 s21, s21, s17
  s_lshl_b32 s21, s21, 13
  s_add_u32 s22, s21, 20971520
  s_add_u32 s21, s21, 4194304
  s_lshl_b32 s23, s17, 6
  s_add_u32 s23, s23, s20
  s_lshl_b32 s23, s23, 2
  s_add_u32 s23, s23, 8192
  v_xor_b32 v127, 32768, v127
  s_xor_b32 s35, s35, 98304
  s_nop 7
  v_cvt_pk_bf16_f32 v64, v0, v1
  v_cvt_pk_bf16_f32 v65, v2, v3
  v_cvt_pk_bf16_f32 v66, v4, v5
  v_cvt_pk_bf16_f32 v67, v6, v7
  v_cvt_pk_bf16_f32 v68, v8, v9
  v_cvt_pk_bf16_f32 v69, v10, v11
  v_cvt_pk_bf16_f32 v70, v12, v13
  v_cvt_pk_bf16_f32 v71, v14, v15
  v_cvt_pk_bf16_f32 v72, v16, v17
  v_cvt_pk_bf16_f32 v73, v18, v19
  v_cvt_pk_bf16_f32 v74, v24, v25
  v_cvt_pk_bf16_f32 v75, v26, v27
  v_cvt_pk_bf16_f32 v76, v20, v21
  v_cvt_pk_bf16_f32 v77, v22, v23
  v_cvt_pk_bf16_f32 v78, v28, v29
  v_cvt_pk_bf16_f32 v79, v30, v31
  s_waitcnt vmcnt(0)
  s_barrier
  s_cmp_eq_u32 s76, 0
  s_cselect_b32 s80, 1, s18
  s_cmp_lg_u32 s80, 0
  s_cbranch_scc1 w1pf_34
  v_mov_b32 v80, 1
  s_mov_b64 exec, 1
  buffer_store_dword v80, off, s[4:7], s76 sc1
  s_mov_b64 exec, -1
w1pf_34:
  buffer_store_dwordx4 v[64:67], v126, s[4:7], s21 offen sc1
  buffer_store_dwordx4 v[68:71], v126, s[4:7], s21 offen offset:512 sc1
  buffer_store_dwordx4 v[72:75], v120, s[4:7], s22 offen sc1
  buffer_store_dwordx4 v[76:79], v120, s[4:7], s22 offen offset:512 sc1
  s_mov_b32 s76, s23
  ds_read_b64_tr_b16 v[224:225], v114 offset:8192
  ds_read_b64_tr_b16 v[226:227], v114 offset:8448
  ds_read_b64_tr_b16 v[228:229], v114 offset:9216
  ds_read_b64_tr_b16 v[230:231], v114 offset:9472
  ds_read_b64_tr_b16 v[232:233], v114 offset:10240
  ds_read_b64_tr_b16 v[234:235], v114 offset:10496
  ds_read_b64_tr_b16 v[236:237], v114 offset:11264
  ds_read_b64_tr_b16 v[238:239], v114 offset:11520
  ds_read_b64_tr_b16 v[240:241], v114 offset:12288
  ds_read_b64_tr_b16 v[242:243], v114 offset:12544
  ds_read_b64_tr_b16 v[244:245], v114 offset:13312
  ds_read_b64_tr_b16 v[246:247], v114 offset:13568
  ds_read_b64_tr_b16 v[248:249], v114 offset:14336
  ds_read_b64_tr_b16 v[250:251], v114 offset:14592
  ds_read_b64_tr_b16 v[252:253], v114 offset:15360
  ds_read_b64_tr_b16 v[254:255], v114 offset:15616
  s_waitcnt lgkmcnt(0)
  s_add_u32 s20, s20, 7
  s_add_u32 s24, s20, 7
  s_cmp_ge_u32 s24, 64
  s_cbranch_scc1 w1nopf_35
  s_lshl_b32 s23, s24, 15
  s_add_u32 s23, s23, 1048576
  s_lshl_b32 s21, s18, 13
  s_add_u32 s22, s21, s23
  s_add_u32 s21, s21, s35
  s_add_u32 m0, s21, 0
  s_add_u32 s80, s22, 0
  buffer_load_dwordx4 v113, s[4:7], s80 offen offset:0 sc1 lds
  buffer_load_dwordx4 v113, s[4:7], s80 offen offset:1024 sc1 lds
  buffer_load_dwordx4 v113, s[4:7], s80 offen offset:2048 sc1 lds
  buffer_load_dwordx4 v113, s[4:7], s80 offen offset:3072 sc1 lds
  s_add_u32 m0, s21, 4096
  s_add_u32 s80, s22, 4096
  buffer_load_dwordx4 v113, s[4:7], s80 offen offset:0 sc1 lds
  buffer_load_dwordx4 v113, s[4:7], s80 offen offset:1024 sc1 lds
  buffer_load_dwordx4 v113, s[4:7], s80 offen offset:2048 sc1 lds
  buffer_load_dwordx4 v113, s[4:7], s80 offen offset:3072 sc1 lds
w1nopf_35:
  ds_read_b128 v[32:35], v127 offset:32768
  ds_read_b128 v[36:39], v127 offset:33792
  ds_read_b128 v[40:43], v127 offset:34816
  ds_read_b128 v[44:47], v127 offset:35840
  ds_read_b128 v[48:51], v127 offset:36864
  ds_read_b128 v[52:55], v127 offset:37888
  ds_read_b128 v[56:59], v127 offset:38912
  ds_read_b128 v[60:63], v127 offset:39936
  s_waitcnt lgkmcnt(7)
  v_mfma_f32_32x32x16_bf16 v[0:15], a[0:3], v[32:35], 0
  s_mov_b32 s28, s36
  s_mov_b32 s29, s37
  s_mov_b32 s30, 0x400000
  s_add_u32 m0, s32, 0
  s_mov_b32 s80, 0
  buffer_load_dwordx4 v100, s[28:31], s80 offen  lds
  v_mfma_f32_32x32x16_bf16 v[16:31], v[32:35], a[128:131], 0
  ds_read_b128 v[32:35], v127 offset:40960
  s_waitcnt lgkmcnt(7)
  v_mfma_f32_32x32x16_bf16 v[0:15], a[4:7], v[36:39], v[0:15]
  v_mfma_f32_32x32x16_bf16 v[16:31], v[36:39], a[132:135], v[16:31]
  ds_read_b128 v[36:39], v127 offset:41984
  s_waitcnt lgkmcnt(7)
  v_mfma_f32_32x32x16_bf16 v[0:15], a[8:11], v[40:43], v[0:15]
  s_add_u32 m0, s32, 1024
  s_mov_b32 s80, 131072
  buffer_load_dwordx4 v100, s[28:31], s80 offen  lds
  v_mfma_f32_32x32x16_bf16 v[16:31], v[40:43], a[136:139], v[16:31]
  ds_read_b128 v[40:43], v127 offset:43008
  s_waitcnt lgkmcnt(7)
  v_mfma_f32_32x32x16_bf16 v[0:15], a[12:15], v[44:47], v[0:15]
  v_mfma_f32_32x32x16_bf16 v[16:31], v[44:47], a[140:143], v[16:31]
  ds_read_b128 v[44:47], v127 offset:44032
  s_waitcnt lgkmcnt(7)
  v_mfma_f32_32x32x16_bf16 v[0:15], a[16:19], v[48:51], v[0:15]
  s_add_u32 m0, s32, 2048
  s_mov_b32 s80, 262144
  buffer_load_dwordx4 v100, s[28:31], s80 offen  lds
  v_mfma_f32_32x32x16_bf16 v[16:31], v[48:51], a[144:147], v[16:31]
  ds_read_b128 v[48:51], v127 offset:45056
  s_waitcnt lgkmcnt(7)
  v_mfma_f32_32x32x16_bf16 v[0:15], a[20:23], v[52:55], v[0:15]
  v_mfma_f32_32x32x16_bf16 v[16:31], v[52:55], a[148:151], v[16:31]
  ds_read_b128 v[52:55], v127 offset:46080
  s_waitcnt lgkmcnt(7)
  v_mfma_f32_32x32x16_bf16 v[0:15], a[24:27], v[56:59], v[0:15]
  s_add_u32 m0, s32, 3072
  s_mov_b32 s80, 393216
  buffer_load_dwordx4 v100, s[28:31], s80 offen  lds
  v_mfma_f32_32x32x16_bf16 v[16:31], v[56:59], a[152:155], v[16:31]
  ds_read_b128 v[56:59], v127 offset:47104
  s_waitcnt lgkmcnt(7)
  v_mfma_f32_32x32x16_bf16 v[0:15], a[28:31], v[60:63], v[0:15]
  v_mfma_f32_32x32x16_bf16 v[16:31], v[60:63], a[156:159], v[16:31]
  ds_read_b128 v[60:63], v127 offset:48128
  s_waitcnt lgkmcnt(7)
  v_mfma_f32_32x32x16_bf16 v[0:15], a[32:35], v[32:35], v[0:15]
  s_add_u32 m0, s32, 4096
  s_mov_b32 s80, 524288
  buffer_load_dwordx4 v100, s[28:31], s80 offen  lds
  v_mfma_f32_32x32x16_bf16 v[16:31], v[32:35], a[160:163], v[16:31]
  ds_read_b128 v[32:35], v127 offset:49152
  s_waitcnt lgkmcnt(7)
  v_mfma_f32_32x32x16_bf16 v[0:15], a[36:39], v[36:39], v[0:15]
  v_mfma_f32_32x32x16_bf16 v[16:31], v[36:39], a[164:167], v[16:31]
  ds_read_b128 v[36:39], v127 offset:50176
  s_waitcnt lgkmcnt(7)
  v_mfma_f32_32x32x16_bf16 v[0:15], a[40:43], v[40:43], v[0:15]
  s_add_u32 m0, s32, 5120
  s_mov_b32 s80, 655360
  buffer_load_dwordx4 v100, s[28:31], s80 offen  lds
  v_mfma_f32_32x32x16_bf16 v[16:31], v[40:43], a[168:171], v[16:31]
  ds_read_b128 v[40:43], v127 offset:51200
  s_waitcnt lgkmcnt(7)
  v_mfma_f32_32x32x16_bf16 v[0:15], a[44:47], v[44:47], v[0:15]
  v_mfma_f32_32x32x16_bf16 v[16:31], v[44:47], a[172:175], v[16:31]
  ds_read_b128 v[44:47], v127 offset:52224
  s_waitcnt lgkmcnt(7)
  v_mfma_f32_32x32x16_bf16 v[0:15], a[48:51], v[48:51], v[0:15]
  s_add_u32 m0, s32, 6144
  s_mov_b32 s80, 786432
  buffer_load_dwordx4 v100, s[28:31], s80 offen  lds
  v_mfma_f32_32x32x16_bf16 v[16:31], v[48:51], a[176:179], v[16:31]
  ds_read_b128 v[48:51], v127 offset:53248
  s_waitcnt lgkmcnt(7)
  v_mfma_f32_32x32x16_bf16 v[0:15], a[52:55], v[52:55], v[0:15]
  v_mfma_f32_32x32x16_bf16 v[16:31], v[52:55], a[180:183], v[16:31]
  ds_read_b128 v[52:55], v127 offset:54272
  s_waitcnt lgkmcnt(7)
  v_mfma_f32_32x32x16_bf16 v[0:15], a[56:59], v[56:59], v[0:15]
  s_add_u32 m0, s32, 7168
  s_mov_b32 s80, 917504
  buffer_load_dwordx4 v100, s[28:31], s80 offen  lds
  v_mfma_f32_32x32x16_bf16 v[16:31], v[56:59], a[184:187], v[16:31]
  ds_read_b128 v[56:59], v127 offset:55296
  s_waitcnt lgkmcnt(7)
  v_mfma_f32_32x32x16_bf16 v[0:15], a[60:63], v[60:63], v[0:15]
  v_mfma_f32_32x32x16_bf16 v[16:31], v[60:63], a[188:191], v[16:31]
  ds_read_b128 v[60:63], v127 offset:56320
  s_waitcnt lgkmcnt(7)
  v_mfma_f32_32x32x16_bf16 v[0:15], a[64:67], v[32:35], v[0:15]
  v_mfma_f32_32x32x16_bf16 v[16:31], v[32:35], a[192:195], v[16:31]
  ds_read_b128 v[32:35], v127 offset:57344
  s_waitcnt lgkmcnt(7)
  v_mfma_f32_32x32x16_bf16 v[0:15], a[68:71], v[36:39], v[0:15]
  v_mfma_f32_32x32x16_bf16 v[16:31], v[36:39], a[196:199], v[16:31]
  ds_read_b128 v[36:39], v127 offset:58368
  s_waitcnt lgkmcnt(7)
  v_mfma_f32_32x32x16_bf16 v[0:15], a[72:75], v[40:43], v[0:15]
  v_mfma_f32_32x32x16_bf16 v[16:31], v[40:43], a[200:203], v[16:31]
  ds_read_b128 v[40:43], v127 offset:59392
  s_waitcnt lgkmcnt(7)
  v_mfma_f32_32x32x16_bf16 v[0:15], a[76:79], v[44:47], v[0:15]
  v_mfma_f32_32x32x16_bf16 v[16:31], v[44:47], a[204:207], v[16:31]
  ds_read_b128 v[44:47], v127 offset:60416
  s_waitcnt lgkmcnt(7)
  v_mfma_f32_32x32x16_bf16 v[0:15], a[80:83], v[48:51], v[0:15]
  v_mfma_f32_32x32x16_bf16 v[16:31], v[48:51], a[208:211], v[16:31]
  ds_read_b128 v[48:51], v127 offset:61440
  s_waitcnt lgkmcnt(7)
  v_mfma_f32_32x32x16_bf16 v[0:15], a[84:87], v[52:55], v[0:15]
  v_mfma_f32_32x32x16_bf16 v[16:31], v[52:55], a[212:215], v[16:31]
  ds_read_b128 v[52:55], v127 offset:62464
  s_waitcnt lgkmcnt(7)
  v_mfma_f32_32x32x16_bf16 v[0:15], a[88:91], v[56:59], v[0:15]
  v_mfma_f32_32x32x16_bf16 v[16:31], v[56:59], a[216:219], v[16:31]
  ds_read_b128 v[56:59], v127 offset:63488
  s_waitcnt lgkmcnt(7)
  v_mfma_f32_32x32x16_bf16 v[0:15], a[92:95], v[60:63], v[0:15]
  v_mfma_f32_32x32x16_bf16 v[16:31], v[60:63], a[220:223], v[16:31]
  ds_read_b128 v[60:63], v127 offset:64512
  s_waitcnt lgkmcnt(7)
  v_mfma_f32_32x32x16_bf16 v[0:15], a[96:99], v[32:35], v[0:15]
  v_mfma_f32_32x32x16_bf16 v[16:31], v[32:35], a[224:227], v[16:31]
  s_waitcnt lgkmcnt(6)
  v_mfma_f32_32x32x16_bf16 v[0:15], a[100:103], v[36:39], v[0:15]
  v_mfma_f32_32x32x16_bf16 v[16:31], v[36:39], a[228:231], v[16:31]
  s_waitcnt lgkmcnt(5)
  v_mfma_f32_32x32x16_bf16 v[0:15], a[104:107], v[40:43], v[0:15]
  v_mfma_f32_32x32x16_bf16 v[16:31], v[40:43], a[232:235], v[16:31]
  s_waitcnt lgkmcnt(4)
  v_mfma_f32_32x32x16_bf16 v[0:15], a[108:111], v[44:47], v[0:15]
  v_mfma_f32_32x32x16_bf16 v[16:31], v[44:47], a[236:239], v[16:31]
  s_waitcnt lgkmcnt(3)
  v_mfma_f32_32x32x16_bf16 v[0:15], a[112:115], v[48:51], v[0:15]
  v_mfma_f32_32x32x16_bf16 v[16:31], v[48:51], a[240:243], v[16:31]
  s_waitcnt lgkmcnt(2)
  v_mfma_f32_32x32x16_bf16 v[0:15], a[116:119], v[52:55], v[0:15]
  v_mfma_f32_32x32x16_bf16 v[16:31], v[52:55], a[244:247], v[16:31]
  s_waitcnt lgkmcnt(1)
  v_mfma_f32_32x32x16_bf16 v[0:15], a[120:123], v[56:59], v[0:15]
  v_mfma_f32_32x32x16_bf16 v[16:31], v[56:59], a[248:251], v[16:31]
  s_waitcnt lgkmcnt(0)
  v_mfma_f32_32x32x16_bf16 v[0:15], a[124:127], v[60:63], v[0:15]
  v_mfma_f32_32x32x16_bf16 v[16:31], v[60:63], a[252:255], v[16:31]
  s_lshl_b32 s21, s20, 5
  s_add_u32 s21, s21, s17
  s_lshl_b32 s21, s21, 13
  s_add_u32 s22, s21, 20971520
  s_add_u32 s21, s21, 4194304
  s_lshl_b32 s23, s17, 6
  s_add_u32 s23, s23, s20
  s_lshl_b32 s23, s23, 2
  s_add_u32 s23, s23, 8192
  v_xor_b32 v127, 32768, v127
  s_xor_b32 s35, s35, 98304
  s_nop 7
  v_cvt_pk_bf16_f32 v64, v0, v1
  v_cvt_pk_bf16_f32 v65, v2, v3
  v_cvt_pk_bf16_f32 v66, v4, v5
  v_cvt_pk_bf16_f32 v67, v6, v7
  v_cvt_pk_bf16_f32 v68, v8, v9
  v_cvt_pk_bf16_f32 v69, v10, v11
  v_cvt_pk_bf16_f32 v70, v12, v13
  v_cvt_pk_bf16_f32 v71, v14, v15
  v_cvt_pk_bf16_f32 v72, v16, v17
  v_cvt_pk_bf16_f32 v73, v18, v19
  v_cvt_pk_bf16_f32 v74, v24, v25
  v_cvt_pk_bf16_f32 v75, v26, v27
  v_cvt_pk_bf16_f32 v76, v20, v21
  v_cvt_pk_bf16_f32 v77, v22, v23
  v_cvt_pk_bf16_f32 v78, v28, v29
  v_cvt_pk_bf16_f32 v79, v30, v31
  s_waitcnt vmcnt(0)
  s_barrier
  s_cmp_eq_u32 s76, 0
  s_cselect_b32 s80, 1, s18
  s_cmp_lg_u32 s80, 0
  s_cbranch_scc1 w1pf_36
  v_mov_b32 v80, 1
  s_mov_b64 exec, 1
  buffer_store_dword v80, off, s[4:7], s76 sc1
  s_mov_b64 exec, -1
w1pf_36:
  buffer_store_dwordx4 v[64:67], v126, s[4:7], s21 offen sc1
  buffer_store_dwordx4 v[68:71], v126, s[4:7], s21 offen offset:512 sc1
  buffer_store_dwordx4 v[72:75], v120, s[4:7], s22 offen sc1
  buffer_store_dwordx4 v[76:79], v120, s[4:7], s22 offen offset:512 sc1
  s_mov_b32 s76, s23
  s_add_u32 s20, s20, 7
  s_add_u32 s24, s20, 7
  s_cmp_ge_u32 s24, 64
  s_cbranch_scc1 w1nopf_37
  s_lshl_b32 s23, s24, 15
  s_add_u32 s23, s23, 1048576
  s_lshl_b32 s21, s18, 13
  s_add_u32 s22, s21, s23
  s_add_u32 s21, s21, s35
  s_add_u32 m0, s21, 0
  s_add_u32 s80, s22, 0
  buffer_load_dwordx4 v113, s[4:7], s80 offen offset:0 sc1 lds
  buffer_load_dwordx4 v113, s[4:7], s80 offen offset:1024 sc1 lds
  buffer_load_dwordx4 v113, s[4:7], s80 offen offset:2048 sc1 lds
  buffer_load_dwordx4 v113, s[4:7], s80 offen offset:3072 sc1 lds
  s_add_u32 m0, s21, 4096
  s_add_u32 s80, s22, 4096
  buffer_load_dwordx4 v113, s[4:7], s80 offen offset:0 sc1 lds
  buffer_load_dwordx4 v113, s[4:7], s80 offen offset:1024 sc1 lds
  buffer_load_dwordx4 v113, s[4:7], s80 offen offset:2048 sc1 lds
  buffer_load_dwordx4 v113, s[4:7], s80 offen offset:3072 sc1 lds
w1nopf_37:
  ds_read_b128 v[32:35], v127 offset:32768
  ds_read_b128 v[36:39], v127 offset:33792
  ds_read_b128 v[40:43], v127 offset:34816
  ds_read_b128 v[44:47], v127 offset:35840
  ds_read_b128 v[48:51], v127 offset:36864
  ds_read_b128 v[52:55], v127 offset:37888
  ds_read_b128 v[56:59], v127 offset:38912
  ds_read_b128 v[60:63], v127 offset:39936
  s_waitcnt lgkmcnt(7)
  v_mfma_f32_32x32x16_bf16 v[0:15], a[0:3], v[32:35], 0
  s_add_u32 m0, s32, 8192
  s_mov_b32 s80, 1048576
  buffer_load_dwordx4 v100, s[28:31], s80 offen  lds
  v_mfma_f32_32x32x16_bf16 v[16:31], v[32:35], a[128:131], 0
  ds_read_b128 v[32:35], v127 offset:40960
  s_waitcnt lgkmcnt(7)
  v_mfma_f32_32x32x16_bf16 v[0:15], a[4:7], v[36:39], v[0:15]
  v_mfma_f32_32x32x16_bf16 v[16:31], v[36:39], a[132:135], v[16:31]
  ds_read_b128 v[36:39], v127 offset:41984
  s_waitcnt lgkmcnt(7)
  v_mfma_f32_32x32x16_bf16 v[0:15], a[8:11], v[40:43], v[0:15]
  s_add_u32 m0, s32, 9216
  s_mov_b32 s80, 1179648
  buffer_load_dwordx4 v100, s[28:31], s80 offen  lds
  v_mfma_f32_32x32x16_bf16 v[16:31], v[40:43], a[136:139], v[16:31]
  ds_read_b128 v[40:43], v127 offset:43008
  s_waitcnt lgkmcnt(7)
  v_mfma_f32_32x32x16_bf16 v[0:15], a[12:15], v[44:47], v[0:15]
  v_mfma_f32_32x32x16_bf16 v[16:31], v[44:47], a[140:143], v[16:31]
  ds_read_b128 v[44:47], v127 offset:44032
  s_waitcnt lgkmcnt(7)
  v_mfma_f32_32x32x16_bf16 v[0:15], a[16:19], v[48:51], v[0:15]
  s_add_u32 m0, s32, 10240
  s_mov_b32 s80, 1310720
  buffer_load_dwordx4 v100, s[28:31], s80 offen  lds
  v_mfma_f32_32x32x16_bf16 v[16:31], v[48:51], a[144:147], v[16:31]
  ds_read_b128 v[48:51], v127 offset:45056
  s_waitcnt lgkmcnt(7)
  v_mfma_f32_32x32x16_bf16 v[0:15], a[20:23], v[52:55], v[0:15]
  v_mfma_f32_32x32x16_bf16 v[16:31], v[52:55], a[148:151], v[16:31]
  ds_read_b128 v[52:55], v127 offset:46080
  s_waitcnt lgkmcnt(7)
  v_mfma_f32_32x32x16_bf16 v[0:15], a[24:27], v[56:59], v[0:15]
  s_add_u32 m0, s32, 11264
  s_mov_b32 s80, 1441792
  buffer_load_dwordx4 v100, s[28:31], s80 offen  lds
  v_mfma_f32_32x32x16_bf16 v[16:31], v[56:59], a[152:155], v[16:31]
  ds_read_b128 v[56:59], v127 offset:47104
  s_waitcnt lgkmcnt(7)
  v_mfma_f32_32x32x16_bf16 v[0:15], a[28:31], v[60:63], v[0:15]
  v_mfma_f32_32x32x16_bf16 v[16:31], v[60:63], a[156:159], v[16:31]
  ds_read_b128 v[60:63], v127 offset:48128
  s_waitcnt lgkmcnt(7)
  v_mfma_f32_32x32x16_bf16 v[0:15], a[32:35], v[32:35], v[0:15]
  s_add_u32 m0, s32, 12288
  s_mov_b32 s80, 1572864
  buffer_load_dwordx4 v100, s[28:31], s80 offen  lds
  v_mfma_f32_32x32x16_bf16 v[16:31], v[32:35], a[160:163], v[16:31]
  ds_read_b128 v[32:35], v127 offset:49152
  s_waitcnt lgkmcnt(7)
  v_mfma_f32_32x32x16_bf16 v[0:15], a[36:39], v[36:39], v[0:15]
  v_mfma_f32_32x32x16_bf16 v[16:31], v[36:39], a[164:167], v[16:31]
  ds_read_b128 v[36:39], v127 offset:50176
  s_waitcnt lgkmcnt(7)
  v_mfma_f32_32x32x16_bf16 v[0:15], a[40:43], v[40:43], v[0:15]
  s_add_u32 m0, s32, 13312
  s_mov_b32 s80, 1703936
  buffer_load_dwordx4 v100, s[28:31], s80 offen  lds
  v_mfma_f32_32x32x16_bf16 v[16:31], v[40:43], a[168:171], v[16:31]
  ds_read_b128 v[40:43], v127 offset:51200
  s_waitcnt lgkmcnt(7)
  v_mfma_f32_32x32x16_bf16 v[0:15], a[44:47], v[44:47], v[0:15]
  v_mfma_f32_32x32x16_bf16 v[16:31], v[44:47], a[172:175], v[16:31]
  ds_read_b128 v[44:47], v127 offset:52224
  s_waitcnt lgkmcnt(7)
  v_mfma_f32_32x32x16_bf16 v[0:15], a[48:51], v[48:51], v[0:15]
  s_add_u32 m0, s32, 14336
  s_mov_b32 s80, 1835008
  buffer_load_dwordx4 v100, s[28:31], s80 offen  lds
  v_mfma_f32_32x32x16_bf16 v[16:31], v[48:51], a[176:179], v[16:31]
  ds_read_b128 v[48:51], v127 offset:53248
  s_waitcnt lgkmcnt(7)
  v_mfma_f32_32x32x16_bf16 v[0:15], a[52:55], v[52:55], v[0:15]
  v_mfma_f32_32x32x16_bf16 v[16:31], v[52:55], a[180:183], v[16:31]
  ds_read_b128 v[52:55], v127 offset:54272
  s_waitcnt lgkmcnt(7)
  v_mfma_f32_32x32x16_bf16 v[0:15], a[56:59], v[56:59], v[0:15]
  s_add_u32 m0, s32, 15360
  s_mov_b32 s80, 1966080
  buffer_load_dwordx4 v100, s[28:31], s80 offen  lds
  v_mfma_f32_32x32x16_bf16 v[16:31], v[56:59], a[184:187], v[16:31]
  ds_read_b128 v[56:59], v127 offset:55296
  s_waitcnt lgkmcnt(7)
  v_mfma_f32_32x32x16_bf16 v[0:15], a[60:63], v[60:63], v[0:15]
  v_mfma_f32_32x32x16_bf16 v[16:31], v[60:63], a[188:191], v[16:31]
  ds_read_b128 v[60:63], v127 offset:56320
  s_waitcnt lgkmcnt(7)
  v_mfma_f32_32x32x16_bf16 v[0:15], a[64:67], v[32:35], v[0:15]
  v_mfma_f32_32x32x16_bf16 v[16:31], v[32:35], a[192:195], v[16:31]
  ds_read_b128 v[32:35], v127 offset:57344
  s_waitcnt lgkmcnt(7)
  v_mfma_f32_32x32x16_bf16 v[0:15], a[68:71], v[36:39], v[0:15]
  v_mfma_f32_32x32x16_bf16 v[16:31], v[36:39], a[196:199], v[16:31]
  ds_read_b128 v[36:39], v127 offset:58368
  s_waitcnt lgkmcnt(7)
  v_mfma_f32_32x32x16_bf16 v[0:15], a[72:75], v[40:43], v[0:15]
  v_mfma_f32_32x32x16_bf16 v[16:31], v[40:43], a[200:203], v[16:31]
  ds_read_b128 v[40:43], v127 offset:59392
  s_waitcnt lgkmcnt(7)
  v_mfma_f32_32x32x16_bf16 v[0:15], a[76:79], v[44:47], v[0:15]
  v_mfma_f32_32x32x16_bf16 v[16:31], v[44:47], a[204:207], v[16:31]
  ds_read_b128 v[44:47], v127 offset:60416
  s_waitcnt lgkmcnt(7)
  v_mfma_f32_32x32x16_bf16 v[0:15], a[80:83], v[48:51], v[0:15]
  v_mfma_f32_32x32x16_bf16 v[16:31], v[48:51], a[208:211], v[16:31]
  ds_read_b128 v[48:51], v127 offset:61440
  s_waitcnt lgkmcnt(7)
  v_mfma_f32_32x32x16_bf16 v[0:15], a[84:87], v[52:55], v[0:15]
  v_mfma_f32_32x32x16_bf16 v[16:31], v[52:55], a[212:215], v[16:31]
  ds_read_b128 v[52:55], v127 offset:62464
  s_waitcnt lgkmcnt(7)
  v_mfma_f32_32x32x16_bf16 v[0:15], a[88:91], v[56:59], v[0:15]
  v_mfma_f32_32x32x16_bf16 v[16:31], v[56:59], a[216:219], v[16:31]
  ds_read_b128 v[56:59], v127 offset:63488
  s_waitcnt lgkmcnt(7)
  v_mfma_f32_32x32x16_bf16 v[0:15], a[92:95], v[60:63], v[0:15]
  v_mfma_f32_32x32x16_bf16 v[16:31], v[60:63], a[220:223], v[16:31]
  ds_read_b128 v[60:63], v127 offset:64512
  s_waitcnt lgkmcnt(7)
  v_mfma_f32_32x32x16_bf16 v[0:15], a[96:99], v[32:35], v[0:15]
  v_mfma_f32_32x32x16_bf16 v[16:31], v[32:35], a[224:227], v[16:31]
  s_waitcnt lgkmcnt(6)
  v_mfma_f32_32x32x16_bf16 v[0:15], a[100:103], v[36:39], v[0:15]
  v_mfma_f32_32x32x16_bf16 v[16:31], v[36:39], a[228:231], v[16:31]
  s_waitcnt lgkmcnt(5)
  v_mfma_f32_32x32x16_bf16 v[0:15], a[104:107], v[40:43], v[0:15]
  v_mfma_f32_32x32x16_bf16 v[16:31], v[40:43], a[232:235], v[16:31]
  s_waitcnt lgkmcnt(4)
  v_mfma_f32_32x32x16_bf16 v[0:15], a[108:111], v[44:47], v[0:15]
  v_mfma_f32_32x32x16_bf16 v[16:31], v[44:47], a[236:239], v[16:31]
  s_waitcnt lgkmcnt(3)
  v_mfma_f32_32x32x16_bf16 v[0:15], a[112:115], v[48:51], v[0:15]
  v_mfma_f32_32x32x16_bf16 v[16:31], v[48:51], a[240:243], v[16:31]
  s_waitcnt lgkmcnt(2)
  v_mfma_f32_32x32x16_bf16 v[0:15], a[116:119], v[52:55], v[0:15]
  v_mfma_f32_32x32x16_bf16 v[16:31], v[52:55], a[244:247], v[16:31]
  s_waitcnt lgkmcnt(1)
  v_mfma_f32_32x32x16_bf16 v[0:15], a[120:123], v[56:59], v[0:15]
  v_mfma_f32_32x32x16_bf16 v[16:31], v[56:59], a[248:251], v[16:31]
  s_waitcnt lgkmcnt(0)
  v_mfma_f32_32x32x16_bf16 v[0:15], a[124:127], v[60:63], v[0:15]
  v_mfma_f32_32x32x16_bf16 v[16:31], v[60:63], a[252:255], v[16:31]
  s_lshl_b32 s21, s20, 5
  s_add_u32 s21, s21, s17
  s_lshl_b32 s21, s21, 13
  s_add_u32 s22, s21, 20971520
  s_add_u32 s21, s21, 4194304
  s_lshl_b32 s23, s17, 6
  s_add_u32 s23, s23, s20
  s_lshl_b32 s23, s23, 2
  s_add_u32 s23, s23, 8192
  v_xor_b32 v127, 32768, v127
  s_xor_b32 s35, s35, 98304
  s_nop 7
  v_cvt_pk_bf16_f32 v64, v0, v1
  v_cvt_pk_bf16_f32 v65, v2, v3
  v_cvt_pk_bf16_f32 v66, v4, v5
  v_cvt_pk_bf16_f32 v67, v6, v7
  v_cvt_pk_bf16_f32 v68, v8, v9
  v_cvt_pk_bf16_f32 v69, v10, v11
  v_cvt_pk_bf16_f32 v70, v12, v13
  v_cvt_pk_bf16_f32 v71, v14, v15
  v_cvt_pk_bf16_f32 v72, v16, v17
  v_cvt_pk_bf16_f32 v73, v18, v19
  v_cvt_pk_bf16_f32 v74, v24, v25
  v_cvt_pk_bf16_f32 v75, v26, v27
  v_cvt_pk_bf16_f32 v76, v20, v21
  v_cvt_pk_bf16_f32 v77, v22, v23
  v_cvt_pk_bf16_f32 v78, v28, v29
  v_cvt_pk_bf16_f32 v79, v30, v31
  s_waitcnt vmcnt(0)
  s_barrier
  s_cmp_eq_u32 s76, 0
  s_cselect_b32 s80, 1, s18
  s_cmp_lg_u32 s80, 0
  s_cbranch_scc1 w1pf_38
  v_mov_b32 v80, 1
  s_mov_b64 exec, 1
  buffer_store_dword v80, off, s[4:7], s76 sc1
  s_mov_b64 exec, -1
w1pf_38:
  buffer_store_dwordx4 v[64:67], v126, s[4:7], s21 offen sc1
  buffer_store_dwordx4 v[68:71], v126, s[4:7], s21 offen offset:512 sc1
  buffer_store_dwordx4 v[72:75], v120, s[4:7], s22 offen sc1
  buffer_store_dwordx4 v[76:79], v120, s[4:7], s22 offen offset:512 sc1
  s_mov_b32 s76, s23
  s_add_u32 s20, s20, 7
w1_loop:
  s_add_u32 s24, s20, 7
  s_cmp_ge_u32 s24, 64
  s_cbranch_scc1 w1nopf_39
  s_lshl_b32 s23, s24, 15
  s_add_u32 s23, s23, 1048576
  s_lshl_b32 s21, s18, 13
  s_add_u32 s22, s21, s23
  s_add_u32 s21, s21, s35
  s_add_u32 m0, s21, 0
  s_add_u32 s80, s22, 0
  buffer_load_dwordx4 v113, s[4:7], s80 offen offset:0 sc1 lds
  buffer_load_dwordx4 v113, s[4:7], s80 offen offset:1024 sc1 lds
  buffer_load_dwordx4 v113, s[4:7], s80 offen offset:2048 sc1 lds
  buffer_load_dwordx4 v113, s[4:7], s80 offen offset:3072 sc1 lds
  s_add_u32 m0, s21, 4096
  s_add_u32 s80, s22, 4096
  buffer_load_dwordx4 v113, s[4:7], s80 offen offset:0 sc1 lds
  buffer_load_dwordx4 v113, s[4:7], s80 offen offset:1024 sc1 lds
  buffer_load_dwordx4 v113, s[4:7], s80 offen offset:2048 sc1 lds
  buffer_load_dwordx4 v113, s[4:7], s80 offen offset:3072 sc1 lds
w1nopf_39:
  ds_read_b128 v[32:35], v127 offset:32768
  ds_read_b128 v[36:39], v127 offset:33792
  ds_read_b128 v[40:43], v127 offset:34816
  ds_read_b128 v[44:47], v127 offset:35840
  ds_read_b128 v[48:51], v127 offset:36864
  ds_read_b128 v[52:55], v127 offset:37888
  ds_read_b128 v[56:59], v127 offset:38912
  ds_read_b128 v[60:63], v127 offset:39936
  s_waitcnt lgkmcnt(7)
  v_mfma_f32_32x32x16_bf16 v[0:15], a[0:3], v[32:35], 0
  v_mfma_f32_32x32x16_bf16 v[16:31], v[32:35], a[128:131], 0
  ds_read_b128 v[32:35], v127 offset:40960
  s_waitcnt lgkmcnt(7)
  v_mfma_f32_32x32x16_bf16 v[0:15], a[4:7], v[36:39], v[0:15]
  v_mfma_f32_32x32x16_bf16 v[16:31], v[36:39], a[132:135], v[16:31]
  ds_read_b128 v[36:39], v127 offset:41984
  s_waitcnt lgkmcnt(7)
  v_mfma_f32_32x32x16_bf16 v[0:15], a[8:11], v[40:43], v[0:15]
  v_mfma_f32_32x32x16_bf16 v[16:31], v[40:43], a[136:139], v[16:31]
  ds_read_b128 v[40:43], v127 offset:43008
  s_waitcnt lgkmcnt(7)
  v_mfma_f32_32x32x16_bf16 v[0:15], a[12:15], v[44:47], v[0:15]
  v_mfma_f32_32x32x16_bf16 v[16:31], v[44:47], a[140:143], v[16:31]
  ds_read_b128 v[44:47], v127 offset:44032
  s_waitcnt lgkmcnt(7)
  v_mfma_f32_32x32x16_bf16 v[0:15], a[16:19], v[48:51], v[0:15]
  v_mfma_f32_32x32x16_bf16 v[16:31], v[48:51], a[144:147], v[16:31]
  ds_read_b128 v[48:51], v127 offset:45056
  s_waitcnt lgkmcnt(7)
  v_mfma_f32_32x32x16_bf16 v[0:15], a[20:23], v[52:55], v[0:15]
  v_mfma_f32_32x32x16_bf16 v[16:31], v[52:55], a[148:151], v[16:31]
  ds_read_b128 v[52:55], v127 offset:46080
  s_waitcnt lgkmcnt(7)
  v_mfma_f32_32x32x16_bf16 v[0:15], a[24:27], v[56:59], v[0:15]
  v_mfma_f32_32x32x16_bf16 v[16:31], v[56:59], a[152:155], v[16:31]
  ds_read_b128 v[56:59], v127 offset:47104
  s_waitcnt lgkmcnt(7)
  v_mfma_f32_32x32x16_bf16 v[0:15], a[28:31], v[60:63], v[0:15]
  v_mfma_f32_32x32x16_bf16 v[16:31], v[60:63], a[156:159], v[16:31]
  ds_read_b128 v[60:63], v127 offset:48128
  s_waitcnt lgkmcnt(7)
  v_mfma_f32_32x32x16_bf16 v[0:15], a[32:35], v[32:35], v[0:15]
  v_mfma_f32_32x32x16_bf16 v[16:31], v[32:35], a[160:163], v[16:31]
  ds_read_b128 v[32:35], v127 offset:49152
  s_waitcnt lgkmcnt(7)
  v_mfma_f32_32x32x16_bf16 v[0:15], a[36:39], v[36:39], v[0:15]
  v_mfma_f32_32x32x16_bf16 v[16:31], v[36:39], a[164:167], v[16:31]
  ds_read_b128 v[36:39], v127 offset:50176
  s_waitcnt lgkmcnt(7)
  v_mfma_f32_32x32x16_bf16 v[0:15], a[40:43], v[40:43], v[0:15]
  v_mfma_f32_32x32x16_bf16 v[16:31], v[40:43], a[168:171], v[16:31]
  ds_read_b128 v[40:43], v127 offset:51200
  s_waitcnt lgkmcnt(7)
  v_mfma_f32_32x32x16_bf16 v[0:15], a[44:47], v[44:47], v[0:15]
  v_mfma_f32_32x32x16_bf16 v[16:31], v[44:47], a[172:175], v[16:31]
  ds_read_b128 v[44:47], v127 offset:52224
  s_waitcnt lgkmcnt(7)
  v_mfma_f32_32x32x16_bf16 v[0:15], a[48:51], v[48:51], v[0:15]
  v_mfma_f32_32x32x16_bf16 v[16:31], v[48:51], a[176:179], v[16:31]
  ds_read_b128 v[48:51], v127 offset:53248
  s_waitcnt lgkmcnt(7)
  v_mfma_f32_32x32x16_bf16 v[0:15], a[52:55], v[52:55], v[0:15]
  v_mfma_f32_32x32x16_bf16 v[16:31], v[52:55], a[180:183], v[16:31]
  ds_read_b128 v[52:55], v127 offset:54272
  s_waitcnt lgkmcnt(7)
  v_mfma_f32_32x32x16_bf16 v[0:15], a[56:59], v[56:59], v[0:15]
  v_mfma_f32_32x32x16_bf16 v[16:31], v[56:59], a[184:187], v[16:31]
  ds_read_b128 v[56:59], v127 offset:55296
  s_waitcnt lgkmcnt(7)
  v_mfma_f32_32x32x16_bf16 v[0:15], a[60:63], v[60:63], v[0:15]
  v_mfma_f32_32x32x16_bf16 v[16:31], v[60:63], a[188:191], v[16:31]
  ds_read_b128 v[60:63], v127 offset:56320
  s_waitcnt lgkmcnt(7)
  v_mfma_f32_32x32x16_bf16 v[0:15], a[64:67], v[32:35], v[0:15]
  v_mfma_f32_32x32x16_bf16 v[16:31], v[32:35], a[192:195], v[16:31]
  ds_read_b128 v[32:35], v127 offset:57344
  s_waitcnt lgkmcnt(7)
  v_mfma_f32_32x32x16_bf16 v[0:15], a[68:71], v[36:39], v[0:15]
  v_mfma_f32_32x32x16_bf16 v[16:31], v[36:39], a[196:199], v[16:31]
  ds_read_b128 v[36:39], v127 offset:58368
  s_waitcnt lgkmcnt(7)
  v_mfma_f32_32x32x16_bf16 v[0:15], a[72:75], v[40:43], v[0:15]
  v_mfma_f32_32x32x16_bf16 v[16:31], v[40:43], a[200:203], v[16:31]
  ds_read_b128 v[40:43], v127 offset:59392
  s_waitcnt lgkmcnt(7)
  v_mfma_f32_32x32x16_bf16 v[0:15], a[76:79], v[44:47], v[0:15]
  v_mfma_f32_32x32x16_bf16 v[16:31], v[44:47], a[204:207], v[16:31]
  ds_read_b128 v[44:47], v127 offset:60416
  s_waitcnt lgkmcnt(7)
  v_mfma_f32_32x32x16_bf16 v[0:15], a[80:83], v[48:51], v[0:15]
  v_mfma_f32_32x32x16_bf16 v[16:31], v[48:51], a[208:211], v[16:31]
  ds_read_b128 v[48:51], v127 offset:61440
  s_waitcnt lgkmcnt(7)
  v_mfma_f32_32x32x16_bf16 v[0:15], a[84:87], v[52:55], v[0:15]
  v_mfma_f32_32x32x16_bf16 v[16:31], v[52:55], a[212:215], v[16:31]
  ds_read_b128 v[52:55], v127 offset:62464
  s_waitcnt lgkmcnt(7)
  v_mfma_f32_32x32x16_bf16 v[0:15], a[88:91], v[56:59], v[0:15]
  v_mfma_f32_32x32x16_bf16 v[16:31], v[56:59], a[216:219], v[16:31]
  ds_read_b128 v[56:59], v127 offset:63488
  s_waitcnt lgkmcnt(7)
  v_mfma_f32_32x32x16_bf16 v[0:15], a[92:95], v[60:63], v[0:15]
  v_mfma_f32_32x32x16_bf16 v[16:31], v[60:63], a[220:223], v[16:31]
  ds_read_b128 v[60:63], v127 offset:64512
  s_waitcnt lgkmcnt(7)
  v_mfma_f32_32x32x16_bf16 v[0:15], a[96:99], v[32:35], v[0:15]
  v_mfma_f32_32x32x16_bf16 v[16:31], v[32:35], a[224:227], v[16:31]
  s_waitcnt lgkmcnt(6)
  v_mfma_f32_32x32x16_bf16 v[0:15], a[100:103], v[36:39], v[0:15]
  v_mfma_f32_32x32x16_bf16 v[16:31], v[36:39], a[228:231], v[16:31]
  s_waitcnt lgkmcnt(5)
  v_mfma_f32_32x32x16_bf16 v[0:15], a[104:107], v[40:43], v[0:15]
  v_mfma_f32_32x32x16_bf16 v[16:31], v[40:43], a[232:235], v[16:31]
  s_waitcnt lgkmcnt(4)
  v_mfma_f32_32x32x16_bf16 v[0:15], a[108:111], v[44:47], v[0:15]
  v_mfma_f32_32x32x16_bf16 v[16:31], v[44:47], a[236:239], v[16:31]
  s_waitcnt lgkmcnt(3)
  v_mfma_f32_32x32x16_bf16 v[0:15], a[112:115], v[48:51], v[0:15]
  v_mfma_f32_32x32x16_bf16 v[16:31], v[48:51], a[240:243], v[16:31]
  s_waitcnt lgkmcnt(2)
  v_mfma_f32_32x32x16_bf16 v[0:15], a[116:119], v[52:55], v[0:15]
  v_mfma_f32_32x32x16_bf16 v[16:31], v[52:55], a[244:247], v[16:31]
  s_waitcnt lgkmcnt(1)
  v_mfma_f32_32x32x16_bf16 v[0:15], a[120:123], v[56:59], v[0:15]
  v_mfma_f32_32x32x16_bf16 v[16:31], v[56:59], a[248:251], v[16:31]
  s_waitcnt lgkmcnt(0)
  v_mfma_f32_32x32x16_bf16 v[0:15], a[124:127], v[60:63], v[0:15]
  v_mfma_f32_32x32x16_bf16 v[16:31], v[60:63], a[252:255], v[16:31]
  s_lshl_b32 s21, s20, 5
  s_add_u32 s21, s21, s17
  s_lshl_b32 s21, s21, 13
  s_add_u32 s22, s21, 20971520
  s_add_u32 s21, s21, 4194304
  s_lshl_b32 s23, s17, 6
  s_add_u32 s23, s23, s20
  s_lshl_b32 s23, s23, 2
  s_add_u32 s23, s23, 8192
  v_xor_b32 v127, 32768, v127
  s_xor_b32 s35, s35, 98304
  s_nop 7
  v_cvt_pk_bf16_f32 v64, v0, v1
  v_cvt_pk_bf16_f32 v65, v2, v3
  v_cvt_pk_bf16_f32 v66, v4, v5
  v_cvt_pk_bf16_f32 v67, v6, v7
  v_cvt_pk_bf16_f32 v68, v8, v9
  v_cvt_pk_bf16_f32 v69, v10, v11
  v_cvt_pk_bf16_f32 v70, v12, v13
  v_cvt_pk_bf16_f32 v71, v14, v15
  v_cvt_pk_bf16_f32 v72, v16, v17
  v_cvt_pk_bf16_f32 v73, v18, v19
  v_cvt_pk_bf16_f32 v74, v24, v25
  v_cvt_pk_bf16_f32 v75, v26, v27
  v_cvt_pk_bf16_f32 v76, v20, v21
  v_cvt_pk_bf16_f32 v77, v22, v23
  v_cvt_pk_bf16_f32 v78, v28, v29
  v_cvt_pk_bf16_f32 v79, v30, v31
  s_waitcnt vmcnt(0)
  s_barrier
  s_cmp_eq_u32 s76, 0
  s_cselect_b32 s80, 1, s18
  s_cmp_lg_u32 s80, 0
  s_cbranch_scc1 w1pf_40
  v_mov_b32 v80, 1
  s_mov_b64 exec, 1
  buffer_store_dword v80, off, s[4:7], s76 sc1
  s_mov_b64 exec, -1
w1pf_40:
  buffer_store_dwordx4 v[64:67], v126, s[4:7], s21 offen sc1
  buffer_store_dwordx4 v[68:71], v126, s[4:7], s21 offen offset:512 sc1
  buffer_store_dwordx4 v[72:75], v120, s[4:7], s22 offen sc1
  buffer_store_dwordx4 v[76:79], v120, s[4:7], s22 offen offset:512 sc1
  s_mov_b32 s76, s23
  s_add_u32 s20, s20, 7
  s_cmp_lt_u32 s20, 64
  s_cbranch_scc1 w1_loop
  s_waitcnt vmcnt(0)
  s_barrier
  s_cmp_eq_u32 s76, 0
  s_cselect_b32 s80, 1, s18
  s_cmp_lg_u32 s80, 0
  s_cbranch_scc1 w1pf_41
  v_mov_b32 v80, 1
  s_mov_b64 exec, 1
  buffer_store_dword v80, off, s[4:7], s76 sc1
  s_mov_b64 exec, -1
w1pf_41:
  s_cmp_eq_u32 s81, 0
  s_cbranch_scc1 worker_slow
  s_load_dwordx2 s[8:9], s[0:1], 104
  s_mov_b32 s10, 0x300000
  s_mov_b32 s11, 0x00020000
  s_waitcnt lgkmcnt(0)
  v_lshrrev_b32 v0, 2, v112
  s_lshl_b32 s21, s18, 7
  v_add_u32 v0, s21, v0
  v_mul_u32_u24 v0, 6144, v0
  v_and_b32 v1, 3, v112
  v_lshl_add_u32 v0, v1, 4, v0
  s_mul_i32 s21, s17, 128
  s_add_u32 s21, s21, 2048
  s_lshl_b32 s22, s18, 14
  s_add_u32 s22, s22, 32768
  s_add_u32 m0, s22, 0
  s_add_u32 s80, s21, 0
  buffer_load_dwordx4 v0, s[8:11], s80 offen lds
  s_add_u32 m0, s22, 1024
  s_add_u32 s80, s21, 98304
  buffer_load_dwordx4 v0, s[8:11], s80 offen lds
  s_add_u32 m0, s22, 2048
  s_add_u32 s80, s21, 196608
  buffer_load_dwordx4 v0, s[8:11], s80 offen lds
  s_add_u32 m0, s22, 3072
  s_add_u32 s80, s21, 294912
  buffer_load_dwordx4 v0, s[8:11], s80 offen lds
  s_add_u32 m0, s22, 4096
  s_add_u32 s80, s21, 393216
  buffer_load_dwordx4 v0, s[8:11], s80 offen lds
  s_add_u32 m0, s22, 5120
  s_add_u32 s80, s21, 491520
  buffer_load_dwordx4 v0, s[8:11], s80 offen lds
  s_add_u32 m0, s22, 6144
  s_add_u32 s80, s21, 589824
  buffer_load_dwordx4 v0, s[8:11], s80 offen lds
  s_add_u32 m0, s22, 7168
  s_add_u32 s80, s21, 688128
  buffer_load_dwordx4 v0, s[8:11], s80 offen lds
  s_add_u32 m0, s22, 8192
  s_add_u32 s80, s21, 64
  buffer_load_dwordx4 v0, s[8:11], s80 offen lds
  s_add_u32 m0, s22, 9216
  s_add_u32 s80, s21, 98368
  buffer_load_dwordx4 v0, s[8:11], s80 offen lds
  s_add_u32 m0, s22, 10240
  s_add_u32 s80, s21, 196672
  buffer_load_dwordx4 v0, s[8:11], s80 offen lds
  s_add_u32 m0, s22, 11264
  s_add_u32 s80, s21, 294976
  buffer_load_dwordx4 v0, s[8:11], s80 offen lds
  s_add_u32 m0, s22, 12288
  s_add_u32 s80, s21, 393280
  buffer_load_dwordx4 v0, s[8:11], s80 offen lds
  s_add_u32 m0, s22, 13312
  s_add_u32 s80, s21, 491584
  buffer_load_dwordx4 v0, s[8:11], s80 offen lds
  s_add_u32 m0, s22, 14336
  s_add_u32 s80, s21, 589888
  buffer_load_dwordx4 v0, s[8:11], s80 offen lds
  s_add_u32 m0, s22, 15360
  s_add_u32 s80, s21, 688192
  buffer_load_dwordx4 v0, s[8:11], s80 offen lds
  ds_read_b64_tr_b16 a[0:1], v114 offset:0
  ds_read_b64_tr_b16 a[2:3], v114 offset:256
  ds_read_b64_tr_b16 a[4:5], v114 offset:1024
  ds_read_b64_tr_b16 a[6:7], v114 offset:1280
  ds_read_b64_tr_b16 a[8:9], v114 offset:2048
  ds_read_b64_tr_b16 a[10:11], v114 offset:2304
  s_waitcnt lgkmcnt(4)
  s_mov_b32 s28, s36
  s_mov_b32 s29, s37
  s_mov_b32 s30, 0x400000
  s_add_u32 m0, s32, 0
  s_mov_b32 s80, 2097152
  buffer_load_dwordx4 v100, s[28:31], s80 offen  lds
  ds_read_b64_tr_b16 a[12:13], v114 offset:3072
  ds_read_b64_tr_b16 a[14:15], v114 offset:3328
  s_waitcnt lgkmcnt(4)
  s_add_u32 m0, s32, 1024
  s_mov_b32 s80, 2228224
  buffer_load_dwordx4 v100, s[28:31], s80 offen  lds
  ds_read_b64_tr_b16 a[16:17], v114 offset:4096
  ds_read_b64_tr_b16 a[18:19], v114 offset:4352
  s_waitcnt lgkmcnt(4)
  s_add_u32 m0, s32, 2048
  s_mov_b32 s80, 2359296
  buffer_load_dwordx4 v100, s[28:31], s80 offen  lds
  ds_read_b64_tr_b16 a[20:21], v114 offset:5120
  ds_read_b64_tr_b16 a[22:23], v114 offset:5376
  s_waitcnt lgkmcnt(4)
  s_add_u32 m0, s32, 3072
  s_mov_b32 s80, 2490368
  buffer_load_dwordx4 v100, s[28:31], s80 offen  lds
  ds_read_b64_tr_b16 a[24:25], v114 offset:6144
  ds_read_b64_tr_b16 a[26:27], v114 offset:6400
  s_waitcnt lgkmcnt(4)
  s_add_u32 m0, s32, 4096
  s_mov_b32 s80, 2621440
  buffer_load_dwordx4 v100, s[28:31], s80 offen  lds
  ds_read_b64_tr_b16 a[28:29], v114 offset:7168
  ds_read_b64_tr_b16 a[30:31], v114 offset:7424
  s_waitcnt lgkmcnt(4)
  s_add_u32 m0, s32, 5120
  s_mov_b32 s80, 2752512
  buffer_load_dwordx4 v100, s[28:31], s80 offen  lds
  ds_read_b64_tr_b16 a[32:33], v114 offset:8192
  ds_read_b64_tr_b16 a[34:35], v114 offset:8448
  s_waitcnt lgkmcnt(4)
  s_add_u32 m0, s32, 6144
  s_mov_b32 s80, 2883584
  buffer_load_dwordx4 v100, s[28:31], s80 offen  lds
  ds_read_b64_tr_b16 a[36:37], v114 offset:9216
  ds_read_b64_tr_b16 a[38:39], v114 offset:9472
  s_waitcnt lgkmcnt(4)
  s_add_u32 m0, s32, 7168
  s_mov_b32 s80, 3014656
  buffer_load_dwordx4 v100, s[28:31], s80 offen  lds
  ds_read_b64_tr_b16 a[40:41], v114 offset:10240
  ds_read_b64_tr_b16 a[42:43], v114 offset:10496
  s_waitcnt lgkmcnt(4)
  s_add_u32 m0, s32, 8192
  s_mov_b32 s80, 3145728
  buffer_load_dwordx4 v100, s[28:31], s80 offen  lds
  ds_read_b64_tr_b16 a[44:45], v114 offset:11264
  ds_read_b64_tr_b16 a[46:47], v114 offset:11520
  s_waitcnt lgkmcnt(4)
  s_add_u32 m0, s32, 9216
  s_mov_b32 s80, 3276800
  buffer_load_dwordx4 v100, s[28:31], s80 offen  lds
  ds_read_b64_tr_b16 a[48:49], v114 offset:12288
  ds_read_b64_tr_b16 a[50:51], v114 offset:12544
  s_waitcnt lgkmcnt(4)
  s_add_u32 m0, s32, 10240
  s_mov_b32 s80, 3407872
  buffer_load_dwordx4 v100, s[28:31], s80 offen  lds
  ds_read_b64_tr_b16 a[52:53], v114 offset:13312
  ds_read_b64_tr_b16 a[54:55], v114 offset:13568
  s_waitcnt lgkmcnt(4)
  s_add_u32 m0, s32, 11264
  s_mov_b32 s80, 3538944
  buffer_load_dwordx4 v100, s[28:31], s80 offen  lds
  ds_read_b64_tr_b16 a[56:57], v114 offset:14336
  ds_read_b64_tr_b16 a[58:59], v114 offset:14592
  s_waitcnt lgkmcnt(4)
  s_add_u32 m0, s32, 12288
  s_mov_b32 s80, 3670016
  buffer_load_dwordx4 v100, s[28:31], s80 offen  lds
  ds_read_b64_tr_b16 a[60:61], v114 offset:15360
  ds_read_b64_tr_b16 a[62:63], v114 offset:15616
  s_waitcnt lgkmcnt(4)
  s_add_u32 m0, s32, 13312
  s_mov_b32 s80, 3801088
  buffer_load_dwordx4 v100, s[28:31], s80 offen  lds
  s_waitcnt lgkmcnt(0)
  s_add_u32 m0, s32, 14336
  s_mov_b32 s80, 3932160
  buffer_load_dwordx4 v100, s[28:31], s80 offen  lds
  s_add_u32 m0, s32, 15360
  s_mov_b32 s80, 4063232
  buffer_load_dwordx4 v100, s[28:31], s80 offen  lds
  s_lshl_b32 s22, s18, 14
  s_add_u32 s22, s22, 32768
  s_sub_u32 s22, s22, s32
  v_add_u32 v1, s22, v114
  v_lshrrev_b32 v2, 5, v112
  v_lshlrev_b32 v2, 4, v2
  s_lshl_b32 s21, s18, 8
  v_add_u32 v2, s21, v2
  s_waitcnt vmcnt(16)
  ds_read_b128 v[4:7], v2 offset:30720
  ds_read_b128 v[8:11], v2 offset:30752
  ds_read_b128 v[12:15], v2 offset:30784
  ds_read_b128 v[16:19], v2 offset:30816
  ds_read_b128 v[20:23], v2 offset:30848
  ds_read_b128 v[24:27], v2 offset:30880
  ds_read_b128 v[28:31], v2 offset:30912
  ds_read_b128 v[32:35], v2 offset:30944
  s_waitcnt lgkmcnt(0)
  ds_read_b64_tr_b16 v[36:37], v1 offset:0
  ds_read_b64_tr_b16 v[38:39], v1 offset:256
  ds_read_b64_tr_b16 v[40:41], v1 offset:1024
  ds_read_b64_tr_b16 v[42:43], v1 offset:1280
  ds_read_b64_tr_b16 v[44:45], v1 offset:2048
  ds_read_b64_tr_b16 v[46:47], v1 offset:2304
  ds_read_b64_tr_b16 v[48:49], v1 offset:3072
  ds_read_b64_tr_b16 v[50:51], v1 offset:3328
  ds_read_b64_tr_b16 v[52:53], v1 offset:4096
  ds_read_b64_tr_b16 v[54:55], v1 offset:4352
  ds_read_b64_tr_b16 v[56:57], v1 offset:5120
  ds_read_b64_tr_b16 v[58:59], v1 offset:5376
  ds_read_b64_tr_b16 v[60:61], v1 offset:6144
  ds_read_b64_tr_b16 v[62:63], v1 offset:6400
  ds_read_b64_tr_b16 v[64:65], v1 offset:7168
  ds_read_b64_tr_b16 v[66:67], v1 offset:7424
  s_waitcnt lgkmcnt(0)
  v_mfma_f32_32x32x16_bf16 v[68:83], v[4:7], v[36:39], 0
  v_mfma_f32_32x32x16_bf16 v[68:83], v[8:11], v[40:43], v[68:83]
  v_mfma_f32_32x32x16_bf16 v[68:83], v[12:15], v[44:47], v[68:83]
  v_mfma_f32_32x32x16_bf16 v[68:83], v[16:19], v[48:51], v[68:83]
  v_mfma_f32_32x32x16_bf16 v[68:83], v[20:23], v[52:55], v[68:83]
  v_mfma_f32_32x32x16_bf16 v[68:83], v[24:27], v[56:59], v[68:83]
  v_mfma_f32_32x32x16_bf16 v[68:83], v[28:31], v[60:63], v[68:83]
  v_mfma_f32_32x32x16_bf16 v[68:83], v[32:35], v[64:67], v[68:83]
  s_waitcnt lgkmcnt(0)
  ds_read_b64_tr_b16 v[36:37], v1 offset:8192
  ds_read_b64_tr_b16 v[38:39], v1 offset:8448
  ds_read_b64_tr_b16 v[40:41], v1 offset:9216
  ds_read_b64_tr_b16 v[42:43], v1 offset:9472
  ds_read_b64_tr_b16 v[44:45], v1 offset:10240
  ds_read_b64_tr_b16 v[46:47], v1 offset:10496
  ds_read_b64_tr_b16 v[48:49], v1 offset:11264
  ds_read_b64_tr_b16 v[50:51], v1 offset:11520
  ds_read_b64_tr_b16 v[52:53], v1 offset:12288
  ds_read_b64_tr_b16 v[54:55], v1 offset:12544
  ds_read_b64_tr_b16 v[56:57], v1 offset:13312
  ds_read_b64_tr_b16 v[58:59], v1 offset:13568
  ds_read_b64_tr_b16 v[60:61], v1 offset:14336
  ds_read_b64_tr_b16 v[62:63], v1 offset:14592
  ds_read_b64_tr_b16 v[64:65], v1 offset:15360
  ds_read_b64_tr_b16 v[66:67], v1 offset:15616
  s_waitcnt lgkmcnt(0)
  v_mfma_f32_32x32x16_bf16 v[84:99], v[4:7], v[36:39], 0
  v_mfma_f32_32x32x16_bf16 v[84:99], v[8:11], v[40:43], v[84:99]
  v_mfma_f32_32x32x16_bf16 v[84:99], v[12:15], v[44:47], v[84:99]
  v_mfma_f32_32x32x16_bf16 v[84:99], v[16:19], v[48:51], v[84:99]
  v_mfma_f32_32x32x16_bf16 v[84:99], v[20:23], v[52:55], v[84:99]
  v_mfma_f32_32x32x16_bf16 v[84:99], v[24:27], v[56:59], v[84:99]
  v_mfma_f32_32x32x16_bf16 v[84:99], v[28:31], v[60:63], v[84:99]
  v_mfma_f32_32x32x16_bf16 v[84:99], v[32:35], v[64:67], v[84:99]
  s_nop 15
  v_and_b32 v1, 31, v112
  v_lshlrev_b32 v1, 2, v1
  s_lshl_b32 s21, s18, 8
  v_add_u32 v2, s21, v1
  ds_write_b32 v2, v68 offset:31744
  ds_write_b32 v2, v84 offset:31872
  s_waitcnt lgkmcnt(0)
  s_barrier
  v_lshlrev_b32 v1, 3, v112
  v_and_b32 v1, 255, v1
  ds_read_b64 v[4:5], v1 offset:31744
  ds_read_b64 v[6:7], v1 offset:32000
  ds_read_b64 v[8:9], v1 offset:32256
  ds_read_b64 v[10:11], v1 offset:32512
  s_waitcnt lgkmcnt(0)
  v_add_f32 v4, v4, v6
  v_add_f32 v8, v8, v10
  v_add_f32 v4, v4, v8
  v_add_f32 v5, v5, v7
  v_add_f32 v9, v9, v11
  v_add_f32 v5, v5, v9
  v_cvt_pk_bf16_f32 v4, v4, v5
  v_lshlrev_b32 v1, 2, v112
  s_lshl_b32 s21, s19, 13
  s_mul_i32 s22, s17, 128
  s_add_u32 s21, s21, s22
  s_add_u32 s21, s21, 657408
  s_cmp_lg_u32 s18, 0
  s_cbranch_scc1 modskip_42
  s_mov_b64 exec, 0xffffffff
  buffer_store_dword v4, v1, s[4:7], s21 offen
  s_mov_b64 exec, -1
modskip_42:
  s_barrier
  s_lshl_b32 s35, s19, 21
  s_add_u32 s35, s35, 54525952
  s_lshl_b32 s22, s17, 14
  s_add_u32 s73, s35, s22
  s_lshl_b32 s22, s17, 9
  s_add_u32 s72, s35, s22
  s_lshl_b32 s74, s19, 16
  s_add_u32 s74, s74, 71303168
  v_mov_b64 v[4:5], -1
  v_mov_b64 v[6:7], -1
  s_lshl_b32 s21, s18, 12
  s_add_u32 s21, s21, s73
  s_add_u32 s22, s21, 0
  buffer_store_dwordx4 v[4:7], v113, s[4:7], s22 offen offset:0
  buffer_store_dwordx4 v[4:7], v113, s[4:7], s22 offen offset:1024
  buffer_store_dwordx4 v[4:7], v113, s[4:7], s22 offen offset:2048
  buffer_store_dwordx4 v[4:7], v113, s[4:7], s22 offen offset:3072
  s_add_u32 s22, s21, 524288
  buffer_store_dwordx4 v[4:7], v113, s[4:7], s22 offen offset:0
  buffer_store_dwordx4 v[4:7], v113, s[4:7], s22 offen offset:1024
  buffer_store_dwordx4 v[4:7], v113, s[4:7], s22 offen offset:2048
  buffer_store_dwordx4 v[4:7], v113, s[4:7], s22 offen offset:3072
  v_add_u32 v107, v116, v116
  v_sub_u32 v107, v107, v113
  s_lshl_b32 s21, s17, 13
  s_add_u32 s21, s21, s35
  s_add_u32 s21, s21, 0x100000
  buffer_store_dwordx4 v[4:7], v107, s[4:7], s21 offen
  buffer_store_dwordx4 v[4:7], v107, s[4:7], s21 offen offset:1024
  s_lshl_b32 s21, s17, 12
  s_add_u32 s21, s21, s35
  s_add_u32 s21, s21, 0x180000
  buffer_store_dwordx4 v[4:7], v116, s[4:7], s21 offen
  s_add_u32 s22, s74, 32768
  buffer_store_dwordx4 v[4:7], v125, s[4:7], s74 offen
  buffer_store_dwordx4 v[4:7], v125, s[4:7], s22 offen
  s_waitcnt vmcnt(28)
  ds_read_b64_tr_b16 a[64:65], v114 offset:0
  ds_read_b64_tr_b16 a[66:67], v114 offset:256
  s_waitcnt vmcnt(27)
  ds_read_b64_tr_b16 a[68:69], v114 offset:1024
  ds_read_b64_tr_b16 a[70:71], v114 offset:1280
  s_waitcnt vmcnt(26)
  ds_read_b64_tr_b16 a[72:73], v114 offset:2048
  ds_read_b64_tr_b16 a[74:75], v114 offset:2304
  s_waitcnt lgkmcnt(4)
  s_mov_b32 s28, s38
  s_mov_b32 s29, s39
  s_mov_b32 s30, 0x400000
  s_add_u32 m0, s32, 0
  s_add_u32 s80, s68, 0
  buffer_load_dwordx4 v101, s[28:31], s80 offen  lds
  s_waitcnt vmcnt(26)
  ds_read_b64_tr_b16 a[76:77], v114 offset:3072
  ds_read_b64_tr_b16 a[78:79], v114 offset:3328
  s_waitcnt lgkmcnt(4)
  s_add_u32 m0, s32, 1024
  s_add_u32 s80, s68, 16384
  buffer_load_dwordx4 v101, s[28:31], s80 offen  lds
  s_waitcnt vmcnt(26)
  ds_read_b64_tr_b16 a[80:81], v114 offset:4096
  ds_read_b64_tr_b16 a[82:83], v114 offset:4352
  s_waitcnt lgkmcnt(4)
  s_add_u32 m0, s32, 2048
  s_add_u32 s80, s68, 32768
  buffer_load_dwordx4 v101, s[28:31], s80 offen  lds
  s_waitcnt vmcnt(26)
  ds_read_b64_tr_b16 a[84:85], v114 offset:5120
  ds_read_b64_tr_b16 a[86:87], v114 offset:5376
  s_waitcnt lgkmcnt(4)
  s_add_u32 m0, s32, 3072
  s_add_u32 s80, s68, 49152
  buffer_load_dwordx4 v101, s[28:31], s80 offen  lds
  s_waitcnt vmcnt(26)
  ds_read_b64_tr_b16 a[88:89], v114 offset:6144
  ds_read_b64_tr_b16 a[90:91], v114 offset:6400
  s_waitcnt lgkmcnt(4)
  s_add_u32 m0, s32, 4096
  s_add_u32 s80, s68, 65536
  buffer_load_dwordx4 v101, s[28:31], s80 offen  lds
  s_waitcnt vmcnt(26)
  ds_read_b64_tr_b16 a[92:93], v114 offset:7168
  ds_read_b64_tr_b16 a[94:95], v114 offset:7424
  s_waitcnt lgkmcnt(4)
  s_add_u32 m0, s32, 5120
  s_add_u32 s80, s68, 81920
  buffer_load_dwordx4 v101, s[28:31], s80 offen  lds
  s_waitcnt vmcnt(26)
  ds_read_b64_tr_b16 a[96:97], v114 offset:8192
  ds_read_b64_tr_b16 a[98:99], v114 offset:8448
  s_waitcnt lgkmcnt(4)
  s_add_u32 m0, s32, 6144
  s_add_u32 s80, s68, 98304
  buffer_load_dwordx4 v101, s[28:31], s80 offen  lds
  s_waitcnt vmcnt(26)
  ds_read_b64_tr_b16 a[100:101], v114 offset:9216
  ds_read_b64_tr_b16 a[102:103], v114 offset:9472
  s_waitcnt lgkmcnt(4)
  s_add_u32 m0, s32, 7168
  s_add_u32 s80, s68, 114688
  buffer_load_dwordx4 v101, s[28:31], s80 offen  lds
  s_waitcnt vmcnt(26)
  ds_read_b64_tr_b16 a[104:105], v114 offset:10240
  ds_read_b64_tr_b16 a[106:107], v114 offset:10496
  s_waitcnt lgkmcnt(4)
  s_add_u32 m0, s32, 8192
  s_add_u32 s80, s68, 131072
  buffer_load_dwordx4 v101, s[28:31], s80 offen  lds
  s_waitcnt vmcnt(26)
  ds_read_b64_tr_b16 a[108:109], v114 offset:11264
  ds_read_b64_tr_b16 a[110:111], v114 offset:11520
  s_waitcnt lgkmcnt(4)
  s_add_u32 m0, s32, 9216
  s_add_u32 s80, s68, 147456
  buffer_load_dwordx4 v101, s[28:31], s80 offen  lds
  s_waitcnt vmcnt(26)
  ds_read_b64_tr_b16 a[112:113], v114 offset:12288
  ds_read_b64_tr_b16 a[114:115], v114 offset:12544
  s_waitcnt lgkmcnt(4)
  s_add_u32 m0, s32, 10240
  s_add_u32 s80, s68, 163840
  buffer_load_dwordx4 v101, s[28:31], s80 offen  lds
  s_waitcnt vmcnt(26)
  ds_read_b64_tr_b16 a[116:117], v114 offset:13312
  ds_read_b64_tr_b16 a[118:119], v114 offset:13568
  s_waitcnt lgkmcnt(4)
  s_add_u32 m0, s32, 11264
  s_add_u32 s80, s68, 180224
  buffer_load_dwordx4 v101, s[28:31], s80 offen  lds
  s_waitcnt vmcnt(26)
  ds_read_b64_tr_b16 a[120:121], v114 offset:14336
  ds_read_b64_tr_b16 a[122:123], v114 offset:14592
  s_waitcnt lgkmcnt(4)
  s_add_u32 m0, s32, 12288
  s_add_u32 s80, s68, 196608
  buffer_load_dwordx4 v101, s[28:31], s80 offen  lds
  s_waitcnt vmcnt(26)
  ds_read_b64_tr_b16 a[124:125], v114 offset:15360
  ds_read_b64_tr_b16 a[126:127], v114 offset:15616
  s_waitcnt lgkmcnt(4)
  s_add_u32 m0, s32, 13312
  s_add_u32 s80, s68, 212992
  buffer_load_dwordx4 v101, s[28:31], s80 offen  lds
  s_waitcnt vmcnt(13)
  ds_read_b64_tr_b16 a[128:129], v115 offset:0
  ds_read_b64_tr_b16 a[130:131], v115 offset:512
  s_waitcnt lgkmcnt(4)
  s_add_u32 m0, s32, 14336
  s_add_u32 s80, s68, 229376
  buffer_load_dwordx4 v101, s[28:31], s80 offen  lds
  s_waitcnt vmcnt(13)
  ds_read_b64_tr_b16 a[132:133], v115 offset:1024
  ds_read_b64_tr_b16 a[134:135], v115 offset:1536
  s_waitcnt lgkmcnt(4)
  s_add_u32 m0, s32, 15360
  s_add_u32 s80, s68, 245760
  buffer_load_dwordx4 v101, s[28:31], s80 offen  lds
  s_waitcnt vmcnt(13)
  ds_read_b64_tr_b16 a[136:137], v115 offset:2048
  ds_read_b64_tr_b16 a[138:139], v115 offset:2560
  s_waitcnt lgkmcnt(4)
  s_add_u32 m0, s32, 0
  s_add_u32 s80, s68, 262144
  buffer_load_dwordx4 v101, s[28:31], s80 offen  lds
  s_waitcnt vmcnt(13)
  ds_read_b64_tr_b16 a[140:141], v115 offset:3072
  ds_read_b64_tr_b16 a[142:143], v115 offset:3584
  s_waitcnt lgkmcnt(4)
  s_add_u32 m0, s32, 1024
  s_add_u32 s80, s68, 278528
  buffer_load_dwordx4 v101, s[28:31], s80 offen  lds
  s_waitcnt vmcnt(13)
  ds_read_b64_tr_b16 a[144:145], v115 offset:4096
  ds_read_b64_tr_b16 a[146:147], v115 offset:4608
  s_waitcnt lgkmcnt(4)
  s_add_u32 m0, s32, 2048
  s_add_u32 s80, s68, 294912
  buffer_load_dwordx4 v101, s[28:31], s80 offen  lds
  s_waitcnt vmcnt(13)
  ds_read_b64_tr_b16 a[148:149], v115 offset:5120
  ds_read_b64_tr_b16 a[150:151], v115 offset:5632
  s_waitcnt lgkmcnt(4)
  s_add_u32 m0, s32, 3072
  s_add_u32 s80, s68, 311296
  buffer_load_dwordx4 v101, s[28:31], s80 offen  lds
  s_waitcnt vmcnt(13)
  ds_read_b64_tr_b16 a[152:153], v115 offset:6144
  ds_read_b64_tr_b16 a[154:155], v115 offset:6656
  s_waitcnt lgkmcnt(4)
  s_add_u32 m0, s32, 4096
  s_add_u32 s80, s68, 327680
  buffer_load_dwordx4 v101, s[28:31], s80 offen  lds
  s_waitcnt vmcnt(13)
  ds_read_b64_tr_b16 a[156:157], v115 offset:7168
  ds_read_b64_tr_b16 a[158:159], v115 offset:7680
  s_waitcnt lgkmcnt(4)
  s_add_u32 m0, s32, 5120
  s_add_u32 s80, s68, 344064
  buffer_load_dwordx4 v101, s[28:31], s80 offen  lds
  s_waitcnt vmcnt(13)
  ds_read_b64_tr_b16 a[160:161], v115 offset:8192
  ds_read_b64_tr_b16 a[162:163], v115 offset:8704
  s_waitcnt lgkmcnt(4)
  s_add_u32 m0, s32, 6144
  s_add_u32 s80, s68, 360448
  buffer_load_dwordx4 v101, s[28:31], s80 offen  lds
  s_waitcnt vmcnt(13)
  ds_read_b64_tr_b16 a[164:165], v115 offset:9216
  ds_read_b64_tr_b16 a[166:167], v115 offset:9728
  s_waitcnt lgkmcnt(4)
  s_add_u32 m0, s32, 7168
  s_add_u32 s80, s68, 376832
  buffer_load_dwordx4 v101, s[28:31], s80 offen  lds
  s_waitcnt vmcnt(13)
  ds_read_b64_tr_b16 a[168:169], v115 offset:10240
  ds_read_b64_tr_b16 a[170:171], v115 offset:10752
  s_waitcnt lgkmcnt(4)
  s_add_u32 m0, s32, 8192
  s_add_u32 s80, s68, 393216
  buffer_load_dwordx4 v101, s[28:31], s80 offen  lds
  s_waitcnt vmcnt(13)
  ds_read_b64_tr_b16 a[172:173], v115 offset:11264
  ds_read_b64_tr_b16 a[174:175], v115 offset:11776
  s_waitcnt lgkmcnt(4)
  s_add_u32 m0, s32, 9216
  s_add_u32 s80, s68, 409600
  buffer_load_dwordx4 v101, s[28:31], s80 offen  lds
  s_waitcnt vmcnt(13)
  ds_read_b64_tr_b16 a[176:177], v115 offset:12288
  ds_read_b64_tr_b16 a[178:179], v115 offset:12800
  s_waitcnt lgkmcnt(4)
  s_add_u32 m0, s32, 10240
  s_add_u32 s80, s68, 425984
  buffer_load_dwordx4 v101, s[28:31], s80 offen  lds
  s_waitcnt vmcnt(13)
  ds_read_b64_tr_b16 a[180:181], v115 offset:13312
  ds_read_b64_tr_b16 a[182:183], v115 offset:13824
  s_waitcnt lgkmcnt(4)
  s_add_u32 m0, s32, 11264
  s_add_u32 s80, s68, 442368
  buffer_load_dwordx4 v101, s[28:31], s80 offen  lds
  s_waitcnt vmcnt(13)
  ds_read_b64_tr_b16 a[184:185], v115 offset:14336
  ds_read_b64_tr_b16 a[186:187], v115 offset:14848
  s_waitcnt lgkmcnt(4)
  s_add_u32 m0, s32, 12288
  s_add_u32 s80, s68, 458752
  buffer_load_dwordx4 v101, s[28:31], s80 offen  lds
  s_waitcnt vmcnt(13)
  ds_read_b64_tr_b16 a[188:189], v115 offset:15360
  ds_read_b64_tr_b16 a[190:191], v115 offset:15872
  s_waitcnt lgkmcnt(4)
  s_add_u32 m0, s32, 13312
  s_add_u32 s80, s68, 475136
  buffer_load_dwordx4 v101, s[28:31], s80 offen  lds
  s_waitcnt vmcnt(13)
  ds_read_b64_tr_b16 a[192:193], v115 offset:0
  ds_read_b64_tr_b16 a[194:195], v115 offset:512
  s_waitcnt lgkmcnt(4)
  s_add_u32 m0, s32, 14336
  s_add_u32 s80, s68, 491520
  buffer_load_dwordx4 v101, s[28:31], s80 offen  lds
  s_waitcnt vmcnt(13)
  ds_read_b64_tr_b16 a[196:197], v115 offset:1024
  ds_read_b64_tr_b16 a[198:199], v115 offset:1536
  s_waitcnt lgkmcnt(4)
  s_add_u32 m0, s32, 15360
  s_add_u32 s80, s68, 507904
  buffer_load_dwordx4 v101, s[28:31], s80 offen  lds
  s_waitcnt vmcnt(13)
  ds_read_b64_tr_b16 a[200:201], v115 offset:2048
  ds_read_b64_tr_b16 a[202:203], v115 offset:2560
  s_waitcnt lgkmcnt(4)
  s_waitcnt vmcnt(12)
  ds_read_b64_tr_b16 a[204:205], v115 offset:3072
  ds_read_b64_tr_b16 a[206:207], v115 offset:3584
  s_waitcnt lgkmcnt(4)
  s_waitcnt vmcnt(11)
  ds_read_b64_tr_b16 a[208:209], v115 offset:4096
  ds_read_b64_tr_b16 a[210:211], v115 offset:4608
  s_waitcnt lgkmcnt(4)
  s_waitcnt vmcnt(10)
  ds_read_b64_tr_b16 a[212:213], v115 offset:5120
  ds_read_b64_tr_b16 a[214:215], v115 offset:5632
  s_waitcnt lgkmcnt(4)
  s_waitcnt vmcnt(9)
  ds_read_b64_tr_b16 a[216:217], v115 offset:6144
  ds_read_b64_tr_b16 a[218:219], v115 offset:6656
  s_waitcnt lgkmcnt(4)
  s_waitcnt vmcnt(8)
  ds_read_b64_tr_b16 a[220:221], v115 offset:7168
  ds_read_b64_tr_b16 a[222:223], v115 offset:7680
  s_waitcnt lgkmcnt(4)
  s_waitcnt vmcnt(7)
  ds_read_b64_tr_b16 a[224:225], v115 offset:8192
  ds_read_b64_tr_b16 a[226:227], v115 offset:8704
  s_waitcnt lgkmcnt(4)
  s_waitcnt vmcnt(6)
  ds_read_b64_tr_b16 a[228:229], v115 offset:9216
  ds_read_b64_tr_b16 a[230:231], v115 offset:9728
  s_waitcnt lgkmcnt(4)
  s_waitcnt vmcnt(5)
  ds_read_b64_tr_b16 a[232:233], v115 offset:10240
  ds_read_b64_tr_b16 a[234:235], v115 offset:10752
  s_waitcnt lgkmcnt(4)
  s_waitcnt vmcnt(4)
  ds_read_b64_tr_b16 a[236:237], v115 offset:11264
  ds_read_b64_tr_b16 a[238:239], v115 offset:11776
  s_waitcnt lgkmcnt(4)
  s_waitcnt vmcnt(3)
  ds_read_b64_tr_b16 a[240:241], v115 offset:12288
  ds_read_b64_tr_b16 a[242:243], v115 offset:12800
  s_waitcnt lgkmcnt(4)
  s_waitcnt vmcnt(2)
  ds_read_b64_tr_b16 a[244:245], v115 offset:13312
  ds_read_b64_tr_b16 a[246:247], v115 offset:13824
  s_waitcnt lgkmcnt(4)
  s_waitcnt vmcnt(1)
  ds_read_b64_tr_b16 a[248:249], v115 offset:14336
  ds_read_b64_tr_b16 a[250:251], v115 offset:14848
  s_waitcnt lgkmcnt(4)
  s_waitcnt vmcnt(0)
  ds_read_b64_tr_b16 a[252:253], v115 offset:15360
  ds_read_b64_tr_b16 a[254:255], v115 offset:15872
  s_waitcnt lgkmcnt(4)
  s_waitcnt lgkmcnt(0)
  s_lshl_b32 s21, s17, 2
  s_add_u32 s23, s77, s21
  s_waitcnt vmcnt(0)
  s_barrier
  s_cmp_lg_u32 s18, 0
  s_cbranch_scc1 flg_43
  v_mov_b32 v0, 1
  s_mov_b64 exec, 1
  buffer_store_dword v0, off, s[4:7], s23
  s_mov_b64 exec, -1
flg_43:
  v_lshrrev_b32 v0, 5, v112
  v_lshlrev_b32 v0, 11, v0
  v_and_b32 v1, 31, v112
  v_lshl_add_u32 v0, v1, 4, v0
  s_lshl_b32 s21, s18, 9
  v_add_u32 v114, s21, v0
  v_lshrrev_b32 v0, 4, v118
  v_lshlrev_b32 v0, 9, v0
  v_and_b32 v1, 15, v118
  v_add_u32 v0, v0, v1
  s_lshl_b32 s22, s17, 4
  v_add_u32 v127, s22, v0
  v_add_u32 v126, s32, v113
  v_and_b32 v0, 31, v112
  v_lshrrev_b32 v1, 5, v112
  v_lshlrev_b32 v1, 2, v1
  v_sub_u32 v0, v0, v1
  v_cmp_le_i32 s[36:37], 0, v0
  v_cmp_le_i32 s[38:39], 1, v0
  v_cmp_le_i32 s[40:41], 2, v0
  v_cmp_le_i32 s[42:43], 3, v0
  v_cmp_le_i32 s[44:45], 16, v0
  v_cmp_le_i32 s[46:47], 17, v0
  v_cmp_le_i32 s[48:49], 18, v0
  v_cmp_le_i32 s[50:51], 19, v0
  v_cmp_le_i32 s[52:53], 8, v0
  v_cmp_le_i32 s[54:55], 9, v0
  v_cmp_le_i32 s[56:57], 10, v0
  v_cmp_le_i32 s[58:59], 11, v0
  v_cmp_le_i32 s[60:61], 24, v0
  v_cmp_le_i32 s[62:63], 25, v0
  v_cmp_le_i32 s[64:65], 26, v0
  v_cmp_le_i32 s[66:67], 27, v0
  s_mov_b32 s68, 0x3db504f3
  s_mov_b32 s69, 0x3fb8aa3b
  s_mov_b32 s70, 0xbdd2d3e8
  s_mov_b32 s71, 0xc0135761
  s_load_dwordx2 s[8:9], s[0:1], 88
  s_mov_b32 s10, 0x400
  s_mov_b32 s11, 0x00020000
  s_waitcnt lgkmcnt(0)
  buffer_load_dword v12, v118, s[8:11], 0 offen
  s_load_dwordx2 s[8:9], s[0:1], 72
  s_mov_b32 s10, 0xe00
  s_mov_b32 s11, 0x00020000
  s_waitcnt lgkmcnt(0)
  v_lshrrev_b32 v0, 4, v112
  v_lshlrev_b32 v0, 3, v0
  s_lshl_b32 s21, s17, 7
  s_lshl_b32 s22, s18, 5
  s_add_u32 s21, s21, s22
  buffer_load_dwordx2 v[14:15], v0, s[8:11], s21 offen
  s_mov_b32 s33, 0
  v_lshlrev_b32 v1, 2, v112
  v_and_b32 v1, 127, v1
wk_pr_44:
  buffer_load_dword v0, v1, s[4:7], s77 offen sc1
  s_add_u32 s33, s33, 1
  s_cmp_gt_u32 s33, 4000000
  s_cbranch_scc1 wk_bail
  s_waitcnt vmcnt(0)
  v_cmp_eq_u32 vcc, 0, v0
  s_cbranch_vccnz wk_pr_44
  buffer_load_dword v8, v118, s[4:7], s34 offen offset:2048 sc1
  buffer_load_dword v9, v118, s[4:7], s34 offen offset:3072 sc1

  s_add_u32 s21, s34, 4096
  buffer_load_dword v10, v118, s[4:7], s21 offen offset:0 sc1
  buffer_load_dword v11, v118, s[4:7], s21 offen offset:1024 sc1
  s_waitcnt vmcnt(0)
  v_lshlrev_b32 v16, 16, v10
  v_and_b32 v17, 0xffff0000, v10
  v_add_f32 v16, 1.0, v16
  v_add_f32 v17, 1.0, v17
  v_cvt_pk_bf16_f32 v10, v16, v17
  v_mov_b32 v13, 0
  ds_write_b128 v126, v[8:11] offset:1024
  ds_write_b128 v126, v[12:15] offset:2048
  s_sub_u32 s20, s19, 1
  s_lshl_b32 s23, s20, 15
  s_add_u32 s23, s23, 1048576
  s_lshl_b32 s21, s18, 13
  s_add_u32 s22, s21, s23
  s_add_u32 m0, s21, 32768
  s_nop 0
  buffer_load_dwordx4 v113, s[4:7], s22 offen offset:0 sc1 lds
  buffer_load_dwordx4 v113, s[4:7], s22 offen offset:1024 sc1 lds
  buffer_load_dwordx4 v113, s[4:7], s22 offen offset:2048 sc1 lds
  buffer_load_dwordx4 v113, s[4:7], s22 offen offset:3072 sc1 lds
  s_add_u32 m0, s21, 36864
  s_add_u32 s22, s22, 4096
  buffer_load_dwordx4 v113, s[4:7], s22 offen offset:0 sc1 lds
  buffer_load_dwordx4 v113, s[4:7], s22 offen offset:1024 sc1 lds
  buffer_load_dwordx4 v113, s[4:7], s22 offen offset:2048 sc1 lds
  buffer_load_dwordx4 v113, s[4:7], s22 offen offset:3072 sc1 lds
  s_load_dwordx2 s[8:9], s[0:1], 0
  s_mov_b32 s10, 0x200000
  s_mov_b32 s11, 0x00020000
  s_waitcnt lgkmcnt(0)
  s_load_dwordx2 s[28:29], s[0:1], 112
  s_mov_b32 s30, 0x200000
  s_mov_b32 s31, 0x00020000
  s_waitcnt lgkmcnt(0)
w3_loop_f:
  s_lshl_b32 s21, s20, 5
  s_add_u32 s21, s21, s17
  s_lshl_b32 s76, s21, 10
  s_lshl_b32 s75, s21, 13
  s_waitcnt vmcnt(0)
  s_barrier
  s_lshl_b32 s21, s17, 12
  s_add_u32 s21, s21, s35
  s_add_u32 s21, s21, 0x180000
  v_mov_b64 v[88:89], -1
  v_mov_b64 v[90:91], -1
  buffer_store_dwordx4 v[88:91], v116, s[4:7], s21 offen
  s_add_u32 s21, s75, 4194304
  s_add_u32 s22, s75, 20971520
  buffer_load_dwordx4 v[48:51], v119, s[4:7], s21 offen offset:0 sc1
  buffer_load_dwordx4 v[52:55], v119, s[4:7], s21 offen offset:512 sc1
  buffer_load_dwordx4 v[56:59], v119, s[4:7], s21 offen offset:1024 sc1
  buffer_load_dwordx4 v[60:63], v119, s[4:7], s21 offen offset:1536 sc1
  buffer_load_dwordx4 v[64:67], v119, s[4:7], s21 offen offset:2048 sc1
  buffer_load_dwordx4 v[68:71], v119, s[4:7], s21 offen offset:2560 sc1
  buffer_load_dwordx4 v[72:75], v119, s[4:7], s21 offen offset:3072 sc1
  buffer_load_dwordx4 v[76:79], v119, s[4:7], s21 offen offset:3584 sc1
  buffer_load_dwordx4 v[80:83], v120, s[4:7], s22 offen offset:0 sc1
  buffer_load_dwordx4 v[84:87], v120, s[4:7], s22 offen offset:512 sc1
  buffer_load_dword v104, v118, s[8:11], s76 offen
  ds_read_b128 v[16:19], v113 offset:32768
  ds_read_b128 v[20:23], v113 offset:33792
  ds_read_b128 v[24:27], v113 offset:34816
  ds_read_b128 v[28:31], v113 offset:35840
  ds_read_b128 v[32:35], v113 offset:36864
  ds_read_b128 v[36:39], v113 offset:37888
  ds_read_b128 v[40:43], v113 offset:38912
  ds_read_b128 v[44:47], v113 offset:39936
  s_waitcnt lgkmcnt(7)
  v_mfma_f32_32x32x16_bf16 v[0:15], a[0:3], v[16:19], 0
  ds_read_b128 v[16:19], v113 offset:40960
  s_waitcnt lgkmcnt(7)
  v_mfma_f32_32x32x16_bf16 v[0:15], a[4:7], v[20:23], v[0:15]
  ds_read_b128 v[20:23], v113 offset:41984
  s_waitcnt lgkmcnt(7)
  v_mfma_f32_32x32x16_bf16 v[0:15], a[8:11], v[24:27], v[0:15]
  ds_read_b128 v[24:27], v113 offset:43008
  s_waitcnt lgkmcnt(7)
  v_mfma_f32_32x32x16_bf16 v[0:15], a[12:15], v[28:31], v[0:15]
  ds_read_b128 v[28:31], v113 offset:44032
  s_waitcnt lgkmcnt(7)
  v_mfma_f32_32x32x16_bf16 v[0:15], a[16:19], v[32:35], v[0:15]
  ds_read_b128 v[32:35], v113 offset:45056
  s_waitcnt lgkmcnt(7)
  v_mfma_f32_32x32x16_bf16 v[0:15], a[20:23], v[36:39], v[0:15]
  ds_read_b128 v[36:39], v113 offset:46080
  s_waitcnt lgkmcnt(7)
  v_mfma_f32_32x32x16_bf16 v[0:15], a[24:27], v[40:43], v[0:15]
  ds_read_b128 v[40:43], v113 offset:47104
  s_waitcnt lgkmcnt(7)
  v_mfma_f32_32x32x16_bf16 v[0:15], a[28:31], v[44:47], v[0:15]
  ds_read_b128 v[44:47], v113 offset:48128
  s_waitcnt lgkmcnt(7)
  v_mfma_f32_32x32x16_bf16 v[0:15], a[32:35], v[16:19], v[0:15]
  ds_read_b128 v[16:19], v113 offset:49152
  s_waitcnt lgkmcnt(7)
  v_mfma_f32_32x32x16_bf16 v[0:15], a[36:39], v[20:23], v[0:15]
  ds_read_b128 v[20:23], v113 offset:50176
  s_waitcnt lgkmcnt(7)
  v_mfma_f32_32x32x16_bf16 v[0:15], a[40:43], v[24:27], v[0:15]
  ds_read_b128 v[24:27], v113 offset:51200
  s_waitcnt lgkmcnt(7)
  v_mfma_f32_32x32x16_bf16 v[0:15], a[44:47], v[28:31], v[0:15]
  ds_read_b128 v[28:31], v113 offset:52224
  s_waitcnt lgkmcnt(7)
  v_mfma_f32_32x32x16_bf16 v[0:15], a[48:51], v[32:35], v[0:15]
  ds_read_b128 v[32:35], v113 offset:53248
  s_waitcnt lgkmcnt(7)
  v_mfma_f32_32x32x16_bf16 v[0:15], a[52:55], v[36:39], v[0:15]
  ds_read_b128 v[36:39], v113 offset:54272
  s_waitcnt lgkmcnt(7)
  v_mfma_f32_32x32x16_bf16 v[0:15], a[56:59], v[40:43], v[0:15]
  ds_read_b128 v[40:43], v113 offset:55296
  s_waitcnt lgkmcnt(7)
  v_mfma_f32_32x32x16_bf16 v[0:15], a[60:63], v[44:47], v[0:15]
  ds_read_b128 v[44:47], v113 offset:56320
  s_waitcnt lgkmcnt(7)
  v_mfma_f32_32x32x16_bf16 v[0:15], a[64:67], v[16:19], v[0:15]
  ds_read_b128 v[16:19], v113 offset:57344
  s_waitcnt lgkmcnt(7)
  v_mfma_f32_32x32x16_bf16 v[0:15], a[68:71], v[20:23], v[0:15]
  ds_read_b128 v[20:23], v113 offset:58368
  s_waitcnt lgkmcnt(7)
  v_mfma_f32_32x32x16_bf16 v[0:15], a[72:75], v[24:27], v[0:15]
  ds_read_b128 v[24:27], v113 offset:59392
  s_waitcnt lgkmcnt(7)
  v_mfma_f32_32x32x16_bf16 v[0:15], a[76:79], v[28:31], v[0:15]
  ds_read_b128 v[28:31], v113 offset:60416
  s_waitcnt lgkmcnt(7)
  v_mfma_f32_32x32x16_bf16 v[0:15], a[80:83], v[32:35], v[0:15]
  ds_read_b128 v[32:35], v113 offset:61440
  s_waitcnt lgkmcnt(7)
  v_mfma_f32_32x32x16_bf16 v[0:15], a[84:87], v[36:39], v[0:15]
  ds_read_b128 v[36:39], v113 offset:62464
  s_waitcnt lgkmcnt(7)
  v_mfma_f32_32x32x16_bf16 v[0:15], a[88:91], v[40:43], v[0:15]
  ds_read_b128 v[40:43], v113 offset:63488
  s_waitcnt lgkmcnt(7)
  v_mfma_f32_32x32x16_bf16 v[0:15], a[92:95], v[44:47], v[0:15]
  ds_read_b128 v[44:47], v113 offset:64512
  s_waitcnt lgkmcnt(7)
  v_mfma_f32_32x32x16_bf16 v[0:15], a[96:99], v[16:19], v[0:15]
  s_waitcnt lgkmcnt(6)
  v_mfma_f32_32x32x16_bf16 v[0:15], a[100:103], v[20:23], v[0:15]
  s_waitcnt lgkmcnt(5)
  v_mfma_f32_32x32x16_bf16 v[0:15], a[104:107], v[24:27], v[0:15]
  s_waitcnt lgkmcnt(4)
  v_mfma_f32_32x32x16_bf16 v[0:15], a[108:111], v[28:31], v[0:15]
  s_waitcnt lgkmcnt(3)
  v_mfma_f32_32x32x16_bf16 v[0:15], a[112:115], v[32:35], v[0:15]
  s_waitcnt lgkmcnt(2)
  v_mfma_f32_32x32x16_bf16 v[0:15], a[116:119], v[36:39], v[0:15]
  s_waitcnt lgkmcnt(1)
  v_mfma_f32_32x32x16_bf16 v[0:15], a[120:123], v[40:43], v[0:15]
  s_waitcnt lgkmcnt(0)
  v_mfma_f32_32x32x16_bf16 v[0:15], a[124:127], v[44:47], v[0:15]
  s_nop 11
  v_cvt_pk_bf16_f32 v88, v0, v1
  v_cvt_pk_bf16_f32 v89, v2, v3
  v_cvt_pk_bf16_f32 v90, v4, v5
  v_cvt_pk_bf16_f32 v91, v6, v7
  v_cvt_pk_bf16_f32 v92, v8, v9
  v_cvt_pk_bf16_f32 v93, v10, v11
  v_cvt_pk_bf16_f32 v94, v12, v13
  v_cvt_pk_bf16_f32 v95, v14, v15
  ds_write_b128 v107, v[88:91] offset:0
  ds_write_b128 v107, v[92:95] offset:1024
  s_waitcnt lgkmcnt(0)
  s_barrier
  ds_read_b128 v[16:19], v113 offset:0
  ds_read_b128 v[20:23], v113 offset:1024
  ds_read_b128 v[24:27], v113 offset:2048
  ds_read_b128 v[28:31], v113 offset:3072
  ds_read_b128 v[32:35], v113 offset:4096
  ds_read_b128 v[36:39], v113 offset:5120
  ds_read_b128 v[40:43], v113 offset:6144
  ds_read_b128 v[44:47], v113 offset:7168
  s_waitcnt vmcnt(0)
  s_add_u32 s24, s20, 7
  s_cmp_ge_u32 s24, 64
  s_cbranch_scc1 w3nopf_45
  s_lshl_b32 s23, s24, 15
  s_add_u32 s23, s23, 1048576
  s_lshl_b32 s21, s18, 13
  s_add_u32 s22, s21, s23
  s_add_u32 m0, s21, 32768
  s_nop 0
  buffer_load_dwordx4 v113, s[4:7], s22 offen offset:0 sc1 lds
  buffer_load_dwordx4 v113, s[4:7], s22 offen offset:1024 sc1 lds
  buffer_load_dwordx4 v113, s[4:7], s22 offen offset:2048 sc1 lds
  buffer_load_dwordx4 v113, s[4:7], s22 offen offset:3072 sc1 lds
  s_add_u32 m0, s21, 36864
  s_add_u32 s22, s22, 4096
  buffer_load_dwordx4 v113, s[4:7], s22 offen offset:0 sc1 lds
  buffer_load_dwordx4 v113, s[4:7], s22 offen offset:1024 sc1 lds
  buffer_load_dwordx4 v113, s[4:7], s22 offen offset:2048 sc1 lds
  buffer_load_dwordx4 v113, s[4:7], s22 offen offset:3072 sc1 lds
w3nopf_45:
  s_waitcnt lgkmcnt(7)
  v_mfma_f32_32x32x16_bf16 v[0:15], v[48:51], v[16:19], 0
  s_waitcnt lgkmcnt(6)
  v_mfma_f32_32x32x16_bf16 v[0:15], v[52:55], v[20:23], v[0:15]
  s_waitcnt lgkmcnt(5)
  v_mfma_f32_32x32x16_bf16 v[0:15], v[56:59], v[24:27], v[0:15]
  s_waitcnt lgkmcnt(4)
  v_mfma_f32_32x32x16_bf16 v[0:15], v[60:63], v[28:31], v[0:15]
  s_waitcnt lgkmcnt(3)
  v_mfma_f32_32x32x16_bf16 v[0:15], v[64:67], v[32:35], v[0:15]
  s_waitcnt lgkmcnt(2)
  v_mfma_f32_32x32x16_bf16 v[0:15], v[68:71], v[36:39], v[0:15]
  s_waitcnt lgkmcnt(1)
  v_mfma_f32_32x32x16_bf16 v[0:15], v[72:75], v[40:43], v[0:15]
  s_waitcnt lgkmcnt(0)
  v_mfma_f32_32x32x16_bf16 v[0:15], v[76:79], v[44:47], v[0:15]
  v_mov_b32 v108, 0xce6e6b28
  s_lshl_b32 s21, s17, 11
  s_lshl_b32 s22, s20, 4
  s_add_u32 s21, s21, s22
  s_add_u32 s23, s21, 720912
  s_sub_u32 s22, s23, s22
  s_sub_u32 s22, s22, 16
  s_lshl_b32 s21, s18, 11
  s_add_u32 s24, s21, s75
  s_add_u32 s24, s24, 37748736
  s_nop 5
  v_cvt_pk_bf16_f32 v109, v0, v1
  v_lshlrev_b32 v0, 16, v109
  v_and_b32 v1, 0xffff0000, v109
  v_cvt_pk_bf16_f32 v109, v2, v3
  v_lshlrev_b32 v2, 16, v109
  v_and_b32 v3, 0xffff0000, v109
  v_cvt_pk_bf16_f32 v109, v4, v5
  v_lshlrev_b32 v4, 16, v109
  v_and_b32 v5, 0xffff0000, v109
  v_cvt_pk_bf16_f32 v109, v6, v7
  v_lshlrev_b32 v6, 16, v109
  v_and_b32 v7, 0xffff0000, v109
  v_cvt_pk_bf16_f32 v109, v8, v9
  v_lshlrev_b32 v8, 16, v109
  v_and_b32 v9, 0xffff0000, v109
  v_cvt_pk_bf16_f32 v109, v10, v11
  v_lshlrev_b32 v10, 16, v109
  v_and_b32 v11, 0xffff0000, v109
  v_cvt_pk_bf16_f32 v109, v12, v13
  v_lshlrev_b32 v12, 16, v109
  v_and_b32 v13, 0xffff0000, v109
  v_cvt_pk_bf16_f32 v109, v14, v15
  v_lshlrev_b32 v14, 16, v109
  v_and_b32 v15, 0xffff0000, v109
  v_mul_f32 v0, s68, v0
  v_mul_f32 v1, s68, v1
  v_mul_f32 v2, s68, v2
  v_mul_f32 v3, s68, v3
  v_mul_f32 v4, s68, v4
  v_mul_f32 v5, s68, v5
  v_mul_f32 v6, s68, v6
  v_mul_f32 v7, s68, v7
  v_mul_f32 v8, s68, v8
  v_mul_f32 v9, s68, v9
  v_mul_f32 v10, s68, v10
  v_mul_f32 v11, s68, v11
  v_mul_f32 v12, s68, v12
  v_mul_f32 v13, s68, v13
  v_mul_f32 v14, s68, v14
  v_mul_f32 v15, s68, v15
  v_cvt_pk_bf16_f32 v109, v0, v1
  v_lshlrev_b32 v0, 16, v109
  v_and_b32 v1, 0xffff0000, v109
  v_cvt_pk_bf16_f32 v109, v2, v3
  v_lshlrev_b32 v2, 16, v109
  v_and_b32 v3, 0xffff0000, v109
  v_cvt_pk_bf16_f32 v109, v4, v5
  v_lshlrev_b32 v4, 16, v109
  v_and_b32 v5, 0xffff0000, v109
  v_cvt_pk_bf16_f32 v109, v6, v7
  v_lshlrev_b32 v6, 16, v109
  v_and_b32 v7, 0xffff0000, v109
  v_cvt_pk_bf16_f32 v109, v8, v9
  v_lshlrev_b32 v8, 16, v109
  v_and_b32 v9, 0xffff0000, v109
  v_cvt_pk_bf16_f32 v109, v10, v11
  v_lshlrev_b32 v10, 16, v109
  v_and_b32 v11, 0xffff0000, v109
  v_cvt_pk_bf16_f32 v109, v12, v13
  v_lshlrev_b32 v12, 16, v109
  v_and_b32 v13, 0xffff0000, v109
  v_cvt_pk_bf16_f32 v109, v14, v15
  v_lshlrev_b32 v14, 16, v109
  v_and_b32 v15, 0xffff0000, v109
  v_cndmask_b32 v0, v108, v0, s[36:37]
  v_cndmask_b32 v1, v108, v1, s[38:39]
  v_cndmask_b32 v2, v108, v2, s[40:41]
  v_cndmask_b32 v3, v108, v3, s[42:43]
  v_cndmask_b32 v4, v108, v4, s[44:45]
  v_cndmask_b32 v5, v108, v5, s[46:47]
  v_cndmask_b32 v6, v108, v6, s[48:49]
  v_cndmask_b32 v7, v108, v7, s[50:51]
  v_cndmask_b32 v8, v108, v8, s[52:53]
  v_cndmask_b32 v9, v108, v9, s[54:55]
  v_cndmask_b32 v10, v108, v10, s[56:57]
  v_cndmask_b32 v11, v108, v11, s[58:59]
  v_cndmask_b32 v12, v108, v12, s[60:61]
  v_cndmask_b32 v13, v108, v13, s[62:63]
  v_cndmask_b32 v14, v108, v14, s[64:65]
  v_cndmask_b32 v15, v108, v15, s[66:67]
  v_max_f32 v105, v0, v1
  v_max3_f32 v105, v105, v2, v3
  v_max3_f32 v105, v105, v4, v5
  v_max3_f32 v105, v105, v6, v7
  v_max3_f32 v105, v105, v8, v9
  v_max3_f32 v105, v105, v10, v11
  v_max3_f32 v105, v105, v12, v13
  v_max3_f32 v105, v105, v14, v15
  v_mov_b32 v109, v105
  s_nop 1
  v_permlane32_swap_b32 v105, v109
  v_max_f32 v105, v105, v109
  v_sub_f32 v0, v0, v105
  v_sub_f32 v1, v1, v105
  v_sub_f32 v2, v2, v105
  v_sub_f32 v3, v3, v105
  v_sub_f32 v4, v4, v105
  v_sub_f32 v5, v5, v105
  v_sub_f32 v6, v6, v105
  v_sub_f32 v7, v7, v105
  v_sub_f32 v8, v8, v105
  v_sub_f32 v9, v9, v105
  v_sub_f32 v10, v10, v105
  v_sub_f32 v11, v11, v105
  v_sub_f32 v12, v12, v105
  v_sub_f32 v13, v13, v105
  v_sub_f32 v14, v14, v105
  v_sub_f32 v15, v15, v105
  v_mul_f32 v0, s69, v0
  v_mul_f32 v1, s69, v1
  v_mul_f32 v2, s69, v2
  v_mul_f32 v3, s69, v3
  v_mul_f32 v4, s69, v4
  v_mul_f32 v5, s69, v5
  v_mul_f32 v6, s69, v6
  v_mul_f32 v7, s69, v7
  v_mul_f32 v8, s69, v8
  v_mul_f32 v9, s69, v9
  v_mul_f32 v10, s69, v10
  v_mul_f32 v11, s69, v11
  v_mul_f32 v12, s69, v12
  v_mul_f32 v13, s69, v13
  v_mul_f32 v14, s69, v14
  v_mul_f32 v15, s69, v15
  v_exp_f32 v0, v0
  v_exp_f32 v1, v1
  v_exp_f32 v2, v2
  v_exp_f32 v3, v3
  v_exp_f32 v4, v4
  v_exp_f32 v5, v5
  v_exp_f32 v6, v6
  v_exp_f32 v7, v7
  v_exp_f32 v8, v8
  v_exp_f32 v9, v9
  v_exp_f32 v10, v10
  v_exp_f32 v11, v11
  v_exp_f32 v12, v12
  v_exp_f32 v13, v13
  v_exp_f32 v14, v14
  v_exp_f32 v15, v15
  v_add_f32 v106, v0, v1
  v_add_f32 v106, v106, v2
  v_add_f32 v106, v106, v3
  v_add_f32 v106, v106, v4
  v_add_f32 v106, v106, v5
  v_add_f32 v106, v106, v6
  v_add_f32 v106, v106, v7
  v_add_f32 v106, v106, v8
  v_add_f32 v106, v106, v9
  v_add_f32 v106, v106, v10
  v_add_f32 v106, v106, v11
  v_add_f32 v106, v106, v12
  v_add_f32 v106, v106, v13
  v_add_f32 v106, v106, v14
  v_add_f32 v106, v106, v15
  s_lshl_b32 s80, s18, 10
  s_add_u32 m0, s80, 16384
  v_lshlrev_b32 v110, 2, v112
  v_and_b32 v110, 15, v110
  s_mov_b32 s33, 0
wk_pg_46:
  s_sub_u32 s21, s23, 16
  s_max_u32 s21, s21, s22
  buffer_load_dword v109, off, s[4:7], s21 sc1
  s_add_u32 s33, s33, 1
  s_cmp_gt_u32 s33, 4000000
  s_cbranch_scc1 wk_bail
  s_waitcnt vmcnt(0)
  v_cmp_ne_u32 vcc, 0, v109
  s_cbranch_vccnz wk_pg_46_x
  s_sleep 16
  s_branch wk_pg_46
wk_pg_46_x:
  s_cmp_lt_u32 s20, 63
  s_cbranch_scc1 wk_pk_47
  s_mov_b32 s33, 0
wk_pl_48:
  buffer_load_dwordx4 v[48:51], v113, s[4:7], s24 offen sc1
  s_add_u32 s33, s33, 1
  s_cmp_gt_u32 s33, 4000000
  s_cbranch_scc1 wk_bail
  s_waitcnt vmcnt(0)
  v_max_u32 v109, v48, v49
  v_max3_u32 v109, v109, v50, v51
  v_cmp_eq_u32 vcc, -1, v109
  s_cbranch_vccnz wk_pl_48
  ds_write_b128 v116, v[48:51] offset:16384
  s_waitcnt lgkmcnt(0)
  s_branch wk_pk_47_x
wk_pk_47:
  buffer_load_dword v109, v110, s[4:7], s23 offen sc1
  buffer_load_dwordx4 v113, s[4:7], s24 offen sc1 lds
  s_add_u32 s33, s33, 1
  s_cmp_gt_u32 s33, 4000000
  s_cbranch_scc1 wk_bail
  s_waitcnt vmcnt(0)
  v_cmp_ne_u32 vcc, 0, v109
  s_cmp_eq_u64 vcc, exec
  s_cbranch_scc1 wk_pk_47_x
  s_branch wk_pk_47
wk_pk_47_x:
  s_barrier
  ds_read_b64_tr_b16 v[48:49], v121 offset:16384
  ds_read_b64_tr_b16 v[50:51], v121 offset:16512
  ds_read_b64_tr_b16 v[52:53], v121 offset:16896
  ds_read_b64_tr_b16 v[54:55], v121 offset:17024
  ds_read_b64_tr_b16 v[56:57], v121 offset:17408
  ds_read_b64_tr_b16 v[58:59], v121 offset:17536
  ds_read_b64_tr_b16 v[60:61], v121 offset:17920
  ds_read_b64_tr_b16 v[62:63], v121 offset:18048
  ds_read_b64_tr_b16 v[64:65], v121 offset:18432
  ds_read_b64_tr_b16 v[66:67], v121 offset:18560
  ds_read_b64_tr_b16 v[68:69], v121 offset:18944
  ds_read_b64_tr_b16 v[70:71], v121 offset:19072
  ds_read_b64_tr_b16 v[72:73], v121 offset:19456
  ds_read_b64_tr_b16 v[74:75], v121 offset:19584
  ds_read_b64_tr_b16 v[76:77], v121 offset:19968
  ds_read_b64_tr_b16 v[78:79], v121 offset:20096
  s_waitcnt lgkmcnt(14)
  v_mfma_f32_32x32x16_bf16 v[88:103], v[48:51], v[16:19], 0
  s_waitcnt lgkmcnt(12)
  v_mfma_f32_32x32x16_bf16 v[88:103], v[52:55], v[20:23], v[88:103]
  s_waitcnt lgkmcnt(10)
  v_mfma_f32_32x32x16_bf16 v[88:103], v[56:59], v[24:27], v[88:103]
  s_waitcnt lgkmcnt(8)
  v_mfma_f32_32x32x16_bf16 v[88:103], v[60:63], v[28:31], v[88:103]
  s_waitcnt lgkmcnt(6)
  v_mfma_f32_32x32x16_bf16 v[88:103], v[64:67], v[32:35], v[88:103]
  s_waitcnt lgkmcnt(4)
  v_mfma_f32_32x32x16_bf16 v[88:103], v[68:71], v[36:39], v[88:103]
  s_waitcnt lgkmcnt(2)
  v_mfma_f32_32x32x16_bf16 v[88:103], v[72:75], v[40:43], v[88:103]
  s_waitcnt lgkmcnt(0)
  v_mfma_f32_32x32x16_bf16 v[88:103], v[76:79], v[44:47], v[88:103]
  ds_read_b64 v[48:49], v122 offset:16384
  v_mov_b64 v[50:51], 0
  v_mov_b64 v[66:67], 0
  s_nop 8
  v_cvt_pk_bf16_f32 v109, v88, v89
  v_lshlrev_b32 v88, 16, v109
  v_and_b32 v89, 0xffff0000, v109
  v_cvt_pk_bf16_f32 v109, v90, v91
  v_lshlrev_b32 v90, 16, v109
  v_and_b32 v91, 0xffff0000, v109
  v_mul_f32 v88, s68, v88
  v_mul_f32 v89, s68, v89
  v_mul_f32 v90, s68, v90
  v_mul_f32 v91, s68, v91
  v_cvt_pk_bf16_f32 v109, v88, v89
  v_lshlrev_b32 v88, 16, v109
  v_and_b32 v89, 0xffff0000, v109
  v_cvt_pk_bf16_f32 v109, v90, v91
  v_lshlrev_b32 v90, 16, v109
  v_and_b32 v91, 0xffff0000, v109
  v_max3_f32 v52, v88, v89, v90
  v_max3_f32 v52, v52, v91, v105
  v_mov_b32 v109, v52
  s_nop 1
  v_permlane32_swap_b32 v52, v109
  v_max_f32 v52, v52, v109
  v_sub_f32 v54, v105, v52
  v_sub_f32 v88, v88, v52
  v_sub_f32 v89, v89, v52
  v_sub_f32 v90, v90, v52
  v_sub_f32 v91, v91, v52
  v_mul_f32 v54, s69, v54
  v_mul_f32 v88, s69, v88
  v_mul_f32 v89, s69, v89
  v_mul_f32 v90, s69, v90
  v_mul_f32 v91, s69, v91
  v_exp_f32 v54, v54
  v_exp_f32 v88, v88
  v_exp_f32 v89, v89
  v_exp_f32 v90, v90
  v_exp_f32 v91, v91
  v_mul_f32 v52, v54, v106
  v_add_f32 v110, v88, v89
  v_add_f32 v52, v52, v90
  v_add_f32 v110, v110, v91
  v_add_f32 v52, v52, v110
  v_mov_b32 v109, v52
  s_nop 1
  v_permlane32_swap_b32 v52, v109
  v_add_f32 v52, v52, v109
  v_rcp_f32 v52, v52
  s_nop 0
  v_mul_f32 v54, v54, v52
  v_pk_mul_f32 v[88:89], v[88:89], v[52:53] op_sel_hi:[1,0]
  v_pk_mul_f32 v[90:91], v[90:91], v[52:53] op_sel_hi:[1,0]
  v_pk_mul_f32 v[0:1], v[0:1], v[54:55] op_sel_hi:[1,0]
  v_cvt_pk_bf16_f32 v56, v0, v1
  v_pk_mul_f32 v[2:3], v[2:3], v[54:55] op_sel_hi:[1,0]
  v_cvt_pk_bf16_f32 v57, v2, v3
  v_pk_mul_f32 v[4:5], v[4:5], v[54:55] op_sel_hi:[1,0]
  v_cvt_pk_bf16_f32 v58, v4, v5
  v_pk_mul_f32 v[6:7], v[6:7], v[54:55] op_sel_hi:[1,0]
  v_cvt_pk_bf16_f32 v59, v6, v7
  v_pk_mul_f32 v[8:9], v[8:9], v[54:55] op_sel_hi:[1,0]
  v_cvt_pk_bf16_f32 v60, v8, v9
  v_pk_mul_f32 v[10:11], v[10:11], v[54:55] op_sel_hi:[1,0]
  v_cvt_pk_bf16_f32 v61, v10, v11
  v_pk_mul_f32 v[12:13], v[12:13], v[54:55] op_sel_hi:[1,0]
  v_cvt_pk_bf16_f32 v62, v12, v13
  v_pk_mul_f32 v[14:15], v[14:15], v[54:55] op_sel_hi:[1,0]
  v_cvt_pk_bf16_f32 v63, v14, v15
  v_cvt_pk_bf16_f32 v64, v88, v89
  v_cvt_pk_bf16_f32 v65, v90, v91
  s_waitcnt lgkmcnt(0)
  v_mfma_f32_32x32x16_bf16 v[16:31], v[80:83], v[56:59], 0
  v_mfma_f32_32x32x16_bf16 v[16:31], v[84:87], v[60:63], v[16:31]
  v_mfma_f32_32x32x16_bf16 v[16:31], v[48:51], v[64:67], v[16:31]
  s_nop 11
  s_lshl_b32 s21, s17, 13
  s_add_u32 s75, s21, s35
  s_add_u32 s75, s75, 0x100000
  v_cvt_pk_bf16_f32 v96, v16, v17
  v_cvt_pk_bf16_f32 v97, v18, v19
  v_cvt_pk_bf16_f32 v98, v20, v21
  v_cvt_pk_bf16_f32 v99, v22, v23
  buffer_store_dwordx4 v[96:99], v107, s[4:7], s75 offen
  v_cvt_pk_bf16_f32 v100, v24, v25
  v_cvt_pk_bf16_f32 v101, v26, v27
  v_cvt_pk_bf16_f32 v102, v28, v29
  v_cvt_pk_bf16_f32 v103, v30, v31
  buffer_store_dwordx4 v[100:103], v107, s[4:7], s75 offen offset:1024
  s_andn2_b32 s21, s17, 3
  s_add_u32 s21, s21, s18
  s_lshl_b32 s21, s21, 13
  s_add_u32 s23, s21, s35
  s_add_u32 s23, s23, 0x100000
  s_add_u32 s24, s23, 4096
  s_mul_i32 s21, s18, 8192
  v_add_u32 v41, s21, v113
  v_add_u32 v41, 32768, v41
  v_add_u32 v42, 32768, v113
  s_mov_b32 s33, 0
wk_pog_49:
  buffer_load_dwordx4 v[0:3], v113, s[4:7], s23 offen offset:0 sc1
  buffer_load_dwordx4 v[4:7], v113, s[4:7], s23 offen offset:1024 sc1
  buffer_load_dwordx4 v[8:11], v113, s[4:7], s23 offen offset:2048 sc1
  buffer_load_dwordx4 v[12:15], v113, s[4:7], s23 offen offset:3072 sc1
  buffer_load_dwordx4 v[16:19], v113, s[4:7], s24 offen offset:0 sc1
  buffer_load_dwordx4 v[20:23], v113, s[4:7], s24 offen offset:1024 sc1
  buffer_load_dwordx4 v[24:27], v113, s[4:7], s24 offen offset:2048 sc1
  buffer_load_dwordx4 v[28:31], v113, s[4:7], s24 offen offset:3072 sc1
  s_add_u32 s33, s33, 1
  s_cmp_gt_u32 s33, 4000000
  s_cbranch_scc1 wk_bail
  s_waitcnt vmcnt(0)
  v_max_u32 v40, v0, v1
  v_max3_u32 v40, v40, v2, v3
  v_max3_u32 v40, v40, v4, v5
  v_max3_u32 v40, v40, v6, v7
  v_max3_u32 v40, v40, v8, v9
  v_max3_u32 v40, v40, v10, v11
  v_max3_u32 v40, v40, v12, v13
  v_max3_u32 v40, v40, v14, v15
  v_max3_u32 v40, v40, v16, v17
  v_max3_u32 v40, v40, v18, v19
  v_max3_u32 v40, v40, v20, v21
  v_max3_u32 v40, v40, v22, v23
  v_max3_u32 v40, v40, v24, v25
  v_max3_u32 v40, v40, v26, v27
  v_max3_u32 v40, v40, v28, v29
  v_max3_u32 v40, v40, v30, v31
  v_cmp_eq_u32 vcc, -1, v40
  s_cbranch_vccnz wk_pog_49
  ds_write_b128 v41, v[0:3] offset:32768
  ds_write_b128 v41, v[4:7] offset:33792
  ds_write_b128 v41, v[8:11] offset:34816
  ds_write_b128 v41, v[12:15] offset:35840
  ds_write_b128 v41, v[16:19] offset:36864
  ds_write_b128 v41, v[20:23] offset:37888
  ds_write_b128 v41, v[24:27] offset:38912
  ds_write_b128 v41, v[28:31] offset:39936
  s_waitcnt lgkmcnt(0)
  s_barrier
  ds_read_b128 v[0:3], v42 offset:32768
  ds_read_b128 v[4:7], v42 offset:33792
  ds_read_b128 v[8:11], v42 offset:34816
  ds_read_b128 v[12:15], v42 offset:35840
  ds_read_b128 v[16:19], v42 offset:36864
  ds_read_b128 v[20:23], v42 offset:37888
  ds_read_b128 v[24:27], v42 offset:38912
  ds_read_b128 v[28:31], v42 offset:39936
  s_waitcnt lgkmcnt(7)
  v_mfma_f32_32x32x16_bf16 v[48:63], v[0:3], a[128:131], 0
  ds_read_b128 v[0:3], v42 offset:40960
  s_waitcnt lgkmcnt(7)
  v_mfma_f32_32x32x16_bf16 v[48:63], v[4:7], a[132:135], v[48:63]
  ds_read_b128 v[4:7], v42 offset:41984
  s_waitcnt lgkmcnt(7)
  v_mfma_f32_32x32x16_bf16 v[48:63], v[8:11], a[136:139], v[48:63]
  ds_read_b128 v[8:11], v42 offset:43008
  s_waitcnt lgkmcnt(7)
  v_mfma_f32_32x32x16_bf16 v[48:63], v[12:15], a[140:143], v[48:63]
  ds_read_b128 v[12:15], v42 offset:44032
  s_waitcnt lgkmcnt(7)
  v_mfma_f32_32x32x16_bf16 v[48:63], v[16:19], a[144:147], v[48:63]
  ds_read_b128 v[16:19], v42 offset:45056
  s_waitcnt lgkmcnt(7)
  v_mfma_f32_32x32x16_bf16 v[48:63], v[20:23], a[148:151], v[48:63]
  ds_read_b128 v[20:23], v42 offset:46080
  s_waitcnt lgkmcnt(7)
  v_mfma_f32_32x32x16_bf16 v[48:63], v[24:27], a[152:155], v[48:63]
  ds_read_b128 v[24:27], v42 offset:47104
  s_waitcnt lgkmcnt(7)
  v_mfma_f32_32x32x16_bf16 v[48:63], v[28:31], a[156:159], v[48:63]
  ds_read_b128 v[28:31], v42 offset:48128
  s_waitcnt lgkmcnt(7)
  v_mfma_f32_32x32x16_bf16 v[48:63], v[0:3], a[160:163], v[48:63]
  ds_read_b128 v[0:3], v42 offset:49152
  s_waitcnt lgkmcnt(7)
  v_mfma_f32_32x32x16_bf16 v[48:63], v[4:7], a[164:167], v[48:63]
  ds_read_b128 v[4:7], v42 offset:50176
  s_waitcnt lgkmcnt(7)
  v_mfma_f32_32x32x16_bf16 v[48:63], v[8:11], a[168:171], v[48:63]
  ds_read_b128 v[8:11], v42 offset:51200
  s_waitcnt lgkmcnt(7)
  v_mfma_f32_32x32x16_bf16 v[48:63], v[12:15], a[172:175], v[48:63]
  ds_read_b128 v[12:15], v42 offset:52224
  s_waitcnt lgkmcnt(7)
  v_mfma_f32_32x32x16_bf16 v[48:63], v[16:19], a[176:179], v[48:63]
  ds_read_b128 v[16:19], v42 offset:53248
  s_waitcnt lgkmcnt(7)
  v_mfma_f32_32x32x16_bf16 v[48:63], v[20:23], a[180:183], v[48:63]
  ds_read_b128 v[20:23], v42 offset:54272
  s_waitcnt lgkmcnt(7)
  v_mfma_f32_32x32x16_bf16 v[48:63], v[24:27], a[184:187], v[48:63]
  ds_read_b128 v[24:27], v42 offset:55296
  s_waitcnt lgkmcnt(7)
  v_mfma_f32_32x32x16_bf16 v[48:63], v[28:31], a[188:191], v[48:63]
  ds_read_b128 v[28:31], v42 offset:56320
  s_waitcnt lgkmcnt(7)
  v_mfma_f32_32x32x16_bf16 v[48:63], v[0:3], a[192:195], v[48:63]
  ds_read_b128 v[0:3], v42 offset:57344
  s_waitcnt lgkmcnt(7)
  v_mfma_f32_32x32x16_bf16 v[48:63], v[4:7], a[196:199], v[48:63]
  ds_read_b128 v[4:7], v42 offset:58368
  s_waitcnt lgkmcnt(7)
  v_mfma_f32_32x32x16_bf16 v[48:63], v[8:11], a[200:203], v[48:63]
  ds_read_b128 v[8:11], v42 offset:59392
  s_waitcnt lgkmcnt(7)
  v_mfma_f32_32x32x16_bf16 v[48:63], v[12:15], a[204:207], v[48:63]
  ds_read_b128 v[12:15], v42 offset:60416
  s_waitcnt lgkmcnt(7)
  v_mfma_f32_32x32x16_bf16 v[48:63], v[16:19], a[208:211], v[48:63]
  ds_read_b128 v[16:19], v42 offset:61440
  s_waitcnt lgkmcnt(7)
  v_mfma_f32_32x32x16_bf16 v[48:63], v[20:23], a[212:215], v[48:63]
  ds_read_b128 v[20:23], v42 offset:62464
  s_waitcnt lgkmcnt(7)
  v_mfma_f32_32x32x16_bf16 v[48:63], v[24:27], a[216:219], v[48:63]
  ds_read_b128 v[24:27], v42 offset:63488
  s_waitcnt lgkmcnt(7)
  v_mfma_f32_32x32x16_bf16 v[48:63], v[28:31], a[220:223], v[48:63]
  ds_read_b128 v[28:31], v42 offset:64512
  s_waitcnt lgkmcnt(7)
  v_mfma_f32_32x32x16_bf16 v[48:63], v[0:3], a[224:227], v[48:63]
  s_waitcnt lgkmcnt(6)
  v_mfma_f32_32x32x16_bf16 v[48:63], v[4:7], a[228:231], v[48:63]
  s_waitcnt lgkmcnt(5)
  v_mfma_f32_32x32x16_bf16 v[48:63], v[8:11], a[232:235], v[48:63]
  s_waitcnt lgkmcnt(4)
  v_mfma_f32_32x32x16_bf16 v[48:63], v[12:15], a[236:239], v[48:63]
  s_waitcnt lgkmcnt(3)
  v_mfma_f32_32x32x16_bf16 v[48:63], v[16:19], a[240:243], v[48:63]
  s_waitcnt lgkmcnt(2)
  v_mfma_f32_32x32x16_bf16 v[48:63], v[20:23], a[244:247], v[48:63]
  s_waitcnt lgkmcnt(1)
  v_mfma_f32_32x32x16_bf16 v[48:63], v[24:27], a[248:251], v[48:63]
  s_waitcnt lgkmcnt(0)
  v_mfma_f32_32x32x16_bf16 v[48:63], v[28:31], a[252:255], v[48:63]
  s_nop 11
  s_add_u32 s21, s72, 0
  buffer_store_dword v48, v117, s[4:7], s21 offen
  s_add_u32 s21, s72, 16384
  buffer_store_dword v49, v117, s[4:7], s21 offen
  s_add_u32 s21, s72, 32768
  buffer_store_dword v50, v117, s[4:7], s21 offen
  s_add_u32 s21, s72, 49152
  buffer_store_dword v51, v117, s[4:7], s21 offen
  s_add_u32 s21, s72, 131072
  buffer_store_dword v52, v117, s[4:7], s21 offen
  s_add_u32 s21, s72, 147456
  buffer_store_dword v53, v117, s[4:7], s21 offen
  s_add_u32 s21, s72, 163840
  buffer_store_dword v54, v117, s[4:7], s21 offen
  s_add_u32 s21, s72, 180224
  buffer_store_dword v55, v117, s[4:7], s21 offen
  s_add_u32 s21, s72, 262144
  buffer_store_dword v56, v117, s[4:7], s21 offen
  s_add_u32 s21, s72, 278528
  buffer_store_dword v57, v117, s[4:7], s21 offen
  s_add_u32 s21, s72, 294912
  buffer_store_dword v58, v117, s[4:7], s21 offen
  s_add_u32 s21, s72, 311296
  buffer_store_dword v59, v117, s[4:7], s21 offen
  s_add_u32 s21, s72, 393216
  buffer_store_dword v60, v117, s[4:7], s21 offen
  s_add_u32 s21, s72, 409600
  buffer_store_dword v61, v117, s[4:7], s21 offen
  s_add_u32 s21, s72, 425984
  buffer_store_dword v62, v117, s[4:7], s21 offen
  s_add_u32 s21, s72, 442368
  buffer_store_dword v63, v117, s[4:7], s21 offen
  ds_read_b128 v[64:67], v126 offset:1024
  ds_read_b128 v[68:71], v126 offset:2048
  v_mov_b64 v[40:41], -1
  v_mov_b64 v[42:43], -1

  s_mov_b32 s33, 0
wk_prs_50:
  s_add_u32 s21, s73, 0
  buffer_load_dwordx4 v[0:3], v114, s[4:7], s21 offen sc1
  s_add_u32 s21, s73, 4096
  buffer_load_dwordx4 v[4:7], v114, s[4:7], s21 offen sc1
  s_add_u32 s21, s73, 8192
  buffer_load_dwordx4 v[8:11], v114, s[4:7], s21 offen sc1
  s_add_u32 s21, s73, 12288
  buffer_load_dwordx4 v[12:15], v114, s[4:7], s21 offen sc1
  s_add_u32 s33, s33, 1
  s_cmp_gt_u32 s33, 4000000
  s_cbranch_scc1 wk_bail
  s_waitcnt vmcnt(0)
  v_max_u32 v36, v0, v1
  v_max3_u32 v36, v36, v2, v3
  v_max3_u32 v36, v36, v4, v5
  v_max3_u32 v36, v36, v6, v7
  v_max3_u32 v36, v36, v8, v9
  v_max3_u32 v36, v36, v10, v11
  v_max3_u32 v36, v36, v12, v13
  v_max3_u32 v36, v36, v14, v15
  v_cmp_eq_u32 vcc, -1, v36
  s_cbranch_vccnz wk_prs_50
  v_pk_add_f32 v[0:1], v[0:1], v[4:5]
  v_pk_add_f32 v[8:9], v[8:9], v[12:13]
  v_pk_add_f32 v[2:3], v[2:3], v[6:7]
  v_pk_add_f32 v[10:11], v[10:11], v[14:15]
  v_pk_add_f32 v[0:1], v[0:1], v[8:9]
  v_pk_add_f32 v[2:3], v[2:3], v[10:11]
  s_add_u32 s21, s73, 0
  buffer_store_dwordx4 v[40:43], v114, s[4:7], s21 offen
  s_add_u32 s21, s73, 4096
  buffer_store_dwordx4 v[40:43], v114, s[4:7], s21 offen
  s_add_u32 s21, s73, 8192
  buffer_store_dwordx4 v[40:43], v114, s[4:7], s21 offen
  s_add_u32 s21, s73, 12288
  buffer_store_dwordx4 v[40:43], v114, s[4:7], s21 offen
  v_permlane32_swap_b32 v0, v2
  v_permlane32_swap_b32 v1, v3
  v_pk_add_f32 v[32:33], v[0:1], v[2:3]
  s_waitcnt lgkmcnt(0)
  v_cvt_pk_bf16_f32 v36, v32, v33
  v_lshlrev_b32 v32, 16, v36
  v_and_b32 v33, 0xffff0000, v36
  v_lshlrev_b32 v0, 16, v64
  v_and_b32 v1, 0xffff0000, v64
  v_pk_mul_f32 v[32:33], v[32:33], v[0:1]
  v_lshlrev_b32 v2, 16, v104
  v_and_b32 v3, 0xffff0000, v104
  v_cvt_pk_bf16_f32 v36, v32, v33
  v_lshlrev_b32 v32, 16, v36
  v_and_b32 v33, 0xffff0000, v36
  v_pk_add_f32 v[32:33], v[32:33], v[2:3]
  v_cvt_pk_bf16_f32 v104, v32, v33
  v_lshlrev_b32 v32, 16, v104
  v_and_b32 v33, 0xffff0000, v104
  v_add_f32 v36, v32, v33
  s_nop 1
  v_add_f32_dpp v36, v36, v36 quad_perm:[1,0,3,2] row_mask:0xf bank_mask:0xf
  s_nop 1
  v_add_f32_dpp v36, v36, v36 quad_perm:[2,3,0,1] row_mask:0xf bank_mask:0xf
  s_nop 1
  v_add_f32_dpp v36, v36, v36 row_ror:4 row_mask:0xf bank_mask:0xf
  s_nop 1
  v_add_f32_dpp v36, v36, v36 row_ror:8 row_mask:0xf bank_mask:0xf
  v_mov_b32 v38, v36
  s_nop 1
  v_permlane16_swap_b32 v36, v38
  v_add_f32 v36, v36, v38
  v_mov_b32 v38, v36
  s_nop 1
  v_permlane32_swap_b32 v36, v38
  v_add_f32 v36, v36, v38
  v_mul_f32 v36, 0x3c000000, v36
  v_sub_f32 v34, v32, v36
  v_sub_f32 v35, v33, v36
  v_mul_f32 v37, v34, v34
  v_fmac_f32 v37, v35, v35
  s_nop 1
  v_add_f32_dpp v37, v37, v37 quad_perm:[1,0,3,2] row_mask:0xf bank_mask:0xf
  s_nop 1
  v_add_f32_dpp v37, v37, v37 quad_perm:[2,3,0,1] row_mask:0xf bank_mask:0xf
  s_nop 1
  v_add_f32_dpp v37, v37, v37 row_ror:4 row_mask:0xf bank_mask:0xf
  s_nop 1
  v_add_f32_dpp v37, v37, v37 row_ror:8 row_mask:0xf bank_mask:0xf
  v_mov_b32 v38, v37
  s_nop 1
  v_permlane16_swap_b32 v37, v38
  v_add_f32 v37, v37, v38
  v_mov_b32 v38, v37
  s_nop 1
  v_permlane32_swap_b32 v37, v38
  v_add_f32 v37, v37, v38
  s_lshl_b32 s21, s18, 3
  v_mov_b32 v38, s21
  ds_write_b64 v38, v[36:37] offset:26624
  v_mov_b32 v38, 0
  v_lshlrev_b32 v8, 16, v65
  v_and_b32 v9, 0xffff0000, v65
  v_lshlrev_b32 v10, 16, v66
  v_and_b32 v11, 0xffff0000, v66
  s_waitcnt vmcnt(0) lgkmcnt(0)
  s_barrier
  ds_read_b128 v[0:3], v38 offset:26624
  ds_read_b128 v[4:7], v38 offset:26640
  buffer_store_dwordx4 v[40:43], v107, s[4:7], s75 offen
  buffer_store_dwordx4 v[40:43], v107, s[4:7], s75 offen offset:1024
  s_waitcnt lgkmcnt(0)
  v_add_f32 v36, v0, v2
  v_add_f32 v38, v4, v6
  v_add_f32 v37, v1, v3
  v_add_f32 v36, v36, v38
  v_add_f32 v39, v5, v7
  v_mul_f32 v36, 0x3e800000, v36
  v_add_f32 v37, v37, v39
  v_sub_f32 v0, v0, v36
  v_sub_f32 v2, v2, v36
  v_sub_f32 v4, v4, v36
  v_sub_f32 v6, v6, v36
  v_mul_f32 v38, v0, v0
  v_fmac_f32 v38, v2, v2
  v_fmac_f32 v38, v4, v4
  v_fmac_f32 v38, v6, v6
  v_mul_f32 v38, 0x43000000, v38
  v_add_f32 v37, v37, v38
  v_mul_f32 v38, 0x3b000000, v37
  v_cvt_pk_bf16_f32 v38, v38, v38
  v_lshlrev_b32 v38, 16, v38
  v_add_f32 v38, 0x3727c5ac, v38
  v_cvt_pk_bf16_f32 v38, v38, v38
  v_lshlrev_b32 v38, 16, v38
  v_sqrt_f32 v38, v38
  v_cvt_pk_bf16_f32 v36, v36, v36
  v_lshlrev_b32 v36, 16, v36
  v_cvt_pk_bf16_f32 v38, v38, v38
  v_lshlrev_b32 v38, 16, v38
  v_rcp_f32 v38, v38
  v_sub_f32 v34, v32, v36
  v_sub_f32 v35, v33, v36
  v_cvt_pk_bf16_f32 v37, v34, v35
  v_lshlrev_b32 v34, 16, v37
  v_and_b32 v35, 0xffff0000, v37
  v_pk_mul_f32 v[34:35], v[34:35], v[38:39] op_sel_hi:[1,0]
  v_cvt_pk_bf16_f32 v37, v34, v35
  v_lshlrev_b32 v34, 16, v37
  v_and_b32 v35, 0xffff0000, v37
  v_pk_mul_f32 v[34:35], v[34:35], v[10:11]
  v_cvt_pk_bf16_f32 v37, v34, v35
  v_lshlrev_b32 v34, 16, v37
  v_and_b32 v35, 0xffff0000, v37
  v_pk_add_f32 v[34:35], v[34:35], v[8:9]
  v_cvt_pk_bf16_f32 v37, v34, v35
  v_min_u32 v37, 0xfffffffe, v37
  s_cmp_lt_u32 s17, 28
  s_cbranch_scc1 w3q_51
  s_waitcnt vmcnt(0)
w3q_51:
  s_xor_b32 s21, s74, 32768
  buffer_store_dword v37, v127, s[4:7], s74 offen
  buffer_store_dword v40, v127, s[4:7], s21 offen
  s_cmp_ge_u32 s17, 28
  s_cbranch_scc1 w3noffn_52
  v_lshlrev_b32 v108, 16, v70
  v_and_b32 v109, 0xffff0000, v70
  v_lshlrev_b32 v110, 16, v71
  v_and_b32 v111, 0xffff0000, v71
  s_lshl_b32 s23, s18, 13
  s_add_u32 s23, s23, s74
  s_add_u32 s24, s23, 4096
  s_mul_i32 s21, s18, 8192
  v_add_u32 v41, s21, v113
  v_add_u32 v41, 32768, v41
  v_add_u32 v42, 32768, v113
  s_mov_b32 s33, 0
wk_pag_53:
  buffer_load_dwordx4 v[0:3], v113, s[4:7], s23 offen offset:0 sc1
  buffer_load_dwordx4 v[4:7], v113, s[4:7], s23 offen offset:1024 sc1
  buffer_load_dwordx4 v[8:11], v113, s[4:7], s23 offen offset:2048 sc1
  buffer_load_dwordx4 v[12:15], v113, s[4:7], s23 offen offset:3072 sc1
  buffer_load_dwordx4 v[16:19], v113, s[4:7], s24 offen offset:0 sc1
  buffer_load_dwordx4 v[20:23], v113, s[4:7], s24 offen offset:1024 sc1
  buffer_load_dwordx4 v[24:27], v113, s[4:7], s24 offen offset:2048 sc1
  buffer_load_dwordx4 v[28:31], v113, s[4:7], s24 offen offset:3072 sc1
  s_add_u32 s33, s33, 1
  s_cmp_gt_u32 s33, 4000000
  s_cbranch_scc1 wk_bail
  s_waitcnt vmcnt(0)
  v_max_u32 v40, v0, v1
  v_max3_u32 v40, v40, v2, v3
  v_max3_u32 v40, v40, v4, v5
  v_max3_u32 v40, v40, v6, v7
  v_max3_u32 v40, v40, v8, v9
  v_max3_u32 v40, v40, v10, v11
  v_max3_u32 v40, v40, v12, v13
  v_max3_u32 v40, v40, v14, v15
  v_max3_u32 v40, v40, v16, v17
  v_max3_u32 v40, v40, v18, v19
  v_max3_u32 v40, v40, v20, v21
  v_max3_u32 v40, v40, v22, v23
  v_max3_u32 v40, v40, v24, v25
  v_max3_u32 v40, v40, v26, v27
  v_max3_u32 v40, v40, v28, v29
  v_max3_u32 v40, v40, v30, v31
  v_cmp_eq_u32 vcc, -1, v40
  s_cbranch_vccnz wk_pag_53
  ds_write_b128 v41, v[0:3] offset:32768
  ds_write_b128 v41, v[4:7] offset:33792
  ds_write_b128 v41, v[8:11] offset:34816
  ds_write_b128 v41, v[12:15] offset:35840
  ds_write_b128 v41, v[16:19] offset:36864
  ds_write_b128 v41, v[20:23] offset:37888
  ds_write_b128 v41, v[24:27] offset:38912
  ds_write_b128 v41, v[28:31] offset:39936
  s_waitcnt lgkmcnt(0)
  s_barrier
  v_add_u32 v42, 32768, v124
  ds_read_b128 v[0:3], v42 offset:32768
  ds_read_b128 v[4:7], v42 offset:33024
  ds_read_b128 v[8:11], v42 offset:34816
  ds_read_b128 v[12:15], v42 offset:35072
  ds_read_b128 v[16:19], v42 offset:36864
  ds_read_b128 v[20:23], v42 offset:37120
  ds_read_b128 v[24:27], v42 offset:38912
  ds_read_b128 v[28:31], v42 offset:39168
  s_waitcnt lgkmcnt(7)
  v_mfma_f32_16x16x32_bf16 v[32:35], v[128:131], v[0:3], 0
  ds_read_b128 v[0:3], v42 offset:40960
  s_waitcnt lgkmcnt(7)
  v_mfma_f32_16x16x32_bf16 v[36:39], v[128:131], v[4:7], 0
  ds_read_b128 v[4:7], v42 offset:41216
  s_waitcnt lgkmcnt(7)
  v_mfma_f32_16x16x32_bf16 v[32:35], v[132:135], v[8:11], v[32:35]
  ds_read_b128 v[8:11], v42 offset:43008
  s_waitcnt lgkmcnt(7)
  v_mfma_f32_16x16x32_bf16 v[36:39], v[132:135], v[12:15], v[36:39]
  ds_read_b128 v[12:15], v42 offset:43264
  s_waitcnt lgkmcnt(7)
  v_mfma_f32_16x16x32_bf16 v[32:35], v[136:139], v[16:19], v[32:35]
  ds_read_b128 v[16:19], v42 offset:45056
  s_waitcnt lgkmcnt(7)
  v_mfma_f32_16x16x32_bf16 v[36:39], v[136:139], v[20:23], v[36:39]
  ds_read_b128 v[20:23], v42 offset:45312
  s_waitcnt lgkmcnt(7)
  v_mfma_f32_16x16x32_bf16 v[32:35], v[140:143], v[24:27], v[32:35]
  ds_read_b128 v[24:27], v42 offset:47104
  s_waitcnt lgkmcnt(7)
  v_mfma_f32_16x16x32_bf16 v[36:39], v[140:143], v[28:31], v[36:39]
  ds_read_b128 v[28:31], v42 offset:47360
  s_waitcnt lgkmcnt(7)
  v_mfma_f32_16x16x32_bf16 v[32:35], v[144:147], v[0:3], v[32:35]
  ds_read_b128 v[0:3], v42 offset:49152
  s_waitcnt lgkmcnt(7)
  v_mfma_f32_16x16x32_bf16 v[36:39], v[144:147], v[4:7], v[36:39]
  ds_read_b128 v[4:7], v42 offset:49408
  s_waitcnt lgkmcnt(7)
  v_mfma_f32_16x16x32_bf16 v[32:35], v[148:151], v[8:11], v[32:35]
  ds_read_b128 v[8:11], v42 offset:51200
  s_waitcnt lgkmcnt(7)
  v_mfma_f32_16x16x32_bf16 v[36:39], v[148:151], v[12:15], v[36:39]
  ds_read_b128 v[12:15], v42 offset:51456
  s_waitcnt lgkmcnt(7)
  v_mfma_f32_16x16x32_bf16 v[32:35], v[152:155], v[16:19], v[32:35]
  ds_read_b128 v[16:19], v42 offset:53248
  s_waitcnt lgkmcnt(7)
  v_mfma_f32_16x16x32_bf16 v[36:39], v[152:155], v[20:23], v[36:39]
  ds_read_b128 v[20:23], v42 offset:53504
  s_waitcnt lgkmcnt(7)
  v_mfma_f32_16x16x32_bf16 v[32:35], v[156:159], v[24:27], v[32:35]
  ds_read_b128 v[24:27], v42 offset:55296
  s_waitcnt lgkmcnt(7)
  v_mfma_f32_16x16x32_bf16 v[36:39], v[156:159], v[28:31], v[36:39]
  ds_read_b128 v[28:31], v42 offset:55552
  s_waitcnt lgkmcnt(7)
  v_mfma_f32_16x16x32_bf16 v[32:35], v[160:163], v[0:3], v[32:35]
  ds_read_b128 v[0:3], v42 offset:57344
  s_waitcnt lgkmcnt(7)
  v_mfma_f32_16x16x32_bf16 v[36:39], v[160:163], v[4:7], v[36:39]
  ds_read_b128 v[4:7], v42 offset:57600
  s_waitcnt lgkmcnt(7)
  v_mfma_f32_16x16x32_bf16 v[32:35], v[164:167], v[8:11], v[32:35]
  ds_read_b128 v[8:11], v42 offset:59392
  s_waitcnt lgkmcnt(7)
  v_mfma_f32_16x16x32_bf16 v[36:39], v[164:167], v[12:15], v[36:39]
  ds_read_b128 v[12:15], v42 offset:59648
  s_waitcnt lgkmcnt(7)
  v_mfma_f32_16x16x32_bf16 v[32:35], v[168:171], v[16:19], v[32:35]
  ds_read_b128 v[16:19], v42 offset:61440
  s_waitcnt lgkmcnt(7)
  v_mfma_f32_16x16x32_bf16 v[36:39], v[168:171], v[20:23], v[36:39]
  ds_read_b128 v[20:23], v42 offset:61696
  s_waitcnt lgkmcnt(7)
  v_mfma_f32_16x16x32_bf16 v[32:35], v[172:175], v[24:27], v[32:35]
  ds_read_b128 v[24:27], v42 offset:63488
  s_waitcnt lgkmcnt(7)
  v_mfma_f32_16x16x32_bf16 v[36:39], v[172:175], v[28:31], v[36:39]
  ds_read_b128 v[28:31], v42 offset:63744
  s_waitcnt lgkmcnt(7)
  v_mfma_f32_16x16x32_bf16 v[32:35], v[176:179], v[0:3], v[32:35]
  s_waitcnt lgkmcnt(6)
  v_mfma_f32_16x16x32_bf16 v[36:39], v[176:179], v[4:7], v[36:39]
  s_waitcnt lgkmcnt(5)
  v_mfma_f32_16x16x32_bf16 v[32:35], v[180:183], v[8:11], v[32:35]
  s_waitcnt lgkmcnt(4)
  v_mfma_f32_16x16x32_bf16 v[36:39], v[180:183], v[12:15], v[36:39]
  s_waitcnt lgkmcnt(3)
  v_mfma_f32_16x16x32_bf16 v[32:35], v[184:187], v[16:19], v[32:35]
  s_waitcnt lgkmcnt(2)
  v_mfma_f32_16x16x32_bf16 v[36:39], v[184:187], v[20:23], v[36:39]
  s_waitcnt lgkmcnt(1)
  v_mfma_f32_16x16x32_bf16 v[32:35], v[188:191], v[24:27], v[32:35]
  s_waitcnt lgkmcnt(0)
  v_mfma_f32_16x16x32_bf16 v[36:39], v[188:191], v[28:31], v[36:39]
  v_mov_b32 v40, s71
  s_nop 6
  v_cvt_pk_bf16_f32 v41, v32, v33
  v_lshlrev_b32 v32, 16, v41
  v_and_b32 v33, 0xffff0000, v41
  v_cvt_pk_bf16_f32 v41, v34, v35
  v_lshlrev_b32 v34, 16, v41
  v_and_b32 v35, 0xffff0000, v41
  v_cvt_pk_bf16_f32 v41, v36, v37
  v_lshlrev_b32 v36, 16, v41
  v_and_b32 v37, 0xffff0000, v41
  v_cvt_pk_bf16_f32 v41, v38, v39
  v_lshlrev_b32 v38, 16, v41
  v_and_b32 v39, 0xffff0000, v41
  v_pk_add_f32 v[32:33], v[32:33], v[108:109]
  v_pk_add_f32 v[34:35], v[34:35], v[110:111]
  v_pk_add_f32 v[36:37], v[36:37], v[108:109]
  v_pk_add_f32 v[38:39], v[38:39], v[110:111]
  v_cvt_pk_bf16_f32 v41, v32, v33
  v_lshlrev_b32 v32, 16, v41
  v_and_b32 v33, 0xffff0000, v41
  v_cvt_pk_bf16_f32 v41, v34, v35
  v_lshlrev_b32 v34, 16, v41
  v_and_b32 v35, 0xffff0000, v41
  v_cvt_pk_bf16_f32 v41, v36, v37
  v_lshlrev_b32 v36, 16, v41
  v_and_b32 v37, 0xffff0000, v41
  v_cvt_pk_bf16_f32 v41, v38, v39
  v_lshlrev_b32 v38, 16, v41
  v_and_b32 v39, 0xffff0000, v41
  v_pk_mul_f32 v[0:1], v[32:33], v[32:33]
  v_pk_mul_f32 v[2:3], v[34:35], v[34:35]
  v_pk_mul_f32 v[4:5], v[36:37], v[36:37]
  v_pk_mul_f32 v[6:7], v[38:39], v[38:39]
  v_fma_f32 v0, v0, s70, v40
  v_fma_f32 v1, v1, s70, v40
  v_fma_f32 v2, v2, s70, v40
  v_fma_f32 v3, v3, s70, v40
  v_fma_f32 v4, v4, s70, v40
  v_fma_f32 v5, v5, s70, v40
  v_fma_f32 v6, v6, s70, v40
  v_fma_f32 v7, v7, s70, v40
  v_pk_mul_f32 v[0:1], v[0:1], v[32:33]
  v_pk_mul_f32 v[2:3], v[2:3], v[34:35]
  v_pk_mul_f32 v[4:5], v[4:5], v[36:37]
  v_pk_mul_f32 v[6:7], v[6:7], v[38:39]
  v_exp_f32 v0, v0
  v_exp_f32 v1, v1
  v_exp_f32 v2, v2
  v_exp_f32 v3, v3
  v_exp_f32 v4, v4
  v_exp_f32 v5, v5
  v_exp_f32 v6, v6
  v_exp_f32 v7, v7
  v_add_f32 v0, 1.0, v0
  v_add_f32 v1, 1.0, v1
  v_add_f32 v2, 1.0, v2
  v_add_f32 v3, 1.0, v3
  v_add_f32 v4, 1.0, v4
  v_add_f32 v5, 1.0, v5
  v_add_f32 v6, 1.0, v6
  v_add_f32 v7, 1.0, v7
  v_rcp_f32 v0, v0
  v_rcp_f32 v1, v1
  v_rcp_f32 v2, v2
  v_rcp_f32 v3, v3
  v_rcp_f32 v4, v4
  v_rcp_f32 v5, v5
  v_rcp_f32 v6, v6
  v_rcp_f32 v7, v7
  v_pk_mul_f32 v[32:33], v[32:33], v[0:1]
  v_cvt_pk_bf16_f32 v8, v32, v33
  v_pk_mul_f32 v[34:35], v[34:35], v[2:3]
  v_cvt_pk_bf16_f32 v9, v34, v35
  v_pk_mul_f32 v[36:37], v[36:37], v[4:5]
  v_cvt_pk_bf16_f32 v10, v36, v37
  v_pk_mul_f32 v[38:39], v[38:39], v[6:7]
  v_cvt_pk_bf16_f32 v11, v38, v39
  s_lshl_b32 s21, s17, 12
  s_add_u32 s75, s21, s35
  s_add_u32 s75, s75, 0x180000
  v_min_u32 v8, 0xfffffffe, v8
  v_min_u32 v9, 0xfffffffe, v9
  v_min_u32 v10, 0xfffffffe, v10
  v_min_u32 v11, 0xfffffffe, v11
  buffer_store_dwordx2 v[8:9], v123, s[4:7], s75 offen
  buffer_store_dwordx2 v[10:11], v123, s[4:7], s75 offen offset:256
  s_barrier
  s_andn2_b32 s21, s17, 3
  s_add_u32 s21, s21, s18
  s_lshl_b32 s21, s21, 12
  s_add_u32 s23, s21, s35
  s_add_u32 s23, s23, 0x180000
  s_add_u32 s24, s23, 4096
  s_mul_i32 s21, s18, 4096
  v_add_u32 v41, s21, v113
  v_add_u32 v41, 32768, v41
  v_add_u32 v42, 32768, v113
  s_mov_b32 s33, 0
wk_pfg_54:
  buffer_load_dwordx4 v[0:3], v113, s[4:7], s23 offen offset:0 sc1
  buffer_load_dwordx4 v[4:7], v113, s[4:7], s23 offen offset:1024 sc1
  buffer_load_dwordx4 v[8:11], v113, s[4:7], s23 offen offset:2048 sc1
  buffer_load_dwordx4 v[12:15], v113, s[4:7], s23 offen offset:3072 sc1
  s_add_u32 s33, s33, 1
  s_cmp_gt_u32 s33, 4000000
  s_cbranch_scc1 wk_bail
  s_waitcnt vmcnt(0)
  v_max_u32 v40, v0, v1
  v_max3_u32 v40, v40, v2, v3
  v_max3_u32 v40, v40, v4, v5
  v_max3_u32 v40, v40, v6, v7
  v_max3_u32 v40, v40, v8, v9
  v_max3_u32 v40, v40, v10, v11
  v_max3_u32 v40, v40, v12, v13
  v_max3_u32 v40, v40, v14, v15
  v_cmp_eq_u32 vcc, -1, v40
  s_cbranch_vccnz wk_pfg_54
  ds_write_b128 v41, v[0:3] offset:32768
  ds_write_b128 v41, v[4:7] offset:33792
  ds_write_b128 v41, v[8:11] offset:34816
  ds_write_b128 v41, v[12:15] offset:35840
  s_waitcnt lgkmcnt(0)
  s_barrier
  ds_read_b128 v[0:3], v42 offset:32768
  ds_read_b128 v[4:7], v42 offset:33792
  ds_read_b128 v[8:11], v42 offset:34816
  ds_read_b128 v[12:15], v42 offset:35840
  ds_read_b128 v[16:19], v42 offset:36864
  ds_read_b128 v[20:23], v42 offset:37888
  ds_read_b128 v[24:27], v42 offset:38912
  ds_read_b128 v[28:31], v42 offset:39936
  s_waitcnt lgkmcnt(7)
  v_mfma_f32_32x32x16_bf16 v[48:63], v[0:3], v[192:195], 0
  ds_read_b128 v[0:3], v42 offset:40960
  s_waitcnt lgkmcnt(7)
  v_mfma_f32_32x32x16_bf16 v[48:63], v[4:7], v[196:199], v[48:63]
  ds_read_b128 v[4:7], v42 offset:41984
  s_waitcnt lgkmcnt(7)
  v_mfma_f32_32x32x16_bf16 v[48:63], v[8:11], v[200:203], v[48:63]
  ds_read_b128 v[8:11], v42 offset:43008
  s_waitcnt lgkmcnt(7)
  v_mfma_f32_32x32x16_bf16 v[48:63], v[12:15], v[204:207], v[48:63]
  ds_read_b128 v[12:15], v42 offset:44032
  s_waitcnt lgkmcnt(7)
  v_mfma_f32_32x32x16_bf16 v[48:63], v[16:19], v[208:211], v[48:63]
  ds_read_b128 v[16:19], v42 offset:45056
  s_waitcnt lgkmcnt(7)
  v_mfma_f32_32x32x16_bf16 v[48:63], v[20:23], v[212:215], v[48:63]
  ds_read_b128 v[20:23], v42 offset:46080
  s_waitcnt lgkmcnt(7)
  v_mfma_f32_32x32x16_bf16 v[48:63], v[24:27], v[216:219], v[48:63]
  ds_read_b128 v[24:27], v42 offset:47104
  s_waitcnt lgkmcnt(7)
  v_mfma_f32_32x32x16_bf16 v[48:63], v[28:31], v[220:223], v[48:63]
  ds_read_b128 v[28:31], v42 offset:48128
  s_waitcnt lgkmcnt(7)
  v_mfma_f32_32x32x16_bf16 v[48:63], v[0:3], v[224:227], v[48:63]
  s_waitcnt lgkmcnt(6)
  v_mfma_f32_32x32x16_bf16 v[48:63], v[4:7], v[228:231], v[48:63]
  s_waitcnt lgkmcnt(5)
  v_mfma_f32_32x32x16_bf16 v[48:63], v[8:11], v[232:235], v[48:63]
  s_waitcnt lgkmcnt(4)
  v_mfma_f32_32x32x16_bf16 v[48:63], v[12:15], v[236:239], v[48:63]
  s_waitcnt lgkmcnt(3)
  v_mfma_f32_32x32x16_bf16 v[48:63], v[16:19], v[240:243], v[48:63]
  s_waitcnt lgkmcnt(2)
  v_mfma_f32_32x32x16_bf16 v[48:63], v[20:23], v[244:247], v[48:63]
  s_waitcnt lgkmcnt(1)
  v_mfma_f32_32x32x16_bf16 v[48:63], v[24:27], v[248:251], v[48:63]
  s_waitcnt lgkmcnt(0)
  v_mfma_f32_32x32x16_bf16 v[48:63], v[28:31], v[252:255], v[48:63]
  s_nop 11
  s_add_u32 s21, s72, 524288
  buffer_store_dword v48, v117, s[4:7], s21 offen
  s_add_u32 s21, s72, 540672
  buffer_store_dword v49, v117, s[4:7], s21 offen
  s_add_u32 s21, s72, 557056
  buffer_store_dword v50, v117, s[4:7], s21 offen
  s_add_u32 s21, s72, 573440
  buffer_store_dword v51, v117, s[4:7], s21 offen
  s_add_u32 s21, s72, 655360
  buffer_store_dword v52, v117, s[4:7], s21 offen
  s_add_u32 s21, s72, 671744
  buffer_store_dword v53, v117, s[4:7], s21 offen
  s_add_u32 s21, s72, 688128
  buffer_store_dword v54, v117, s[4:7], s21 offen
  s_add_u32 s21, s72, 704512
  buffer_store_dword v55, v117, s[4:7], s21 offen
  s_add_u32 s21, s72, 786432
  buffer_store_dword v56, v117, s[4:7], s21 offen
  s_add_u32 s21, s72, 802816
  buffer_store_dword v57, v117, s[4:7], s21 offen
  s_add_u32 s21, s72, 819200
  buffer_store_dword v58, v117, s[4:7], s21 offen
  s_add_u32 s21, s72, 835584
  buffer_store_dword v59, v117, s[4:7], s21 offen
  s_add_u32 s21, s72, 917504
  buffer_store_dword v60, v117, s[4:7], s21 offen
  s_add_u32 s21, s72, 933888
  buffer_store_dword v61, v117, s[4:7], s21 offen
  s_add_u32 s21, s72, 950272
  buffer_store_dword v62, v117, s[4:7], s21 offen
  s_add_u32 s21, s72, 966656
  buffer_store_dword v63, v117, s[4:7], s21 offen
w3noffn_52:
  ds_read_b128 v[64:67], v126 offset:1024
  ds_read_b128 v[68:71], v126 offset:2048
  v_mov_b64 v[40:41], -1
  v_mov_b64 v[42:43], -1
  v_mov_b64 v[12:13], 0
  v_mov_b64 v[14:15], 0

  s_mov_b32 s33, 0
wk_prs_55:
  s_add_u32 s21, s73, 524288
  buffer_load_dwordx4 v[0:3], v114, s[4:7], s21 offen sc1
  s_add_u32 s21, s73, 528384
  buffer_load_dwordx4 v[4:7], v114, s[4:7], s21 offen sc1
  s_add_u32 s21, s73, 532480
  buffer_load_dwordx4 v[8:11], v114, s[4:7], s21 offen sc1
  s_add_u32 s21, s73, 536576
  s_mov_b64 exec, s[78:79]
  buffer_load_dwordx4 v[12:15], v114, s[4:7], s21 offen sc1
  s_mov_b64 exec, -1
  s_add_u32 s33, s33, 1
  s_cmp_gt_u32 s33, 4000000
  s_cbranch_scc1 wk_bail
  s_waitcnt vmcnt(0)
  v_max_u32 v36, v0, v1
  v_max3_u32 v36, v36, v2, v3
  v_max3_u32 v36, v36, v4, v5
  v_max3_u32 v36, v36, v6, v7
  v_max3_u32 v36, v36, v8, v9
  v_max3_u32 v36, v36, v10, v11
  v_max3_u32 v36, v36, v12, v13
  v_max3_u32 v36, v36, v14, v15
  v_cmp_eq_u32 vcc, -1, v36
  s_cbranch_vccnz wk_prs_55
  v_pk_add_f32 v[0:1], v[0:1], v[4:5]
  v_pk_add_f32 v[8:9], v[8:9], v[12:13]
  v_pk_add_f32 v[2:3], v[2:3], v[6:7]
  v_pk_add_f32 v[10:11], v[10:11], v[14:15]
  v_pk_add_f32 v[0:1], v[0:1], v[8:9]
  v_pk_add_f32 v[2:3], v[2:3], v[10:11]
  s_add_u32 s21, s73, 524288
  buffer_store_dwordx4 v[40:43], v114, s[4:7], s21 offen
  s_add_u32 s21, s73, 528384
  buffer_store_dwordx4 v[40:43], v114, s[4:7], s21 offen
  s_add_u32 s21, s73, 532480
  buffer_store_dwordx4 v[40:43], v114, s[4:7], s21 offen
  s_add_u32 s21, s73, 536576
  s_mov_b64 exec, s[78:79]
  buffer_store_dwordx4 v[40:43], v114, s[4:7], s21 offen
  s_mov_b64 exec, -1
  v_permlane32_swap_b32 v0, v2
  v_permlane32_swap_b32 v1, v3
  v_pk_add_f32 v[32:33], v[0:1], v[2:3]
  s_waitcnt lgkmcnt(0)
  v_cvt_pk_bf16_f32 v36, v32, v33
  v_lshlrev_b32 v32, 16, v36
  v_and_b32 v33, 0xffff0000, v36
  v_lshlrev_b32 v0, 16, v68
  v_and_b32 v1, 0xffff0000, v68
  v_pk_add_f32 v[32:33], v[32:33], v[0:1]
  v_lshlrev_b32 v2, 16, v67
  v_and_b32 v3, 0xffff0000, v67
  v_cvt_pk_bf16_f32 v36, v32, v33
  v_lshlrev_b32 v32, 16, v36
  v_and_b32 v33, 0xffff0000, v36
  v_pk_mul_f32 v[32:33], v[32:33], v[2:3]
  v_lshlrev_b32 v0, 16, v104
  v_and_b32 v1, 0xffff0000, v104
  v_cvt_pk_bf16_f32 v36, v32, v33
  v_lshlrev_b32 v32, 16, v36
  v_and_b32 v33, 0xffff0000, v36
  v_pk_add_f32 v[32:33], v[32:33], v[0:1]
  v_cvt_pk_bf16_f32 v36, v32, v33
  buffer_store_dword v36, v118, s[28:31], s76 offen
  s_xor_b32 s74, s74, 32768
  s_add_u32 s20, s20, 7
  s_cmp_lt_u32 s20, 64
  s_cbranch_scc1 w3_loop_f
  s_branch wk_bail
worker_slow:
  s_load_dwordx2 s[8:9], s[0:1], 104
  s_mov_b32 s10, 0x300000
  s_mov_b32 s11, 0x00020000
  s_waitcnt lgkmcnt(0)
  v_lshrrev_b32 v0, 2, v112
  s_lshl_b32 s21, s18, 7
  v_add_u32 v0, s21, v0
  v_mul_u32_u24 v0, 6144, v0
  v_and_b32 v1, 3, v112
  v_lshl_add_u32 v0, v1, 4, v0
  s_mul_i32 s21, s17, 128
  s_add_u32 s21, s21, 2048
  s_lshl_b32 s22, s18, 14
  s_add_u32 s22, s22, 32768
  s_add_u32 m0, s22, 0
  s_add_u32 s80, s21, 0
  buffer_load_dwordx4 v0, s[8:11], s80 offen lds
  s_add_u32 m0, s22, 1024
  s_add_u32 s80, s21, 98304
  buffer_load_dwordx4 v0, s[8:11], s80 offen lds
  s_add_u32 m0, s22, 2048
  s_add_u32 s80, s21, 196608
  buffer_load_dwordx4 v0, s[8:11], s80 offen lds
  s_add_u32 m0, s22, 3072
  s_add_u32 s80, s21, 294912
  buffer_load_dwordx4 v0, s[8:11], s80 offen lds
  s_add_u32 m0, s22, 4096
  s_add_u32 s80, s21, 393216
  buffer_load_dwordx4 v0, s[8:11], s80 offen lds
  s_add_u32 m0, s22, 5120
  s_add_u32 s80, s21, 491520
  buffer_load_dwordx4 v0, s[8:11], s80 offen lds
  s_add_u32 m0, s22, 6144
  s_add_u32 s80, s21, 589824
  buffer_load_dwordx4 v0, s[8:11], s80 offen lds
  s_add_u32 m0, s22, 7168
  s_add_u32 s80, s21, 688128
  buffer_load_dwordx4 v0, s[8:11], s80 offen lds
  s_add_u32 m0, s22, 8192
  s_add_u32 s80, s21, 64
  buffer_load_dwordx4 v0, s[8:11], s80 offen lds
  s_add_u32 m0, s22, 9216
  s_add_u32 s80, s21, 98368
  buffer_load_dwordx4 v0, s[8:11], s80 offen lds
  s_add_u32 m0, s22, 10240
  s_add_u32 s80, s21, 196672
  buffer_load_dwordx4 v0, s[8:11], s80 offen lds
  s_add_u32 m0, s22, 11264
  s_add_u32 s80, s21, 294976
  buffer_load_dwordx4 v0, s[8:11], s80 offen lds
  s_add_u32 m0, s22, 12288
  s_add_u32 s80, s21, 393280
  buffer_load_dwordx4 v0, s[8:11], s80 offen lds
  s_add_u32 m0, s22, 13312
  s_add_u32 s80, s21, 491584
  buffer_load_dwordx4 v0, s[8:11], s80 offen lds
  s_add_u32 m0, s22, 14336
  s_add_u32 s80, s21, 589888
  buffer_load_dwordx4 v0, s[8:11], s80 offen lds
  s_add_u32 m0, s22, 15360
  s_add_u32 s80, s21, 688192
  buffer_load_dwordx4 v0, s[8:11], s80 offen lds
  ds_read_b64_tr_b16 a[0:1], v114 offset:0
  ds_read_b64_tr_b16 a[2:3], v114 offset:256
  ds_read_b64_tr_b16 a[4:5], v114 offset:1024
  ds_read_b64_tr_b16 a[6:7], v114 offset:1280
  ds_read_b64_tr_b16 a[8:9], v114 offset:2048
  ds_read_b64_tr_b16 a[10:11], v114 offset:2304
  s_waitcnt lgkmcnt(4)
  s_mov_b32 s28, s36
  s_mov_b32 s29, s37
  s_mov_b32 s30, 0x400000
  s_add_u32 m0, s32, 0
  s_mov_b32 s80, 2097152
  buffer_load_dwordx4 v100, s[28:31], s80 offen  lds
  ds_read_b64_tr_b16 a[12:13], v114 offset:3072
  ds_read_b64_tr_b16 a[14:15], v114 offset:3328
  s_waitcnt lgkmcnt(4)
  s_add_u32 m0, s32, 1024
  s_mov_b32 s80, 2228224
  buffer_load_dwordx4 v100, s[28:31], s80 offen  lds
  ds_read_b64_tr_b16 a[16:17], v114 offset:4096
  ds_read_b64_tr_b16 a[18:19], v114 offset:4352
  s_waitcnt lgkmcnt(4)
  s_add_u32 m0, s32, 2048
  s_mov_b32 s80, 2359296
  buffer_load_dwordx4 v100, s[28:31], s80 offen  lds
  ds_read_b64_tr_b16 a[20:21], v114 offset:5120
  ds_read_b64_tr_b16 a[22:23], v114 offset:5376
  s_waitcnt lgkmcnt(4)
  s_add_u32 m0, s32, 3072
  s_mov_b32 s80, 2490368
  buffer_load_dwordx4 v100, s[28:31], s80 offen  lds
  ds_read_b64_tr_b16 a[24:25], v114 offset:6144
  ds_read_b64_tr_b16 a[26:27], v114 offset:6400
  s_waitcnt lgkmcnt(4)
  s_add_u32 m0, s32, 4096
  s_mov_b32 s80, 2621440
  buffer_load_dwordx4 v100, s[28:31], s80 offen  lds
  ds_read_b64_tr_b16 a[28:29], v114 offset:7168
  ds_read_b64_tr_b16 a[30:31], v114 offset:7424
  s_waitcnt lgkmcnt(4)
  s_add_u32 m0, s32, 5120
  s_mov_b32 s80, 2752512
  buffer_load_dwordx4 v100, s[28:31], s80 offen  lds
  ds_read_b64_tr_b16 a[32:33], v114 offset:8192
  ds_read_b64_tr_b16 a[34:35], v114 offset:8448
  s_waitcnt lgkmcnt(4)
  s_add_u32 m0, s32, 6144
  s_mov_b32 s80, 2883584
  buffer_load_dwordx4 v100, s[28:31], s80 offen  lds
  ds_read_b64_tr_b16 a[36:37], v114 offset:9216
  ds_read_b64_tr_b16 a[38:39], v114 offset:9472
  s_waitcnt lgkmcnt(4)
  s_add_u32 m0, s32, 7168
  s_mov_b32 s80, 3014656
  buffer_load_dwordx4 v100, s[28:31], s80 offen  lds
  ds_read_b64_tr_b16 a[40:41], v114 offset:10240
  ds_read_b64_tr_b16 a[42:43], v114 offset:10496
  s_waitcnt lgkmcnt(4)
  s_add_u32 m0, s32, 8192
  s_mov_b32 s80, 3145728
  buffer_load_dwordx4 v100, s[28:31], s80 offen  lds
  ds_read_b64_tr_b16 a[44:45], v114 offset:11264
  ds_read_b64_tr_b16 a[46:47], v114 offset:11520
  s_waitcnt lgkmcnt(4)
  s_add_u32 m0, s32, 9216
  s_mov_b32 s80, 3276800
  buffer_load_dwordx4 v100, s[28:31], s80 offen  lds
  ds_read_b64_tr_b16 a[48:49], v114 offset:12288
  ds_read_b64_tr_b16 a[50:51], v114 offset:12544
  s_waitcnt lgkmcnt(4)
  s_add_u32 m0, s32, 10240
  s_mov_b32 s80, 3407872
  buffer_load_dwordx4 v100, s[28:31], s80 offen  lds
  ds_read_b64_tr_b16 a[52:53], v114 offset:13312
  ds_read_b64_tr_b16 a[54:55], v114 offset:13568
  s_waitcnt lgkmcnt(4)
  s_add_u32 m0, s32, 11264
  s_mov_b32 s80, 3538944
  buffer_load_dwordx4 v100, s[28:31], s80 offen  lds
  ds_read_b64_tr_b16 a[56:57], v114 offset:14336
  ds_read_b64_tr_b16 a[58:59], v114 offset:14592
  s_waitcnt lgkmcnt(4)
  s_add_u32 m0, s32, 12288
  s_mov_b32 s80, 3670016
  buffer_load_dwordx4 v100, s[28:31], s80 offen  lds
  ds_read_b64_tr_b16 a[60:61], v114 offset:15360
  ds_read_b64_tr_b16 a[62:63], v114 offset:15616
  s_waitcnt lgkmcnt(4)
  s_add_u32 m0, s32, 13312
  s_mov_b32 s80, 3801088
  buffer_load_dwordx4 v100, s[28:31], s80 offen  lds
  s_waitcnt lgkmcnt(0)
  s_add_u32 m0, s32, 14336
  s_mov_b32 s80, 3932160
  buffer_load_dwordx4 v100, s[28:31], s80 offen  lds
  s_add_u32 m0, s32, 15360
  s_mov_b32 s80, 4063232
  buffer_load_dwordx4 v100, s[28:31], s80 offen  lds
  s_lshl_b32 s22, s18, 14
  s_add_u32 s22, s22, 32768
  s_sub_u32 s22, s22, s32
  v_add_u32 v1, s22, v114
  v_lshrrev_b32 v2, 5, v112
  v_lshlrev_b32 v2, 4, v2
  s_lshl_b32 s21, s18, 8
  v_add_u32 v2, s21, v2
  s_waitcnt vmcnt(16)
  ds_read_b128 v[4:7], v2 offset:30720
  ds_read_b128 v[8:11], v2 offset:30752
  ds_read_b128 v[12:15], v2 offset:30784
  ds_read_b128 v[16:19], v2 offset:30816
  ds_read_b128 v[20:23], v2 offset:30848
  ds_read_b128 v[24:27], v2 offset:30880
  ds_read_b128 v[28:31], v2 offset:30912
  ds_read_b128 v[32:35], v2 offset:30944
  s_waitcnt lgkmcnt(0)
  ds_read_b64_tr_b16 v[36:37], v1 offset:0
  ds_read_b64_tr_b16 v[38:39], v1 offset:256
  ds_read_b64_tr_b16 v[40:41], v1 offset:1024
  ds_read_b64_tr_b16 v[42:43], v1 offset:1280
  ds_read_b64_tr_b16 v[44:45], v1 offset:2048
  ds_read_b64_tr_b16 v[46:47], v1 offset:2304
  ds_read_b64_tr_b16 v[48:49], v1 offset:3072
  ds_read_b64_tr_b16 v[50:51], v1 offset:3328
  ds_read_b64_tr_b16 v[52:53], v1 offset:4096
  ds_read_b64_tr_b16 v[54:55], v1 offset:4352
  ds_read_b64_tr_b16 v[56:57], v1 offset:5120
  ds_read_b64_tr_b16 v[58:59], v1 offset:5376
  ds_read_b64_tr_b16 v[60:61], v1 offset:6144
  ds_read_b64_tr_b16 v[62:63], v1 offset:6400
  ds_read_b64_tr_b16 v[64:65], v1 offset:7168
  ds_read_b64_tr_b16 v[66:67], v1 offset:7424
  s_waitcnt lgkmcnt(0)
  v_mfma_f32_32x32x16_bf16 v[68:83], v[4:7], v[36:39], 0
  v_mfma_f32_32x32x16_bf16 v[68:83], v[8:11], v[40:43], v[68:83]
  v_mfma_f32_32x32x16_bf16 v[68:83], v[12:15], v[44:47], v[68:83]
  v_mfma_f32_32x32x16_bf16 v[68:83], v[16:19], v[48:51], v[68:83]
  v_mfma_f32_32x32x16_bf16 v[68:83], v[20:23], v[52:55], v[68:83]
  v_mfma_f32_32x32x16_bf16 v[68:83], v[24:27], v[56:59], v[68:83]
  v_mfma_f32_32x32x16_bf16 v[68:83], v[28:31], v[60:63], v[68:83]
  v_mfma_f32_32x32x16_bf16 v[68:83], v[32:35], v[64:67], v[68:83]
  s_waitcnt lgkmcnt(0)
  ds_read_b64_tr_b16 v[36:37], v1 offset:8192
  ds_read_b64_tr_b16 v[38:39], v1 offset:8448
  ds_read_b64_tr_b16 v[40:41], v1 offset:9216
  ds_read_b64_tr_b16 v[42:43], v1 offset:9472
  ds_read_b64_tr_b16 v[44:45], v1 offset:10240
  ds_read_b64_tr_b16 v[46:47], v1 offset:10496
  ds_read_b64_tr_b16 v[48:49], v1 offset:11264
  ds_read_b64_tr_b16 v[50:51], v1 offset:11520
  ds_read_b64_tr_b16 v[52:53], v1 offset:12288
  ds_read_b64_tr_b16 v[54:55], v1 offset:12544
  ds_read_b64_tr_b16 v[56:57], v1 offset:13312
  ds_read_b64_tr_b16 v[58:59], v1 offset:13568
  ds_read_b64_tr_b16 v[60:61], v1 offset:14336
  ds_read_b64_tr_b16 v[62:63], v1 offset:14592
  ds_read_b64_tr_b16 v[64:65], v1 offset:15360
  ds_read_b64_tr_b16 v[66:67], v1 offset:15616
  s_waitcnt lgkmcnt(0)
  v_mfma_f32_32x32x16_bf16 v[84:99], v[4:7], v[36:39], 0
  v_mfma_f32_32x32x16_bf16 v[84:99], v[8:11], v[40:43], v[84:99]
  v_mfma_f32_32x32x16_bf16 v[84:99], v[12:15], v[44:47], v[84:99]
  v_mfma_f32_32x32x16_bf16 v[84:99], v[16:19], v[48:51], v[84:99]
  v_mfma_f32_32x32x16_bf16 v[84:99], v[20:23], v[52:55], v[84:99]
  v_mfma_f32_32x32x16_bf16 v[84:99], v[24:27], v[56:59], v[84:99]
  v_mfma_f32_32x32x16_bf16 v[84:99], v[28:31], v[60:63], v[84:99]
  v_mfma_f32_32x32x16_bf16 v[84:99], v[32:35], v[64:67], v[84:99]
  s_nop 15
  v_and_b32 v1, 31, v112
  v_lshlrev_b32 v1, 2, v1
  s_lshl_b32 s21, s18, 8
  v_add_u32 v2, s21, v1
  ds_write_b32 v2, v68 offset:31744
  ds_write_b32 v2, v84 offset:31872
  s_waitcnt lgkmcnt(0)
  s_barrier
  v_lshlrev_b32 v1, 3, v112
  v_and_b32 v1, 255, v1
  ds_read_b64 v[4:5], v1 offset:31744
  ds_read_b64 v[6:7], v1 offset:32000
  ds_read_b64 v[8:9], v1 offset:32256
  ds_read_b64 v[10:11], v1 offset:32512
  s_waitcnt lgkmcnt(0)
  v_add_f32 v4, v4, v6
  v_add_f32 v8, v8, v10
  v_add_f32 v4, v4, v8
  v_add_f32 v5, v5, v7
  v_add_f32 v9, v9, v11
  v_add_f32 v5, v5, v9
  v_cvt_pk_bf16_f32 v4, v4, v5
  v_lshlrev_b32 v1, 2, v112
  s_lshl_b32 s21, s19, 13
  s_mul_i32 s22, s17, 128
  s_add_u32 s21, s21, s22
  s_add_u32 s21, s21, 657408
  s_cmp_lg_u32 s18, 0
  s_cbranch_scc1 modskip_56
  s_mov_b64 exec, 0xffffffff
  buffer_store_dword v4, v1, s[4:7], s21 offen sc1
  s_mov_b64 exec, -1
modskip_56:
  s_barrier
  s_lshl_b32 s35, s19, 21
  s_add_u32 s35, s35, 54525952
  s_lshl_b32 s22, s17, 14
  s_add_u32 s73, s35, s22
  s_lshl_b32 s22, s17, 9
  s_add_u32 s72, s35, s22
  s_lshl_b32 s74, s19, 16
  s_add_u32 s74, s74, 71303168
  v_mov_b64 v[4:5], -1
  v_mov_b64 v[6:7], -1
  s_lshl_b32 s21, s18, 12
  s_add_u32 s21, s21, s73
  s_add_u32 s22, s21, 0
  buffer_store_dwordx4 v[4:7], v113, s[4:7], s22 offen offset:0 sc1
  buffer_store_dwordx4 v[4:7], v113, s[4:7], s22 offen offset:1024 sc1
  buffer_store_dwordx4 v[4:7], v113, s[4:7], s22 offen offset:2048 sc1
  buffer_store_dwordx4 v[4:7], v113, s[4:7], s22 offen offset:3072 sc1
  s_add_u32 s22, s21, 524288
  buffer_store_dwordx4 v[4:7], v113, s[4:7], s22 offen offset:0 sc1
  buffer_store_dwordx4 v[4:7], v113, s[4:7], s22 offen offset:1024 sc1
  buffer_store_dwordx4 v[4:7], v113, s[4:7], s22 offen offset:2048 sc1
  buffer_store_dwordx4 v[4:7], v113, s[4:7], s22 offen offset:3072 sc1
  v_add_u32 v107, v116, v116
  v_sub_u32 v107, v107, v113
  s_lshl_b32 s21, s17, 13
  s_add_u32 s21, s21, s35
  s_add_u32 s21, s21, 0x100000
  buffer_store_dwordx4 v[4:7], v107, s[4:7], s21 offen sc1
  buffer_store_dwordx4 v[4:7], v107, s[4:7], s21 offen offset:1024 sc1
  s_lshl_b32 s21, s17, 12
  s_add_u32 s21, s21, s35
  s_add_u32 s21, s21, 0x180000
  buffer_store_dwordx4 v[4:7], v116, s[4:7], s21 offen sc1
  s_add_u32 s22, s74, 32768
  buffer_store_dwordx4 v[4:7], v125, s[4:7], s74 offen sc1
  buffer_store_dwordx4 v[4:7], v125, s[4:7], s22 offen sc1
  s_waitcnt vmcnt(28)
  ds_read_b64_tr_b16 a[64:65], v114 offset:0
  ds_read_b64_tr_b16 a[66:67], v114 offset:256
  s_waitcnt vmcnt(27)
  ds_read_b64_tr_b16 a[68:69], v114 offset:1024
  ds_read_b64_tr_b16 a[70:71], v114 offset:1280
  s_waitcnt vmcnt(26)
  ds_read_b64_tr_b16 a[72:73], v114 offset:2048
  ds_read_b64_tr_b16 a[74:75], v114 offset:2304
  s_waitcnt lgkmcnt(4)
  s_mov_b32 s28, s38
  s_mov_b32 s29, s39
  s_mov_b32 s30, 0x400000
  s_add_u32 m0, s32, 0
  s_add_u32 s80, s68, 0
  buffer_load_dwordx4 v101, s[28:31], s80 offen  lds
  s_waitcnt vmcnt(26)
  ds_read_b64_tr_b16 a[76:77], v114 offset:3072
  ds_read_b64_tr_b16 a[78:79], v114 offset:3328
  s_waitcnt lgkmcnt(4)
  s_add_u32 m0, s32, 1024
  s_add_u32 s80, s68, 16384
  buffer_load_dwordx4 v101, s[28:31], s80 offen  lds
  s_waitcnt vmcnt(26)
  ds_read_b64_tr_b16 a[80:81], v114 offset:4096
  ds_read_b64_tr_b16 a[82:83], v114 offset:4352
  s_waitcnt lgkmcnt(4)
  s_add_u32 m0, s32, 2048
  s_add_u32 s80, s68, 32768
  buffer_load_dwordx4 v101, s[28:31], s80 offen  lds
  s_waitcnt vmcnt(26)
  ds_read_b64_tr_b16 a[84:85], v114 offset:5120
  ds_read_b64_tr_b16 a[86:87], v114 offset:5376
  s_waitcnt lgkmcnt(4)
  s_add_u32 m0, s32, 3072
  s_add_u32 s80, s68, 49152
  buffer_load_dwordx4 v101, s[28:31], s80 offen  lds
  s_waitcnt vmcnt(26)
  ds_read_b64_tr_b16 a[88:89], v114 offset:6144
  ds_read_b64_tr_b16 a[90:91], v114 offset:6400
  s_waitcnt lgkmcnt(4)
  s_add_u32 m0, s32, 4096
  s_add_u32 s80, s68, 65536
  buffer_load_dwordx4 v101, s[28:31], s80 offen  lds
  s_waitcnt vmcnt(26)
  ds_read_b64_tr_b16 a[92:93], v114 offset:7168
  ds_read_b64_tr_b16 a[94:95], v114 offset:7424
  s_waitcnt lgkmcnt(4)
  s_add_u32 m0, s32, 5120
  s_add_u32 s80, s68, 81920
  buffer_load_dwordx4 v101, s[28:31], s80 offen  lds
  s_waitcnt vmcnt(26)
  ds_read_b64_tr_b16 a[96:97], v114 offset:8192
  ds_read_b64_tr_b16 a[98:99], v114 offset:8448
  s_waitcnt lgkmcnt(4)
  s_add_u32 m0, s32, 6144
  s_add_u32 s80, s68, 98304
  buffer_load_dwordx4 v101, s[28:31], s80 offen  lds
  s_waitcnt vmcnt(26)
  ds_read_b64_tr_b16 a[100:101], v114 offset:9216
  ds_read_b64_tr_b16 a[102:103], v114 offset:9472
  s_waitcnt lgkmcnt(4)
  s_add_u32 m0, s32, 7168
  s_add_u32 s80, s68, 114688
  buffer_load_dwordx4 v101, s[28:31], s80 offen  lds
  s_waitcnt vmcnt(26)
  ds_read_b64_tr_b16 a[104:105], v114 offset:10240
  ds_read_b64_tr_b16 a[106:107], v114 offset:10496
  s_waitcnt lgkmcnt(4)
  s_add_u32 m0, s32, 8192
  s_add_u32 s80, s68, 131072
  buffer_load_dwordx4 v101, s[28:31], s80 offen  lds
  s_waitcnt vmcnt(26)
  ds_read_b64_tr_b16 a[108:109], v114 offset:11264
  ds_read_b64_tr_b16 a[110:111], v114 offset:11520
  s_waitcnt lgkmcnt(4)
  s_add_u32 m0, s32, 9216
  s_add_u32 s80, s68, 147456
  buffer_load_dwordx4 v101, s[28:31], s80 offen  lds
  s_waitcnt vmcnt(26)
  ds_read_b64_tr_b16 a[112:113], v114 offset:12288
  ds_read_b64_tr_b16 a[114:115], v114 offset:12544
  s_waitcnt lgkmcnt(4)
  s_add_u32 m0, s32, 10240
  s_add_u32 s80, s68, 163840
  buffer_load_dwordx4 v101, s[28:31], s80 offen  lds
  s_waitcnt vmcnt(26)
  ds_read_b64_tr_b16 a[116:117], v114 offset:13312
  ds_read_b64_tr_b16 a[118:119], v114 offset:13568
  s_waitcnt lgkmcnt(4)
  s_add_u32 m0, s32, 11264
  s_add_u32 s80, s68, 180224
  buffer_load_dwordx4 v101, s[28:31], s80 offen  lds
  s_waitcnt vmcnt(26)
  ds_read_b64_tr_b16 a[120:121], v114 offset:14336
  ds_read_b64_tr_b16 a[122:123], v114 offset:14592
  s_waitcnt lgkmcnt(4)
  s_add_u32 m0, s32, 12288
  s_add_u32 s80, s68, 196608
  buffer_load_dwordx4 v101, s[28:31], s80 offen  lds
  s_waitcnt vmcnt(26)
  ds_read_b64_tr_b16 a[124:125], v114 offset:15360
  ds_read_b64_tr_b16 a[126:127], v114 offset:15616
  s_waitcnt lgkmcnt(4)
  s_add_u32 m0, s32, 13312
  s_add_u32 s80, s68, 212992
  buffer_load_dwordx4 v101, s[28:31], s80 offen  lds
  s_waitcnt vmcnt(13)
  ds_read_b64_tr_b16 a[128:129], v115 offset:0
  ds_read_b64_tr_b16 a[130:131], v115 offset:512
  s_waitcnt lgkmcnt(4)
  s_add_u32 m0, s32, 14336
  s_add_u32 s80, s68, 229376
  buffer_load_dwordx4 v101, s[28:31], s80 offen  lds
  s_waitcnt vmcnt(13)
  ds_read_b64_tr_b16 a[132:133], v115 offset:1024
  ds_read_b64_tr_b16 a[134:135], v115 offset:1536
  s_waitcnt lgkmcnt(4)
  s_add_u32 m0, s32, 15360
  s_add_u32 s80, s68, 245760
  buffer_load_dwordx4 v101, s[28:31], s80 offen  lds
  s_waitcnt vmcnt(13)
  ds_read_b64_tr_b16 a[136:137], v115 offset:2048
  ds_read_b64_tr_b16 a[138:139], v115 offset:2560
  s_waitcnt lgkmcnt(4)
  s_add_u32 m0, s32, 0
  s_add_u32 s80, s68, 262144
  buffer_load_dwordx4 v101, s[28:31], s80 offen  lds
  s_waitcnt vmcnt(13)
  ds_read_b64_tr_b16 a[140:141], v115 offset:3072
  ds_read_b64_tr_b16 a[142:143], v115 offset:3584
  s_waitcnt lgkmcnt(4)
  s_add_u32 m0, s32, 1024
  s_add_u32 s80, s68, 278528
  buffer_load_dwordx4 v101, s[28:31], s80 offen  lds
  s_waitcnt vmcnt(13)
  ds_read_b64_tr_b16 a[144:145], v115 offset:4096
  ds_read_b64_tr_b16 a[146:147], v115 offset:4608
  s_waitcnt lgkmcnt(4)
  s_add_u32 m0, s32, 2048
  s_add_u32 s80, s68, 294912
  buffer_load_dwordx4 v101, s[28:31], s80 offen  lds
  s_waitcnt vmcnt(13)
  ds_read_b64_tr_b16 a[148:149], v115 offset:5120
  ds_read_b64_tr_b16 a[150:151], v115 offset:5632
  s_waitcnt lgkmcnt(4)
  s_add_u32 m0, s32, 3072
  s_add_u32 s80, s68, 311296
  buffer_load_dwordx4 v101, s[28:31], s80 offen  lds
  s_waitcnt vmcnt(13)
  ds_read_b64_tr_b16 a[152:153], v115 offset:6144
  ds_read_b64_tr_b16 a[154:155], v115 offset:6656
  s_waitcnt lgkmcnt(4)
  s_add_u32 m0, s32, 4096
  s_add_u32 s80, s68, 327680
  buffer_load_dwordx4 v101, s[28:31], s80 offen  lds
  s_waitcnt vmcnt(13)
  ds_read_b64_tr_b16 a[156:157], v115 offset:7168
  ds_read_b64_tr_b16 a[158:159], v115 offset:7680
  s_waitcnt lgkmcnt(4)
  s_add_u32 m0, s32, 5120
  s_add_u32 s80, s68, 344064
  buffer_load_dwordx4 v101, s[28:31], s80 offen  lds
  s_waitcnt vmcnt(13)
  ds_read_b64_tr_b16 a[160:161], v115 offset:8192
  ds_read_b64_tr_b16 a[162:163], v115 offset:8704
  s_waitcnt lgkmcnt(4)
  s_add_u32 m0, s32, 6144
  s_add_u32 s80, s68, 360448
  buffer_load_dwordx4 v101, s[28:31], s80 offen  lds
  s_waitcnt vmcnt(13)
  ds_read_b64_tr_b16 a[164:165], v115 offset:9216
  ds_read_b64_tr_b16 a[166:167], v115 offset:9728
  s_waitcnt lgkmcnt(4)
  s_add_u32 m0, s32, 7168
  s_add_u32 s80, s68, 376832
  buffer_load_dwordx4 v101, s[28:31], s80 offen  lds
  s_waitcnt vmcnt(13)
  ds_read_b64_tr_b16 a[168:169], v115 offset:10240
  ds_read_b64_tr_b16 a[170:171], v115 offset:10752
  s_waitcnt lgkmcnt(4)
  s_add_u32 m0, s32, 8192
  s_add_u32 s80, s68, 393216
  buffer_load_dwordx4 v101, s[28:31], s80 offen  lds
  s_waitcnt vmcnt(13)
  ds_read_b64_tr_b16 a[172:173], v115 offset:11264
  ds_read_b64_tr_b16 a[174:175], v115 offset:11776
  s_waitcnt lgkmcnt(4)
  s_add_u32 m0, s32, 9216
  s_add_u32 s80, s68, 409600
  buffer_load_dwordx4 v101, s[28:31], s80 offen  lds
  s_waitcnt vmcnt(13)
  ds_read_b64_tr_b16 a[176:177], v115 offset:12288
  ds_read_b64_tr_b16 a[178:179], v115 offset:12800
  s_waitcnt lgkmcnt(4)
  s_add_u32 m0, s32, 10240
  s_add_u32 s80, s68, 425984
  buffer_load_dwordx4 v101, s[28:31], s80 offen  lds
  s_waitcnt vmcnt(13)
  ds_read_b64_tr_b16 a[180:181], v115 offset:13312
  ds_read_b64_tr_b16 a[182:183], v115 offset:13824
  s_waitcnt lgkmcnt(4)
  s_add_u32 m0, s32, 11264
  s_add_u32 s80, s68, 442368
  buffer_load_dwordx4 v101, s[28:31], s80 offen  lds
  s_waitcnt vmcnt(13)
  ds_read_b64_tr_b16 a[184:185], v115 offset:14336
  ds_read_b64_tr_b16 a[186:187], v115 offset:14848
  s_waitcnt lgkmcnt(4)
  s_add_u32 m0, s32, 12288
  s_add_u32 s80, s68, 458752
  buffer_load_dwordx4 v101, s[28:31], s80 offen  lds
  s_waitcnt vmcnt(13)
  ds_read_b64_tr_b16 a[188:189], v115 offset:15360
  ds_read_b64_tr_b16 a[190:191], v115 offset:15872
  s_waitcnt lgkmcnt(4)
  s_add_u32 m0, s32, 13312
  s_add_u32 s80, s68, 475136
  buffer_load_dwordx4 v101, s[28:31], s80 offen  lds
  s_waitcnt vmcnt(13)
  ds_read_b64_tr_b16 a[192:193], v115 offset:0
  ds_read_b64_tr_b16 a[194:195], v115 offset:512
  s_waitcnt lgkmcnt(4)
  s_add_u32 m0, s32, 14336
  s_add_u32 s80, s68, 491520
  buffer_load_dwordx4 v101, s[28:31], s80 offen  lds
  s_waitcnt vmcnt(13)
  ds_read_b64_tr_b16 a[196:197], v115 offset:1024
  ds_read_b64_tr_b16 a[198:199], v115 offset:1536
  s_waitcnt lgkmcnt(4)
  s_add_u32 m0, s32, 15360
  s_add_u32 s80, s68, 507904
  buffer_load_dwordx4 v101, s[28:31], s80 offen  lds
  s_waitcnt vmcnt(13)
  ds_read_b64_tr_b16 a[200:201], v115 offset:2048
  ds_read_b64_tr_b16 a[202:203], v115 offset:2560
  s_waitcnt lgkmcnt(4)
  s_waitcnt vmcnt(12)
  ds_read_b64_tr_b16 a[204:205], v115 offset:3072
  ds_read_b64_tr_b16 a[206:207], v115 offset:3584
  s_waitcnt lgkmcnt(4)
  s_waitcnt vmcnt(11)
  ds_read_b64_tr_b16 a[208:209], v115 offset:4096
  ds_read_b64_tr_b16 a[210:211], v115 offset:4608
  s_waitcnt lgkmcnt(4)
  s_waitcnt vmcnt(10)
  ds_read_b64_tr_b16 a[212:213], v115 offset:5120
  ds_read_b64_tr_b16 a[214:215], v115 offset:5632
  s_waitcnt lgkmcnt(4)
  s_waitcnt vmcnt(9)
  ds_read_b64_tr_b16 a[216:217], v115 offset:6144
  ds_read_b64_tr_b16 a[218:219], v115 offset:6656
  s_waitcnt lgkmcnt(4)
  s_waitcnt vmcnt(8)
  ds_read_b64_tr_b16 a[220:221], v115 offset:7168
  ds_read_b64_tr_b16 a[222:223], v115 offset:7680
  s_waitcnt lgkmcnt(4)
  s_waitcnt vmcnt(7)
  ds_read_b64_tr_b16 a[224:225], v115 offset:8192
  ds_read_b64_tr_b16 a[226:227], v115 offset:8704
  s_waitcnt lgkmcnt(4)
  s_waitcnt vmcnt(6)
  ds_read_b64_tr_b16 a[228:229], v115 offset:9216
  ds_read_b64_tr_b16 a[230:231], v115 offset:9728
  s_waitcnt lgkmcnt(4)
  s_waitcnt vmcnt(5)
  ds_read_b64_tr_b16 a[232:233], v115 offset:10240
  ds_read_b64_tr_b16 a[234:235], v115 offset:10752
  s_waitcnt lgkmcnt(4)
  s_waitcnt vmcnt(4)
  ds_read_b64_tr_b16 a[236:237], v115 offset:11264
  ds_read_b64_tr_b16 a[238:239], v115 offset:11776
  s_waitcnt lgkmcnt(4)
  s_waitcnt vmcnt(3)
  ds_read_b64_tr_b16 a[240:241], v115 offset:12288
  ds_read_b64_tr_b16 a[242:243], v115 offset:12800
  s_waitcnt lgkmcnt(4)
  s_waitcnt vmcnt(2)
  ds_read_b64_tr_b16 a[244:245], v115 offset:13312
  ds_read_b64_tr_b16 a[246:247], v115 offset:13824
  s_waitcnt lgkmcnt(4)
  s_waitcnt vmcnt(1)
  ds_read_b64_tr_b16 a[248:249], v115 offset:14336
  ds_read_b64_tr_b16 a[250:251], v115 offset:14848
  s_waitcnt lgkmcnt(4)
  s_waitcnt vmcnt(0)
  ds_read_b64_tr_b16 a[252:253], v115 offset:15360
  ds_read_b64_tr_b16 a[254:255], v115 offset:15872
  s_waitcnt lgkmcnt(4)
  s_waitcnt lgkmcnt(0)
  s_lshl_b32 s21, s17, 2
  s_add_u32 s23, s77, s21
  s_waitcnt vmcnt(0)
  s_barrier
  s_cmp_lg_u32 s18, 0
  s_cbranch_scc1 flg_57
  v_mov_b32 v0, 1
  s_mov_b64 exec, 1
  buffer_store_dword v0, off, s[4:7], s23 sc1
  s_mov_b64 exec, -1
flg_57:
  v_lshrrev_b32 v0, 5, v112
  v_lshlrev_b32 v0, 11, v0
  v_and_b32 v1, 31, v112
  v_lshl_add_u32 v0, v1, 4, v0
  s_lshl_b32 s21, s18, 9
  v_add_u32 v114, s21, v0
  v_lshrrev_b32 v0, 4, v118
  v_lshlrev_b32 v0, 9, v0
  v_and_b32 v1, 15, v118
  v_add_u32 v0, v0, v1
  s_lshl_b32 s22, s17, 4
  v_add_u32 v127, s22, v0
  v_add_u32 v126, s32, v113
  v_and_b32 v0, 31, v112
  v_lshrrev_b32 v1, 5, v112
  v_lshlrev_b32 v1, 2, v1
  v_sub_u32 v0, v0, v1
  v_cmp_le_i32 s[36:37], 0, v0
  v_cmp_le_i32 s[38:39], 1, v0
  v_cmp_le_i32 s[40:41], 2, v0
  v_cmp_le_i32 s[42:43], 3, v0
  v_cmp_le_i32 s[44:45], 16, v0
  v_cmp_le_i32 s[46:47], 17, v0
  v_cmp_le_i32 s[48:49], 18, v0
  v_cmp_le_i32 s[50:51], 19, v0
  v_cmp_le_i32 s[52:53], 8, v0
  v_cmp_le_i32 s[54:55], 9, v0
  v_cmp_le_i32 s[56:57], 10, v0
  v_cmp_le_i32 s[58:59], 11, v0
  v_cmp_le_i32 s[60:61], 24, v0
  v_cmp_le_i32 s[62:63], 25, v0
  v_cmp_le_i32 s[64:65], 26, v0
  v_cmp_le_i32 s[66:67], 27, v0
  s_mov_b32 s68, 0x3db504f3
  s_mov_b32 s69, 0x3fb8aa3b
  s_mov_b32 s70, 0xbdd2d3e8
  s_mov_b32 s71, 0xc0135761
  s_load_dwordx2 s[8:9], s[0:1], 88
  s_mov_b32 s10, 0x400
  s_mov_b32 s11, 0x00020000
  s_waitcnt lgkmcnt(0)
  buffer_load_dword v12, v118, s[8:11], 0 offen
  s_load_dwordx2 s[8:9], s[0:1], 72
  s_mov_b32 s10, 0xe00
  s_mov_b32 s11, 0x00020000
  s_waitcnt lgkmcnt(0)
  v_lshrrev_b32 v0, 4, v112
  v_lshlrev_b32 v0, 3, v0
  s_lshl_b32 s21, s17, 7
  s_lshl_b32 s22, s18, 5
  s_add_u32 s21, s21, s22
  buffer_load_dwordx2 v[14:15], v0, s[8:11], s21 offen
  s_mov_b32 s33, 0
  v_lshlrev_b32 v1, 2, v112
  v_and_b32 v1, 127, v1
wk_pr_58:
  buffer_load_dword v0, v1, s[4:7], s77 offen sc1
  s_add_u32 s33, s33, 1
  s_cmp_gt_u32 s33, 4000000
  s_cbranch_scc1 wk_bail
  s_waitcnt vmcnt(0)
  v_cmp_eq_u32 vcc, 0, v0
  s_cbranch_vccnz wk_pr_58
  buffer_load_dword v8, v118, s[4:7], s34 offen offset:2048 sc1
  buffer_load_dword v9, v118, s[4:7], s34 offen offset:3072 sc1

  s_add_u32 s21, s34, 4096
  buffer_load_dword v10, v118, s[4:7], s21 offen offset:0 sc1
  buffer_load_dword v11, v118, s[4:7], s21 offen offset:1024 sc1
  s_waitcnt vmcnt(0)
  v_lshlrev_b32 v16, 16, v10
  v_and_b32 v17, 0xffff0000, v10
  v_add_f32 v16, 1.0, v16
  v_add_f32 v17, 1.0, v17
  v_cvt_pk_bf16_f32 v10, v16, v17
  v_mov_b32 v13, 0
  ds_write_b128 v126, v[8:11] offset:1024
  ds_write_b128 v126, v[12:15] offset:2048
  s_sub_u32 s20, s19, 1
  s_lshl_b32 s23, s20, 15
  s_add_u32 s23, s23, 1048576
  s_lshl_b32 s21, s18, 13
  s_add_u32 s22, s21, s23
  s_add_u32 m0, s21, 32768
  s_nop 0
  buffer_load_dwordx4 v113, s[4:7], s22 offen offset:0 sc1 lds
  buffer_load_dwordx4 v113, s[4:7], s22 offen offset:1024 sc1 lds
  buffer_load_dwordx4 v113, s[4:7], s22 offen offset:2048 sc1 lds
  buffer_load_dwordx4 v113, s[4:7], s22 offen offset:3072 sc1 lds
  s_add_u32 m0, s21, 36864
  s_add_u32 s22, s22, 4096
  buffer_load_dwordx4 v113, s[4:7], s22 offen offset:0 sc1 lds
  buffer_load_dwordx4 v113, s[4:7], s22 offen offset:1024 sc1 lds
  buffer_load_dwordx4 v113, s[4:7], s22 offen offset:2048 sc1 lds
  buffer_load_dwordx4 v113, s[4:7], s22 offen offset:3072 sc1 lds
  s_load_dwordx2 s[8:9], s[0:1], 0
  s_mov_b32 s10, 0x200000
  s_mov_b32 s11, 0x00020000
  s_waitcnt lgkmcnt(0)
  s_load_dwordx2 s[28:29], s[0:1], 112
  s_mov_b32 s30, 0x200000
  s_mov_b32 s31, 0x00020000
  s_waitcnt lgkmcnt(0)
w3_loop_s:
  s_lshl_b32 s21, s20, 5
  s_add_u32 s21, s21, s17
  s_lshl_b32 s76, s21, 10
  s_lshl_b32 s75, s21, 13
  s_waitcnt vmcnt(0)
  s_barrier
  s_lshl_b32 s21, s17, 12
  s_add_u32 s21, s21, s35
  s_add_u32 s21, s21, 0x180000
  v_mov_b64 v[88:89], -1
  v_mov_b64 v[90:91], -1
  buffer_store_dwordx4 v[88:91], v116, s[4:7], s21 offen sc1
  s_add_u32 s21, s75, 4194304
  s_add_u32 s22, s75, 20971520
  buffer_load_dwordx4 v[48:51], v119, s[4:7], s21 offen offset:0 sc1
  buffer_load_dwordx4 v[52:55], v119, s[4:7], s21 offen offset:512 sc1
  buffer_load_dwordx4 v[56:59], v119, s[4:7], s21 offen offset:1024 sc1
  buffer_load_dwordx4 v[60:63], v119, s[4:7], s21 offen offset:1536 sc1
  buffer_load_dwordx4 v[64:67], v119, s[4:7], s21 offen offset:2048 sc1
  buffer_load_dwordx4 v[68:71], v119, s[4:7], s21 offen offset:2560 sc1
  buffer_load_dwordx4 v[72:75], v119, s[4:7], s21 offen offset:3072 sc1
  buffer_load_dwordx4 v[76:79], v119, s[4:7], s21 offen offset:3584 sc1
  buffer_load_dwordx4 v[80:83], v120, s[4:7], s22 offen offset:0 sc1
  buffer_load_dwordx4 v[84:87], v120, s[4:7], s22 offen offset:512 sc1
  buffer_load_dword v104, v118, s[8:11], s76 offen
  ds_read_b128 v[16:19], v113 offset:32768
  ds_read_b128 v[20:23], v113 offset:33792
  ds_read_b128 v[24:27], v113 offset:34816
  ds_read_b128 v[28:31], v113 offset:35840
  ds_read_b128 v[32:35], v113 offset:36864
  ds_read_b128 v[36:39], v113 offset:37888
  ds_read_b128 v[40:43], v113 offset:38912
  ds_read_b128 v[44:47], v113 offset:39936
  s_waitcnt lgkmcnt(7)
  v_mfma_f32_32x32x16_bf16 v[0:15], a[0:3], v[16:19], 0
  ds_read_b128 v[16:19], v113 offset:40960
  s_waitcnt lgkmcnt(7)
  v_mfma_f32_32x32x16_bf16 v[0:15], a[4:7], v[20:23], v[0:15]
  ds_read_b128 v[20:23], v113 offset:41984
  s_waitcnt lgkmcnt(7)
  v_mfma_f32_32x32x16_bf16 v[0:15], a[8:11], v[24:27], v[0:15]
  ds_read_b128 v[24:27], v113 offset:43008
  s_waitcnt lgkmcnt(7)
  v_mfma_f32_32x32x16_bf16 v[0:15], a[12:15], v[28:31], v[0:15]
  ds_read_b128 v[28:31], v113 offset:44032
  s_waitcnt lgkmcnt(7)
  v_mfma_f32_32x32x16_bf16 v[0:15], a[16:19], v[32:35], v[0:15]
  ds_read_b128 v[32:35], v113 offset:45056
  s_waitcnt lgkmcnt(7)
  v_mfma_f32_32x32x16_bf16 v[0:15], a[20:23], v[36:39], v[0:15]
  ds_read_b128 v[36:39], v113 offset:46080
  s_waitcnt lgkmcnt(7)
  v_mfma_f32_32x32x16_bf16 v[0:15], a[24:27], v[40:43], v[0:15]
  ds_read_b128 v[40:43], v113 offset:47104
  s_waitcnt lgkmcnt(7)
  v_mfma_f32_32x32x16_bf16 v[0:15], a[28:31], v[44:47], v[0:15]
  ds_read_b128 v[44:47], v113 offset:48128
  s_waitcnt lgkmcnt(7)
  v_mfma_f32_32x32x16_bf16 v[0:15], a[32:35], v[16:19], v[0:15]
  ds_read_b128 v[16:19], v113 offset:49152
  s_waitcnt lgkmcnt(7)
  v_mfma_f32_32x32x16_bf16 v[0:15], a[36:39], v[20:23], v[0:15]
  ds_read_b128 v[20:23], v113 offset:50176
  s_waitcnt lgkmcnt(7)
  v_mfma_f32_32x32x16_bf16 v[0:15], a[40:43], v[24:27], v[0:15]
  ds_read_b128 v[24:27], v113 offset:51200
  s_waitcnt lgkmcnt(7)
  v_mfma_f32_32x32x16_bf16 v[0:15], a[44:47], v[28:31], v[0:15]
  ds_read_b128 v[28:31], v113 offset:52224
  s_waitcnt lgkmcnt(7)
  v_mfma_f32_32x32x16_bf16 v[0:15], a[48:51], v[32:35], v[0:15]
  ds_read_b128 v[32:35], v113 offset:53248
  s_waitcnt lgkmcnt(7)
  v_mfma_f32_32x32x16_bf16 v[0:15], a[52:55], v[36:39], v[0:15]
  ds_read_b128 v[36:39], v113 offset:54272
  s_waitcnt lgkmcnt(7)
  v_mfma_f32_32x32x16_bf16 v[0:15], a[56:59], v[40:43], v[0:15]
  ds_read_b128 v[40:43], v113 offset:55296
  s_waitcnt lgkmcnt(7)
  v_mfma_f32_32x32x16_bf16 v[0:15], a[60:63], v[44:47], v[0:15]
  ds_read_b128 v[44:47], v113 offset:56320
  s_waitcnt lgkmcnt(7)
  v_mfma_f32_32x32x16_bf16 v[0:15], a[64:67], v[16:19], v[0:15]
  ds_read_b128 v[16:19], v113 offset:57344
  s_waitcnt lgkmcnt(7)
  v_mfma_f32_32x32x16_bf16 v[0:15], a[68:71], v[20:23], v[0:15]
  ds_read_b128 v[20:23], v113 offset:58368
  s_waitcnt lgkmcnt(7)
  v_mfma_f32_32x32x16_bf16 v[0:15], a[72:75], v[24:27], v[0:15]
  ds_read_b128 v[24:27], v113 offset:59392
  s_waitcnt lgkmcnt(7)
  v_mfma_f32_32x32x16_bf16 v[0:15], a[76:79], v[28:31], v[0:15]
  ds_read_b128 v[28:31], v113 offset:60416
  s_waitcnt lgkmcnt(7)
  v_mfma_f32_32x32x16_bf16 v[0:15], a[80:83], v[32:35], v[0:15]
  ds_read_b128 v[32:35], v113 offset:61440
  s_waitcnt lgkmcnt(7)
  v_mfma_f32_32x32x16_bf16 v[0:15], a[84:87], v[36:39], v[0:15]
  ds_read_b128 v[36:39], v113 offset:62464
  s_waitcnt lgkmcnt(7)
  v_mfma_f32_32x32x16_bf16 v[0:15], a[88:91], v[40:43], v[0:15]
  ds_read_b128 v[40:43], v113 offset:63488
  s_waitcnt lgkmcnt(7)
  v_mfma_f32_32x32x16_bf16 v[0:15], a[92:95], v[44:47], v[0:15]
  ds_read_b128 v[44:47], v113 offset:64512
  s_waitcnt lgkmcnt(7)
  v_mfma_f32_32x32x16_bf16 v[0:15], a[96:99], v[16:19], v[0:15]
  s_waitcnt lgkmcnt(6)
  v_mfma_f32_32x32x16_bf16 v[0:15], a[100:103], v[20:23], v[0:15]
  s_waitcnt lgkmcnt(5)
  v_mfma_f32_32x32x16_bf16 v[0:15], a[104:107], v[24:27], v[0:15]
  s_waitcnt lgkmcnt(4)
  v_mfma_f32_32x32x16_bf16 v[0:15], a[108:111], v[28:31], v[0:15]
  s_waitcnt lgkmcnt(3)
  v_mfma_f32_32x32x16_bf16 v[0:15], a[112:115], v[32:35], v[0:15]
  s_waitcnt lgkmcnt(2)
  v_mfma_f32_32x32x16_bf16 v[0:15], a[116:119], v[36:39], v[0:15]
  s_waitcnt lgkmcnt(1)
  v_mfma_f32_32x32x16_bf16 v[0:15], a[120:123], v[40:43], v[0:15]
  s_waitcnt lgkmcnt(0)
  v_mfma_f32_32x32x16_bf16 v[0:15], a[124:127], v[44:47], v[0:15]
  s_nop 11
  v_cvt_pk_bf16_f32 v88, v0, v1
  v_cvt_pk_bf16_f32 v89, v2, v3
  v_cvt_pk_bf16_f32 v90, v4, v5
  v_cvt_pk_bf16_f32 v91, v6, v7
  v_cvt_pk_bf16_f32 v92, v8, v9
  v_cvt_pk_bf16_f32 v93, v10, v11
  v_cvt_pk_bf16_f32 v94, v12, v13
  v_cvt_pk_bf16_f32 v95, v14, v15
  ds_write_b128 v107, v[88:91] offset:0
  ds_write_b128 v107, v[92:95] offset:1024
  s_waitcnt lgkmcnt(0)
  s_barrier
  ds_read_b128 v[16:19], v113 offset:0
  ds_read_b128 v[20:23], v113 offset:1024
  ds_read_b128 v[24:27], v113 offset:2048
  ds_read_b128 v[28:31], v113 offset:3072
  ds_read_b128 v[32:35], v113 offset:4096
  ds_read_b128 v[36:39], v113 offset:5120
  ds_read_b128 v[40:43], v113 offset:6144
  ds_read_b128 v[44:47], v113 offset:7168
  s_waitcnt vmcnt(0)
  s_add_u32 s24, s20, 7
  s_cmp_ge_u32 s24, 64
  s_cbranch_scc1 w3nopf_59
  s_lshl_b32 s23, s24, 15
  s_add_u32 s23, s23, 1048576
  s_lshl_b32 s21, s18, 13
  s_add_u32 s22, s21, s23
  s_add_u32 m0, s21, 32768
  s_nop 0
  buffer_load_dwordx4 v113, s[4:7], s22 offen offset:0 sc1 lds
  buffer_load_dwordx4 v113, s[4:7], s22 offen offset:1024 sc1 lds
  buffer_load_dwordx4 v113, s[4:7], s22 offen offset:2048 sc1 lds
  buffer_load_dwordx4 v113, s[4:7], s22 offen offset:3072 sc1 lds
  s_add_u32 m0, s21, 36864
  s_add_u32 s22, s22, 4096
  buffer_load_dwordx4 v113, s[4:7], s22 offen offset:0 sc1 lds
  buffer_load_dwordx4 v113, s[4:7], s22 offen offset:1024 sc1 lds
  buffer_load_dwordx4 v113, s[4:7], s22 offen offset:2048 sc1 lds
  buffer_load_dwordx4 v113, s[4:7], s22 offen offset:3072 sc1 lds
w3nopf_59:
  s_waitcnt lgkmcnt(7)
  v_mfma_f32_32x32x16_bf16 v[0:15], v[48:51], v[16:19], 0
  s_waitcnt lgkmcnt(6)
  v_mfma_f32_32x32x16_bf16 v[0:15], v[52:55], v[20:23], v[0:15]
  s_waitcnt lgkmcnt(5)
  v_mfma_f32_32x32x16_bf16 v[0:15], v[56:59], v[24:27], v[0:15]
  s_waitcnt lgkmcnt(4)
  v_mfma_f32_32x32x16_bf16 v[0:15], v[60:63], v[28:31], v[0:15]
  s_waitcnt lgkmcnt(3)
  v_mfma_f32_32x32x16_bf16 v[0:15], v[64:67], v[32:35], v[0:15]
  s_waitcnt lgkmcnt(2)
  v_mfma_f32_32x32x16_bf16 v[0:15], v[68:71], v[36:39], v[0:15]
  s_waitcnt lgkmcnt(1)
  v_mfma_f32_32x32x16_bf16 v[0:15], v[72:75], v[40:43], v[0:15]
  s_waitcnt lgkmcnt(0)
  v_mfma_f32_32x32x16_bf16 v[0:15], v[76:79], v[44:47], v[0:15]
  v_mov_b32 v108, 0xce6e6b28
  s_lshl_b32 s21, s17, 11
  s_lshl_b32 s22, s20, 4
  s_add_u32 s21, s21, s22
  s_add_u32 s23, s21, 720912
  s_sub_u32 s22, s23, s22
  s_sub_u32 s22, s22, 16
  s_lshl_b32 s21, s18, 11
  s_add_u32 s24, s21, s75
  s_add_u32 s24, s24, 37748736
  s_nop 5
  v_cvt_pk_bf16_f32 v109, v0, v1
  v_lshlrev_b32 v0, 16, v109
  v_and_b32 v1, 0xffff0000, v109
  v_cvt_pk_bf16_f32 v109, v2, v3
  v_lshlrev_b32 v2, 16, v109
  v_and_b32 v3, 0xffff0000, v109
  v_cvt_pk_bf16_f32 v109, v4, v5
  v_lshlrev_b32 v4, 16, v109
  v_and_b32 v5, 0xffff0000, v109
  v_cvt_pk_bf16_f32 v109, v6, v7
  v_lshlrev_b32 v6, 16, v109
  v_and_b32 v7, 0xffff0000, v109
  v_cvt_pk_bf16_f32 v109, v8, v9
  v_lshlrev_b32 v8, 16, v109
  v_and_b32 v9, 0xffff0000, v109
  v_cvt_pk_bf16_f32 v109, v10, v11
  v_lshlrev_b32 v10, 16, v109
  v_and_b32 v11, 0xffff0000, v109
  v_cvt_pk_bf16_f32 v109, v12, v13
  v_lshlrev_b32 v12, 16, v109
  v_and_b32 v13, 0xffff0000, v109
  v_cvt_pk_bf16_f32 v109, v14, v15
  v_lshlrev_b32 v14, 16, v109
  v_and_b32 v15, 0xffff0000, v109
  v_mul_f32 v0, s68, v0
  v_mul_f32 v1, s68, v1
  v_mul_f32 v2, s68, v2
  v_mul_f32 v3, s68, v3
  v_mul_f32 v4, s68, v4
  v_mul_f32 v5, s68, v5
  v_mul_f32 v6, s68, v6
  v_mul_f32 v7, s68, v7
  v_mul_f32 v8, s68, v8
  v_mul_f32 v9, s68, v9
  v_mul_f32 v10, s68, v10
  v_mul_f32 v11, s68, v11
  v_mul_f32 v12, s68, v12
  v_mul_f32 v13, s68, v13
  v_mul_f32 v14, s68, v14
  v_mul_f32 v15, s68, v15
  v_cvt_pk_bf16_f32 v109, v0, v1
  v_lshlrev_b32 v0, 16, v109
  v_and_b32 v1, 0xffff0000, v109
  v_cvt_pk_bf16_f32 v109, v2, v3
  v_lshlrev_b32 v2, 16, v109
  v_and_b32 v3, 0xffff0000, v109
  v_cvt_pk_bf16_f32 v109, v4, v5
  v_lshlrev_b32 v4, 16, v109
  v_and_b32 v5, 0xffff0000, v109
  v_cvt_pk_bf16_f32 v109, v6, v7
  v_lshlrev_b32 v6, 16, v109
  v_and_b32 v7, 0xffff0000, v109
  v_cvt_pk_bf16_f32 v109, v8, v9
  v_lshlrev_b32 v8, 16, v109
  v_and_b32 v9, 0xffff0000, v109
  v_cvt_pk_bf16_f32 v109, v10, v11
  v_lshlrev_b32 v10, 16, v109
  v_and_b32 v11, 0xffff0000, v109
  v_cvt_pk_bf16_f32 v109, v12, v13
  v_lshlrev_b32 v12, 16, v109
  v_and_b32 v13, 0xffff0000, v109
  v_cvt_pk_bf16_f32 v109, v14, v15
  v_lshlrev_b32 v14, 16, v109
  v_and_b32 v15, 0xffff0000, v109
  v_cndmask_b32 v0, v108, v0, s[36:37]
  v_cndmask_b32 v1, v108, v1, s[38:39]
  v_cndmask_b32 v2, v108, v2, s[40:41]
  v_cndmask_b32 v3, v108, v3, s[42:43]
  v_cndmask_b32 v4, v108, v4, s[44:45]
  v_cndmask_b32 v5, v108, v5, s[46:47]
  v_cndmask_b32 v6, v108, v6, s[48:49]
  v_cndmask_b32 v7, v108, v7, s[50:51]
  v_cndmask_b32 v8, v108, v8, s[52:53]
  v_cndmask_b32 v9, v108, v9, s[54:55]
  v_cndmask_b32 v10, v108, v10, s[56:57]
  v_cndmask_b32 v11, v108, v11, s[58:59]
  v_cndmask_b32 v12, v108, v12, s[60:61]
  v_cndmask_b32 v13, v108, v13, s[62:63]
  v_cndmask_b32 v14, v108, v14, s[64:65]
  v_cndmask_b32 v15, v108, v15, s[66:67]
  v_max_f32 v105, v0, v1
  v_max3_f32 v105, v105, v2, v3
  v_max3_f32 v105, v105, v4, v5
  v_max3_f32 v105, v105, v6, v7
  v_max3_f32 v105, v105, v8, v9
  v_max3_f32 v105, v105, v10, v11
  v_max3_f32 v105, v105, v12, v13
  v_max3_f32 v105, v105, v14, v15
  v_mov_b32 v109, v105
  s_nop 1
  v_permlane32_swap_b32 v105, v109
  v_max_f32 v105, v105, v109
  v_sub_f32 v0, v0, v105
  v_sub_f32 v1, v1, v105
  v_sub_f32 v2, v2, v105
  v_sub_f32 v3, v3, v105
  v_sub_f32 v4, v4, v105
  v_sub_f32 v5, v5, v105
  v_sub_f32 v6, v6, v105
  v_sub_f32 v7, v7, v105
  v_sub_f32 v8, v8, v105
  v_sub_f32 v9, v9, v105
  v_sub_f32 v10, v10, v105
  v_sub_f32 v11, v11, v105
  v_sub_f32 v12, v12, v105
  v_sub_f32 v13, v13, v105
  v_sub_f32 v14, v14, v105
  v_sub_f32 v15, v15, v105
  v_mul_f32 v0, s69, v0
  v_mul_f32 v1, s69, v1
  v_mul_f32 v2, s69, v2
  v_mul_f32 v3, s69, v3
  v_mul_f32 v4, s69, v4
  v_mul_f32 v5, s69, v5
  v_mul_f32 v6, s69, v6
  v_mul_f32 v7, s69, v7
  v_mul_f32 v8, s69, v8
  v_mul_f32 v9, s69, v9
  v_mul_f32 v10, s69, v10
  v_mul_f32 v11, s69, v11
  v_mul_f32 v12, s69, v12
  v_mul_f32 v13, s69, v13
  v_mul_f32 v14, s69, v14
  v_mul_f32 v15, s69, v15
  v_exp_f32 v0, v0
  v_exp_f32 v1, v1
  v_exp_f32 v2, v2
  v_exp_f32 v3, v3
  v_exp_f32 v4, v4
  v_exp_f32 v5, v5
  v_exp_f32 v6, v6
  v_exp_f32 v7, v7
  v_exp_f32 v8, v8
  v_exp_f32 v9, v9
  v_exp_f32 v10, v10
  v_exp_f32 v11, v11
  v_exp_f32 v12, v12
  v_exp_f32 v13, v13
  v_exp_f32 v14, v14
  v_exp_f32 v15, v15
  v_add_f32 v106, v0, v1
  v_add_f32 v106, v106, v2
  v_add_f32 v106, v106, v3
  v_add_f32 v106, v106, v4
  v_add_f32 v106, v106, v5
  v_add_f32 v106, v106, v6
  v_add_f32 v106, v106, v7
  v_add_f32 v106, v106, v8
  v_add_f32 v106, v106, v9
  v_add_f32 v106, v106, v10
  v_add_f32 v106, v106, v11
  v_add_f32 v106, v106, v12
  v_add_f32 v106, v106, v13
  v_add_f32 v106, v106, v14
  v_add_f32 v106, v106, v15
  s_lshl_b32 s80, s18, 10
  s_add_u32 m0, s80, 16384
  v_lshlrev_b32 v110, 2, v112
  v_and_b32 v110, 15, v110
  s_mov_b32 s33, 0
wk_pg_60:
  s_sub_u32 s21, s23, 16
  s_max_u32 s21, s21, s22
  buffer_load_dword v109, off, s[4:7], s21 sc1
  s_add_u32 s33, s33, 1
  s_cmp_gt_u32 s33, 4000000
  s_cbranch_scc1 wk_bail
  s_waitcnt vmcnt(0)
  v_cmp_ne_u32 vcc, 0, v109
  s_cbranch_vccnz wk_pg_60_x
  s_sleep 16
  s_branch wk_pg_60
wk_pg_60_x:
  s_cmp_lt_u32 s20, 63
  s_cbranch_scc1 wk_pk_61
  s_mov_b32 s33, 0
wk_pl_62:
  buffer_load_dwordx4 v[48:51], v113, s[4:7], s24 offen sc1
  s_add_u32 s33, s33, 1
  s_cmp_gt_u32 s33, 4000000
  s_cbranch_scc1 wk_bail
  s_waitcnt vmcnt(0)
  v_max_u32 v109, v48, v49
  v_max3_u32 v109, v109, v50, v51
  v_cmp_eq_u32 vcc, -1, v109
  s_cbranch_vccnz wk_pl_62
  ds_write_b128 v116, v[48:51] offset:16384
  s_waitcnt lgkmcnt(0)
  s_branch wk_pk_61_x
wk_pk_61:
  buffer_load_dword v109, v110, s[4:7], s23 offen sc1
  buffer_load_dwordx4 v113, s[4:7], s24 offen sc1 lds
  s_add_u32 s33, s33, 1
  s_cmp_gt_u32 s33, 4000000
  s_cbranch_scc1 wk_bail
  s_waitcnt vmcnt(0)
  v_cmp_ne_u32 vcc, 0, v109
  s_cmp_eq_u64 vcc, exec
  s_cbranch_scc1 wk_pk_61_x
  s_branch wk_pk_61
wk_pk_61_x:
  s_barrier
  ds_read_b64_tr_b16 v[48:49], v121 offset:16384
  ds_read_b64_tr_b16 v[50:51], v121 offset:16512
  ds_read_b64_tr_b16 v[52:53], v121 offset:16896
  ds_read_b64_tr_b16 v[54:55], v121 offset:17024
  ds_read_b64_tr_b16 v[56:57], v121 offset:17408
  ds_read_b64_tr_b16 v[58:59], v121 offset:17536
  ds_read_b64_tr_b16 v[60:61], v121 offset:17920
  ds_read_b64_tr_b16 v[62:63], v121 offset:18048
  ds_read_b64_tr_b16 v[64:65], v121 offset:18432
  ds_read_b64_tr_b16 v[66:67], v121 offset:18560
  ds_read_b64_tr_b16 v[68:69], v121 offset:18944
  ds_read_b64_tr_b16 v[70:71], v121 offset:19072
  ds_read_b64_tr_b16 v[72:73], v121 offset:19456
  ds_read_b64_tr_b16 v[74:75], v121 offset:19584
  ds_read_b64_tr_b16 v[76:77], v121 offset:19968
  ds_read_b64_tr_b16 v[78:79], v121 offset:20096
  s_waitcnt lgkmcnt(14)
  v_mfma_f32_32x32x16_bf16 v[88:103], v[48:51], v[16:19], 0
  s_waitcnt lgkmcnt(12)
  v_mfma_f32_32x32x16_bf16 v[88:103], v[52:55], v[20:23], v[88:103]
  s_waitcnt lgkmcnt(10)
  v_mfma_f32_32x32x16_bf16 v[88:103], v[56:59], v[24:27], v[88:103]
  s_waitcnt lgkmcnt(8)
  v_mfma_f32_32x32x16_bf16 v[88:103], v[60:63], v[28:31], v[88:103]
  s_waitcnt lgkmcnt(6)
  v_mfma_f32_32x32x16_bf16 v[88:103], v[64:67], v[32:35], v[88:103]
  s_waitcnt lgkmcnt(4)
  v_mfma_f32_32x32x16_bf16 v[88:103], v[68:71], v[36:39], v[88:103]
  s_waitcnt lgkmcnt(2)
  v_mfma_f32_32x32x16_bf16 v[88:103], v[72:75], v[40:43], v[88:103]
  s_waitcnt lgkmcnt(0)
  v_mfma_f32_32x32x16_bf16 v[88:103], v[76:79], v[44:47], v[88:103]
  ds_read_b64 v[48:49], v122 offset:16384
  v_mov_b64 v[50:51], 0
  v_mov_b64 v[66:67], 0
  s_nop 8
  v_cvt_pk_bf16_f32 v109, v88, v89
  v_lshlrev_b32 v88, 16, v109
  v_and_b32 v89, 0xffff0000, v109
  v_cvt_pk_bf16_f32 v109, v90, v91
  v_lshlrev_b32 v90, 16, v109
  v_and_b32 v91, 0xffff0000, v109
  v_mul_f32 v88, s68, v88
  v_mul_f32 v89, s68, v89
  v_mul_f32 v90, s68, v90
  v_mul_f32 v91, s68, v91
  v_cvt_pk_bf16_f32 v109, v88, v89
  v_lshlrev_b32 v88, 16, v109
  v_and_b32 v89, 0xffff0000, v109
  v_cvt_pk_bf16_f32 v109, v90, v91
  v_lshlrev_b32 v90, 16, v109
  v_and_b32 v91, 0xffff0000, v109
  v_max3_f32 v52, v88, v89, v90
  v_max3_f32 v52, v52, v91, v105
  v_mov_b32 v109, v52
  s_nop 1
  v_permlane32_swap_b32 v52, v109
  v_max_f32 v52, v52, v109
  v_sub_f32 v54, v105, v52
  v_sub_f32 v88, v88, v52
  v_sub_f32 v89, v89, v52
  v_sub_f32 v90, v90, v52
  v_sub_f32 v91, v91, v52
  v_mul_f32 v54, s69, v54
  v_mul_f32 v88, s69, v88
  v_mul_f32 v89, s69, v89
  v_mul_f32 v90, s69, v90
  v_mul_f32 v91, s69, v91
  v_exp_f32 v54, v54
  v_exp_f32 v88, v88
  v_exp_f32 v89, v89
  v_exp_f32 v90, v90
  v_exp_f32 v91, v91
  v_mul_f32 v52, v54, v106
  v_add_f32 v110, v88, v89
  v_add_f32 v52, v52, v90
  v_add_f32 v110, v110, v91
  v_add_f32 v52, v52, v110
  v_mov_b32 v109, v52
  s_nop 1
  v_permlane32_swap_b32 v52, v109
  v_add_f32 v52, v52, v109
  v_rcp_f32 v52, v52
  s_nop 0
  v_mul_f32 v54, v54, v52
  v_pk_mul_f32 v[88:89], v[88:89], v[52:53] op_sel_hi:[1,0]
  v_pk_mul_f32 v[90:91], v[90:91], v[52:53] op_sel_hi:[1,0]
  v_pk_mul_f32 v[0:1], v[0:1], v[54:55] op_sel_hi:[1,0]
  v_cvt_pk_bf16_f32 v56, v0, v1
  v_pk_mul_f32 v[2:3], v[2:3], v[54:55] op_sel_hi:[1,0]
  v_cvt_pk_bf16_f32 v57, v2, v3
  v_pk_mul_f32 v[4:5], v[4:5], v[54:55] op_sel_hi:[1,0]
  v_cvt_pk_bf16_f32 v58, v4, v5
  v_pk_mul_f32 v[6:7], v[6:7], v[54:55] op_sel_hi:[1,0]
  v_cvt_pk_bf16_f32 v59, v6, v7
  v_pk_mul_f32 v[8:9], v[8:9], v[54:55] op_sel_hi:[1,0]
  v_cvt_pk_bf16_f32 v60, v8, v9
  v_pk_mul_f32 v[10:11], v[10:11], v[54:55] op_sel_hi:[1,0]
  v_cvt_pk_bf16_f32 v61, v10, v11
  v_pk_mul_f32 v[12:13], v[12:13], v[54:55] op_sel_hi:[1,0]
  v_cvt_pk_bf16_f32 v62, v12, v13
  v_pk_mul_f32 v[14:15], v[14:15], v[54:55] op_sel_hi:[1,0]
  v_cvt_pk_bf16_f32 v63, v14, v15
  v_cvt_pk_bf16_f32 v64, v88, v89
  v_cvt_pk_bf16_f32 v65, v90, v91
  s_waitcnt lgkmcnt(0)
  v_mfma_f32_32x32x16_bf16 v[16:31], v[80:83], v[56:59], 0
  v_mfma_f32_32x32x16_bf16 v[16:31], v[84:87], v[60:63], v[16:31]
  v_mfma_f32_32x32x16_bf16 v[16:31], v[48:51], v[64:67], v[16:31]
  s_nop 11
  s_lshl_b32 s21, s17, 13
  s_add_u32 s75, s21, s35
  s_add_u32 s75, s75, 0x100000
  v_cvt_pk_bf16_f32 v96, v16, v17
  v_cvt_pk_bf16_f32 v97, v18, v19
  v_cvt_pk_bf16_f32 v98, v20, v21
  v_cvt_pk_bf16_f32 v99, v22, v23
  buffer_store_dwordx4 v[96:99], v107, s[4:7], s75 offen sc1
  v_cvt_pk_bf16_f32 v100, v24, v25
  v_cvt_pk_bf16_f32 v101, v26, v27
  v_cvt_pk_bf16_f32 v102, v28, v29
  v_cvt_pk_bf16_f32 v103, v30, v31
  buffer_store_dwordx4 v[100:103], v107, s[4:7], s75 offen offset:1024 sc1
  s_andn2_b32 s21, s17, 3
  s_add_u32 s21, s21, s18
  s_lshl_b32 s21, s21, 13
  s_add_u32 s23, s21, s35
  s_add_u32 s23, s23, 0x100000
  s_add_u32 s24, s23, 4096
  s_mul_i32 s21, s18, 8192
  v_add_u32 v41, s21, v113
  v_add_u32 v41, 32768, v41
  v_add_u32 v42, 32768, v113
  s_mov_b32 s33, 0
wk_pog_63:
  buffer_load_dwordx4 v[0:3], v113, s[4:7], s23 offen offset:0 sc1
  buffer_load_dwordx4 v[4:7], v113, s[4:7], s23 offen offset:1024 sc1
  buffer_load_dwordx4 v[8:11], v113, s[4:7], s23 offen offset:2048 sc1
  buffer_load_dwordx4 v[12:15], v113, s[4:7], s23 offen offset:3072 sc1
  buffer_load_dwordx4 v[16:19], v113, s[4:7], s24 offen offset:0 sc1
  buffer_load_dwordx4 v[20:23], v113, s[4:7], s24 offen offset:1024 sc1
  buffer_load_dwordx4 v[24:27], v113, s[4:7], s24 offen offset:2048 sc1
  buffer_load_dwordx4 v[28:31], v113, s[4:7], s24 offen offset:3072 sc1
  s_add_u32 s33, s33, 1
  s_cmp_gt_u32 s33, 4000000
  s_cbranch_scc1 wk_bail
  s_waitcnt vmcnt(0)
  v_max_u32 v40, v0, v1
  v_max3_u32 v40, v40, v2, v3
  v_max3_u32 v40, v40, v4, v5
  v_max3_u32 v40, v40, v6, v7
  v_max3_u32 v40, v40, v8, v9
  v_max3_u32 v40, v40, v10, v11
  v_max3_u32 v40, v40, v12, v13
  v_max3_u32 v40, v40, v14, v15
  v_max3_u32 v40, v40, v16, v17
  v_max3_u32 v40, v40, v18, v19
  v_max3_u32 v40, v40, v20, v21
  v_max3_u32 v40, v40, v22, v23
  v_max3_u32 v40, v40, v24, v25
  v_max3_u32 v40, v40, v26, v27
  v_max3_u32 v40, v40, v28, v29
  v_max3_u32 v40, v40, v30, v31
  v_cmp_eq_u32 vcc, -1, v40
  s_cbranch_vccnz wk_pog_63
  ds_write_b128 v41, v[0:3] offset:32768
  ds_write_b128 v41, v[4:7] offset:33792
  ds_write_b128 v41, v[8:11] offset:34816
  ds_write_b128 v41, v[12:15] offset:35840
  ds_write_b128 v41, v[16:19] offset:36864
  ds_write_b128 v41, v[20:23] offset:37888
  ds_write_b128 v41, v[24:27] offset:38912
  ds_write_b128 v41, v[28:31] offset:39936
  s_waitcnt lgkmcnt(0)
  s_barrier
  ds_read_b128 v[0:3], v42 offset:32768
  ds_read_b128 v[4:7], v42 offset:33792
  ds_read_b128 v[8:11], v42 offset:34816
  ds_read_b128 v[12:15], v42 offset:35840
  ds_read_b128 v[16:19], v42 offset:36864
  ds_read_b128 v[20:23], v42 offset:37888
  ds_read_b128 v[24:27], v42 offset:38912
  ds_read_b128 v[28:31], v42 offset:39936
  s_waitcnt lgkmcnt(7)
  v_mfma_f32_32x32x16_bf16 v[48:63], v[0:3], a[128:131], 0
  ds_read_b128 v[0:3], v42 offset:40960
  s_waitcnt lgkmcnt(7)
  v_mfma_f32_32x32x16_bf16 v[48:63], v[4:7], a[132:135], v[48:63]
  ds_read_b128 v[4:7], v42 offset:41984
  s_waitcnt lgkmcnt(7)
  v_mfma_f32_32x32x16_bf16 v[48:63], v[8:11], a[136:139], v[48:63]
  ds_read_b128 v[8:11], v42 offset:43008
  s_waitcnt lgkmcnt(7)
  v_mfma_f32_32x32x16_bf16 v[48:63], v[12:15], a[140:143], v[48:63]
  ds_read_b128 v[12:15], v42 offset:44032
  s_waitcnt lgkmcnt(7)
  v_mfma_f32_32x32x16_bf16 v[48:63], v[16:19], a[144:147], v[48:63]
  ds_read_b128 v[16:19], v42 offset:45056
  s_waitcnt lgkmcnt(7)
  v_mfma_f32_32x32x16_bf16 v[48:63], v[20:23], a[148:151], v[48:63]
  ds_read_b128 v[20:23], v42 offset:46080
  s_waitcnt lgkmcnt(7)
  v_mfma_f32_32x32x16_bf16 v[48:63], v[24:27], a[152:155], v[48:63]
  ds_read_b128 v[24:27], v42 offset:47104
  s_waitcnt lgkmcnt(7)
  v_mfma_f32_32x32x16_bf16 v[48:63], v[28:31], a[156:159], v[48:63]
  ds_read_b128 v[28:31], v42 offset:48128
  s_waitcnt lgkmcnt(7)
  v_mfma_f32_32x32x16_bf16 v[48:63], v[0:3], a[160:163], v[48:63]
  ds_read_b128 v[0:3], v42 offset:49152
  s_waitcnt lgkmcnt(7)
  v_mfma_f32_32x32x16_bf16 v[48:63], v[4:7], a[164:167], v[48:63]
  ds_read_b128 v[4:7], v42 offset:50176
  s_waitcnt lgkmcnt(7)
  v_mfma_f32_32x32x16_bf16 v[48:63], v[8:11], a[168:171], v[48:63]
  ds_read_b128 v[8:11], v42 offset:51200
  s_waitcnt lgkmcnt(7)
  v_mfma_f32_32x32x16_bf16 v[48:63], v[12:15], a[172:175], v[48:63]
  ds_read_b128 v[12:15], v42 offset:52224
  s_waitcnt lgkmcnt(7)
  v_mfma_f32_32x32x16_bf16 v[48:63], v[16:19], a[176:179], v[48:63]
  ds_read_b128 v[16:19], v42 offset:53248
  s_waitcnt lgkmcnt(7)
  v_mfma_f32_32x32x16_bf16 v[48:63], v[20:23], a[180:183], v[48:63]
  ds_read_b128 v[20:23], v42 offset:54272
  s_waitcnt lgkmcnt(7)
  v_mfma_f32_32x32x16_bf16 v[48:63], v[24:27], a[184:187], v[48:63]
  ds_read_b128 v[24:27], v42 offset:55296
  s_waitcnt lgkmcnt(7)
  v_mfma_f32_32x32x16_bf16 v[48:63], v[28:31], a[188:191], v[48:63]
  ds_read_b128 v[28:31], v42 offset:56320
  s_waitcnt lgkmcnt(7)
  v_mfma_f32_32x32x16_bf16 v[48:63], v[0:3], a[192:195], v[48:63]
  ds_read_b128 v[0:3], v42 offset:57344
  s_waitcnt lgkmcnt(7)
  v_mfma_f32_32x32x16_bf16 v[48:63], v[4:7], a[196:199], v[48:63]
  ds_read_b128 v[4:7], v42 offset:58368
  s_waitcnt lgkmcnt(7)
  v_mfma_f32_32x32x16_bf16 v[48:63], v[8:11], a[200:203], v[48:63]
  ds_read_b128 v[8:11], v42 offset:59392
  s_waitcnt lgkmcnt(7)
  v_mfma_f32_32x32x16_bf16 v[48:63], v[12:15], a[204:207], v[48:63]
  ds_read_b128 v[12:15], v42 offset:60416
  s_waitcnt lgkmcnt(7)
  v_mfma_f32_32x32x16_bf16 v[48:63], v[16:19], a[208:211], v[48:63]
  ds_read_b128 v[16:19], v42 offset:61440
  s_waitcnt lgkmcnt(7)
  v_mfma_f32_32x32x16_bf16 v[48:63], v[20:23], a[212:215], v[48:63]
  ds_read_b128 v[20:23], v42 offset:62464
  s_waitcnt lgkmcnt(7)
  v_mfma_f32_32x32x16_bf16 v[48:63], v[24:27], a[216:219], v[48:63]
  ds_read_b128 v[24:27], v42 offset:63488
  s_waitcnt lgkmcnt(7)
  v_mfma_f32_32x32x16_bf16 v[48:63], v[28:31], a[220:223], v[48:63]
  ds_read_b128 v[28:31], v42 offset:64512
  s_waitcnt lgkmcnt(7)
  v_mfma_f32_32x32x16_bf16 v[48:63], v[0:3], a[224:227], v[48:63]
  s_waitcnt lgkmcnt(6)
  v_mfma_f32_32x32x16_bf16 v[48:63], v[4:7], a[228:231], v[48:63]
  s_waitcnt lgkmcnt(5)
  v_mfma_f32_32x32x16_bf16 v[48:63], v[8:11], a[232:235], v[48:63]
  s_waitcnt lgkmcnt(4)
  v_mfma_f32_32x32x16_bf16 v[48:63], v[12:15], a[236:239], v[48:63]
  s_waitcnt lgkmcnt(3)
  v_mfma_f32_32x32x16_bf16 v[48:63], v[16:19], a[240:243], v[48:63]
  s_waitcnt lgkmcnt(2)
  v_mfma_f32_32x32x16_bf16 v[48:63], v[20:23], a[244:247], v[48:63]
  s_waitcnt lgkmcnt(1)
  v_mfma_f32_32x32x16_bf16 v[48:63], v[24:27], a[248:251], v[48:63]
  s_waitcnt lgkmcnt(0)
  v_mfma_f32_32x32x16_bf16 v[48:63], v[28:31], a[252:255], v[48:63]
  s_nop 11
  s_add_u32 s21, s72, 0
  buffer_store_dword v48, v117, s[4:7], s21 offen sc1
  s_add_u32 s21, s72, 16384
  buffer_store_dword v49, v117, s[4:7], s21 offen sc1
  s_add_u32 s21, s72, 32768
  buffer_store_dword v50, v117, s[4:7], s21 offen sc1
  s_add_u32 s21, s72, 49152
  buffer_store_dword v51, v117, s[4:7], s21 offen sc1
  s_add_u32 s21, s72, 131072
  buffer_store_dword v52, v117, s[4:7], s21 offen sc1
  s_add_u32 s21, s72, 147456
  buffer_store_dword v53, v117, s[4:7], s21 offen sc1
  s_add_u32 s21, s72, 163840
  buffer_store_dword v54, v117, s[4:7], s21 offen sc1
  s_add_u32 s21, s72, 180224
  buffer_store_dword v55, v117, s[4:7], s21 offen sc1
  s_add_u32 s21, s72, 262144
  buffer_store_dword v56, v117, s[4:7], s21 offen sc1
  s_add_u32 s21, s72, 278528
  buffer_store_dword v57, v117, s[4:7], s21 offen sc1
  s_add_u32 s21, s72, 294912
  buffer_store_dword v58, v117, s[4:7], s21 offen sc1
  s_add_u32 s21, s72, 311296
  buffer_store_dword v59, v117, s[4:7], s21 offen sc1
  s_add_u32 s21, s72, 393216
  buffer_store_dword v60, v117, s[4:7], s21 offen sc1
  s_add_u32 s21, s72, 409600
  buffer_store_dword v61, v117, s[4:7], s21 offen sc1
  s_add_u32 s21, s72, 425984
  buffer_store_dword v62, v117, s[4:7], s21 offen sc1
  s_add_u32 s21, s72, 442368
  buffer_store_dword v63, v117, s[4:7], s21 offen sc1
  ds_read_b128 v[64:67], v126 offset:1024
  ds_read_b128 v[68:71], v126 offset:2048
  v_mov_b64 v[40:41], -1
  v_mov_b64 v[42:43], -1

  s_mov_b32 s33, 0
wk_prs_64:
  s_add_u32 s21, s73, 0
  buffer_load_dwordx4 v[0:3], v114, s[4:7], s21 offen sc1
  s_add_u32 s21, s73, 4096
  buffer_load_dwordx4 v[4:7], v114, s[4:7], s21 offen sc1
  s_add_u32 s21, s73, 8192
  buffer_load_dwordx4 v[8:11], v114, s[4:7], s21 offen sc1
  s_add_u32 s21, s73, 12288
  buffer_load_dwordx4 v[12:15], v114, s[4:7], s21 offen sc1
  s_add_u32 s33, s33, 1
  s_cmp_gt_u32 s33, 4000000
  s_cbranch_scc1 wk_bail
  s_waitcnt vmcnt(0)
  v_max_u32 v36, v0, v1
  v_max3_u32 v36, v36, v2, v3
  v_max3_u32 v36, v36, v4, v5
  v_max3_u32 v36, v36, v6, v7
  v_max3_u32 v36, v36, v8, v9
  v_max3_u32 v36, v36, v10, v11
  v_max3_u32 v36, v36, v12, v13
  v_max3_u32 v36, v36, v14, v15
  v_cmp_eq_u32 vcc, -1, v36
  s_cbranch_vccnz wk_prs_64
  v_pk_add_f32 v[0:1], v[0:1], v[4:5]
  v_pk_add_f32 v[8:9], v[8:9], v[12:13]
  v_pk_add_f32 v[2:3], v[2:3], v[6:7]
  v_pk_add_f32 v[10:11], v[10:11], v[14:15]
  v_pk_add_f32 v[0:1], v[0:1], v[8:9]
  v_pk_add_f32 v[2:3], v[2:3], v[10:11]
  s_add_u32 s21, s73, 0
  buffer_store_dwordx4 v[40:43], v114, s[4:7], s21 offen sc1
  s_add_u32 s21, s73, 4096
  buffer_store_dwordx4 v[40:43], v114, s[4:7], s21 offen sc1
  s_add_u32 s21, s73, 8192
  buffer_store_dwordx4 v[40:43], v114, s[4:7], s21 offen sc1
  s_add_u32 s21, s73, 12288
  buffer_store_dwordx4 v[40:43], v114, s[4:7], s21 offen sc1
  v_permlane32_swap_b32 v0, v2
  v_permlane32_swap_b32 v1, v3
  v_pk_add_f32 v[32:33], v[0:1], v[2:3]
  s_waitcnt lgkmcnt(0)
  v_cvt_pk_bf16_f32 v36, v32, v33
  v_lshlrev_b32 v32, 16, v36
  v_and_b32 v33, 0xffff0000, v36
  v_lshlrev_b32 v0, 16, v64
  v_and_b32 v1, 0xffff0000, v64
  v_pk_mul_f32 v[32:33], v[32:33], v[0:1]
  v_lshlrev_b32 v2, 16, v104
  v_and_b32 v3, 0xffff0000, v104
  v_cvt_pk_bf16_f32 v36, v32, v33
  v_lshlrev_b32 v32, 16, v36
  v_and_b32 v33, 0xffff0000, v36
  v_pk_add_f32 v[32:33], v[32:33], v[2:3]
  v_cvt_pk_bf16_f32 v104, v32, v33
  v_lshlrev_b32 v32, 16, v104
  v_and_b32 v33, 0xffff0000, v104
  v_add_f32 v36, v32, v33
  s_nop 1
  v_add_f32_dpp v36, v36, v36 quad_perm:[1,0,3,2] row_mask:0xf bank_mask:0xf
  s_nop 1
  v_add_f32_dpp v36, v36, v36 quad_perm:[2,3,0,1] row_mask:0xf bank_mask:0xf
  s_nop 1
  v_add_f32_dpp v36, v36, v36 row_ror:4 row_mask:0xf bank_mask:0xf
  s_nop 1
  v_add_f32_dpp v36, v36, v36 row_ror:8 row_mask:0xf bank_mask:0xf
  v_mov_b32 v38, v36
  s_nop 1
  v_permlane16_swap_b32 v36, v38
  v_add_f32 v36, v36, v38
  v_mov_b32 v38, v36
  s_nop 1
  v_permlane32_swap_b32 v36, v38
  v_add_f32 v36, v36, v38
  v_mul_f32 v36, 0x3c000000, v36
  v_sub_f32 v34, v32, v36
  v_sub_f32 v35, v33, v36
  v_mul_f32 v37, v34, v34
  v_fmac_f32 v37, v35, v35
  s_nop 1
  v_add_f32_dpp v37, v37, v37 quad_perm:[1,0,3,2] row_mask:0xf bank_mask:0xf
  s_nop 1
  v_add_f32_dpp v37, v37, v37 quad_perm:[2,3,0,1] row_mask:0xf bank_mask:0xf
  s_nop 1
  v_add_f32_dpp v37, v37, v37 row_ror:4 row_mask:0xf bank_mask:0xf
  s_nop 1
  v_add_f32_dpp v37, v37, v37 row_ror:8 row_mask:0xf bank_mask:0xf
  v_mov_b32 v38, v37
  s_nop 1
  v_permlane16_swap_b32 v37, v38
  v_add_f32 v37, v37, v38
  v_mov_b32 v38, v37
  s_nop 1
  v_permlane32_swap_b32 v37, v38
  v_add_f32 v37, v37, v38
  s_lshl_b32 s21, s18, 3
  v_mov_b32 v38, s21
  ds_write_b64 v38, v[36:37] offset:26624
  v_mov_b32 v38, 0
  v_lshlrev_b32 v8, 16, v65
  v_and_b32 v9, 0xffff0000, v65
  v_lshlrev_b32 v10, 16, v66
  v_and_b32 v11, 0xffff0000, v66
  s_waitcnt vmcnt(0) lgkmcnt(0)
  s_barrier
  ds_read_b128 v[0:3], v38 offset:26624
  ds_read_b128 v[4:7], v38 offset:26640
  buffer_store_dwordx4 v[40:43], v107, s[4:7], s75 offen sc1
  buffer_store_dwordx4 v[40:43], v107, s[4:7], s75 offen offset:1024 sc1
  s_waitcnt lgkmcnt(0)
  v_add_f32 v36, v0, v2
  v_add_f32 v38, v4, v6
  v_add_f32 v37, v1, v3
  v_add_f32 v36, v36, v38
  v_add_f32 v39, v5, v7
  v_mul_f32 v36, 0x3e800000, v36
  v_add_f32 v37, v37, v39
  v_sub_f32 v0, v0, v36
  v_sub_f32 v2, v2, v36
  v_sub_f32 v4, v4, v36
  v_sub_f32 v6, v6, v36
  v_mul_f32 v38, v0, v0
  v_fmac_f32 v38, v2, v2
  v_fmac_f32 v38, v4, v4
  v_fmac_f32 v38, v6, v6
  v_mul_f32 v38, 0x43000000, v38
  v_add_f32 v37, v37, v38
  v_mul_f32 v38, 0x3b000000, v37
  v_cvt_pk_bf16_f32 v38, v38, v38
  v_lshlrev_b32 v38, 16, v38
  v_add_f32 v38, 0x3727c5ac, v38
  v_cvt_pk_bf16_f32 v38, v38, v38
  v_lshlrev_b32 v38, 16, v38
  v_sqrt_f32 v38, v38
  v_cvt_pk_bf16_f32 v36, v36, v36
  v_lshlrev_b32 v36, 16, v36
  v_cvt_pk_bf16_f32 v38, v38, v38
  v_lshlrev_b32 v38, 16, v38
  v_rcp_f32 v38, v38
  v_sub_f32 v34, v32, v36
  v_sub_f32 v35, v33, v36
  v_cvt_pk_bf16_f32 v37, v34, v35
  v_lshlrev_b32 v34, 16, v37
  v_and_b32 v35, 0xffff0000, v37
  v_pk_mul_f32 v[34:35], v[34:35], v[38:39] op_sel_hi:[1,0]
  v_cvt_pk_bf16_f32 v37, v34, v35
  v_lshlrev_b32 v34, 16, v37
  v_and_b32 v35, 0xffff0000, v37
  v_pk_mul_f32 v[34:35], v[34:35], v[10:11]
  v_cvt_pk_bf16_f32 v37, v34, v35
  v_lshlrev_b32 v34, 16, v37
  v_and_b32 v35, 0xffff0000, v37
  v_pk_add_f32 v[34:35], v[34:35], v[8:9]
  v_cvt_pk_bf16_f32 v37, v34, v35
  v_min_u32 v37, 0xfffffffe, v37
  s_cmp_lt_u32 s17, 28
  s_cbranch_scc1 w3q_65
  s_waitcnt vmcnt(0)
w3q_65:
  s_xor_b32 s21, s74, 32768
  buffer_store_dword v37, v127, s[4:7], s74 offen sc1
  buffer_store_dword v40, v127, s[4:7], s21 offen sc1
  s_cmp_ge_u32 s17, 28
  s_cbranch_scc1 w3noffn_66
  v_lshlrev_b32 v108, 16, v70
  v_and_b32 v109, 0xffff0000, v70
  v_lshlrev_b32 v110, 16, v71
  v_and_b32 v111, 0xffff0000, v71
  s_lshl_b32 s23, s18, 13
  s_add_u32 s23, s23, s74
  s_add_u32 s24, s23, 4096
  s_mul_i32 s21, s18, 8192
  v_add_u32 v41, s21, v113
  v_add_u32 v41, 32768, v41
  v_add_u32 v42, 32768, v113
  s_mov_b32 s33, 0
wk_pag_67:
  buffer_load_dwordx4 v[0:3], v113, s[4:7], s23 offen offset:0 sc1
  buffer_load_dwordx4 v[4:7], v113, s[4:7], s23 offen offset:1024 sc1
  buffer_load_dwordx4 v[8:11], v113, s[4:7], s23 offen offset:2048 sc1
  buffer_load_dwordx4 v[12:15], v113, s[4:7], s23 offen offset:3072 sc1
  buffer_load_dwordx4 v[16:19], v113, s[4:7], s24 offen offset:0 sc1
  buffer_load_dwordx4 v[20:23], v113, s[4:7], s24 offen offset:1024 sc1
  buffer_load_dwordx4 v[24:27], v113, s[4:7], s24 offen offset:2048 sc1
  buffer_load_dwordx4 v[28:31], v113, s[4:7], s24 offen offset:3072 sc1
  s_add_u32 s33, s33, 1
  s_cmp_gt_u32 s33, 4000000
  s_cbranch_scc1 wk_bail
  s_waitcnt vmcnt(0)
  v_max_u32 v40, v0, v1
  v_max3_u32 v40, v40, v2, v3
  v_max3_u32 v40, v40, v4, v5
  v_max3_u32 v40, v40, v6, v7
  v_max3_u32 v40, v40, v8, v9
  v_max3_u32 v40, v40, v10, v11
  v_max3_u32 v40, v40, v12, v13
  v_max3_u32 v40, v40, v14, v15
  v_max3_u32 v40, v40, v16, v17
  v_max3_u32 v40, v40, v18, v19
  v_max3_u32 v40, v40, v20, v21
  v_max3_u32 v40, v40, v22, v23
  v_max3_u32 v40, v40, v24, v25
  v_max3_u32 v40, v40, v26, v27
  v_max3_u32 v40, v40, v28, v29
  v_max3_u32 v40, v40, v30, v31
  v_cmp_eq_u32 vcc, -1, v40
  s_cbranch_vccnz wk_pag_67
  ds_write_b128 v41, v[0:3] offset:32768
  ds_write_b128 v41, v[4:7] offset:33792
  ds_write_b128 v41, v[8:11] offset:34816
  ds_write_b128 v41, v[12:15] offset:35840
  ds_write_b128 v41, v[16:19] offset:36864
  ds_write_b128 v41, v[20:23] offset:37888
  ds_write_b128 v41, v[24:27] offset:38912
  ds_write_b128 v41, v[28:31] offset:39936
  s_waitcnt lgkmcnt(0)
  s_barrier
  v_add_u32 v42, 32768, v124
  ds_read_b128 v[0:3], v42 offset:32768
  ds_read_b128 v[4:7], v42 offset:33024
  ds_read_b128 v[8:11], v42 offset:34816
  ds_read_b128 v[12:15], v42 offset:35072
  ds_read_b128 v[16:19], v42 offset:36864
  ds_read_b128 v[20:23], v42 offset:37120
  ds_read_b128 v[24:27], v42 offset:38912
  ds_read_b128 v[28:31], v42 offset:39168
  s_waitcnt lgkmcnt(7)
  v_mfma_f32_16x16x32_bf16 v[32:35], v[128:131], v[0:3], 0
  ds_read_b128 v[0:3], v42 offset:40960
  s_waitcnt lgkmcnt(7)
  v_mfma_f32_16x16x32_bf16 v[36:39], v[128:131], v[4:7], 0
  ds_read_b128 v[4:7], v42 offset:41216
  s_waitcnt lgkmcnt(7)
  v_mfma_f32_16x16x32_bf16 v[32:35], v[132:135], v[8:11], v[32:35]
  ds_read_b128 v[8:11], v42 offset:43008
  s_waitcnt lgkmcnt(7)
  v_mfma_f32_16x16x32_bf16 v[36:39], v[132:135], v[12:15], v[36:39]
  ds_read_b128 v[12:15], v42 offset:43264
  s_waitcnt lgkmcnt(7)
  v_mfma_f32_16x16x32_bf16 v[32:35], v[136:139], v[16:19], v[32:35]
  ds_read_b128 v[16:19], v42 offset:45056
  s_waitcnt lgkmcnt(7)
  v_mfma_f32_16x16x32_bf16 v[36:39], v[136:139], v[20:23], v[36:39]
  ds_read_b128 v[20:23], v42 offset:45312
  s_waitcnt lgkmcnt(7)
  v_mfma_f32_16x16x32_bf16 v[32:35], v[140:143], v[24:27], v[32:35]
  ds_read_b128 v[24:27], v42 offset:47104
  s_waitcnt lgkmcnt(7)
  v_mfma_f32_16x16x32_bf16 v[36:39], v[140:143], v[28:31], v[36:39]
  ds_read_b128 v[28:31], v42 offset:47360
  s_waitcnt lgkmcnt(7)
  v_mfma_f32_16x16x32_bf16 v[32:35], v[144:147], v[0:3], v[32:35]
  ds_read_b128 v[0:3], v42 offset:49152
  s_waitcnt lgkmcnt(7)
  v_mfma_f32_16x16x32_bf16 v[36:39], v[144:147], v[4:7], v[36:39]
  ds_read_b128 v[4:7], v42 offset:49408
  s_waitcnt lgkmcnt(7)
  v_mfma_f32_16x16x32_bf16 v[32:35], v[148:151], v[8:11], v[32:35]
  ds_read_b128 v[8:11], v42 offset:51200
  s_waitcnt lgkmcnt(7)
  v_mfma_f32_16x16x32_bf16 v[36:39], v[148:151], v[12:15], v[36:39]
  ds_read_b128 v[12:15], v42 offset:51456
  s_waitcnt lgkmcnt(7)
  v_mfma_f32_16x16x32_bf16 v[32:35], v[152:155], v[16:19], v[32:35]
  ds_read_b128 v[16:19], v42 offset:53248
  s_waitcnt lgkmcnt(7)
  v_mfma_f32_16x16x32_bf16 v[36:39], v[152:155], v[20:23], v[36:39]
  ds_read_b128 v[20:23], v42 offset:53504
  s_waitcnt lgkmcnt(7)
  v_mfma_f32_16x16x32_bf16 v[32:35], v[156:159], v[24:27], v[32:35]
  ds_read_b128 v[24:27], v42 offset:55296
  s_waitcnt lgkmcnt(7)
  v_mfma_f32_16x16x32_bf16 v[36:39], v[156:159], v[28:31], v[36:39]
  ds_read_b128 v[28:31], v42 offset:55552
  s_waitcnt lgkmcnt(7)
  v_mfma_f32_16x16x32_bf16 v[32:35], v[160:163], v[0:3], v[32:35]
  ds_read_b128 v[0:3], v42 offset:57344
  s_waitcnt lgkmcnt(7)
  v_mfma_f32_16x16x32_bf16 v[36:39], v[160:163], v[4:7], v[36:39]
  ds_read_b128 v[4:7], v42 offset:57600
  s_waitcnt lgkmcnt(7)
  v_mfma_f32_16x16x32_bf16 v[32:35], v[164:167], v[8:11], v[32:35]
  ds_read_b128 v[8:11], v42 offset:59392
  s_waitcnt lgkmcnt(7)
  v_mfma_f32_16x16x32_bf16 v[36:39], v[164:167], v[12:15], v[36:39]
  ds_read_b128 v[12:15], v42 offset:59648
  s_waitcnt lgkmcnt(7)
  v_mfma_f32_16x16x32_bf16 v[32:35], v[168:171], v[16:19], v[32:35]
  ds_read_b128 v[16:19], v42 offset:61440
  s_waitcnt lgkmcnt(7)
  v_mfma_f32_16x16x32_bf16 v[36:39], v[168:171], v[20:23], v[36:39]
  ds_read_b128 v[20:23], v42 offset:61696
  s_waitcnt lgkmcnt(7)
  v_mfma_f32_16x16x32_bf16 v[32:35], v[172:175], v[24:27], v[32:35]
  ds_read_b128 v[24:27], v42 offset:63488
  s_waitcnt lgkmcnt(7)
  v_mfma_f32_16x16x32_bf16 v[36:39], v[172:175], v[28:31], v[36:39]
  ds_read_b128 v[28:31], v42 offset:63744
  s_waitcnt lgkmcnt(7)
  v_mfma_f32_16x16x32_bf16 v[32:35], v[176:179], v[0:3], v[32:35]
  s_waitcnt lgkmcnt(6)
  v_mfma_f32_16x16x32_bf16 v[36:39], v[176:179], v[4:7], v[36:39]
  s_waitcnt lgkmcnt(5)
  v_mfma_f32_16x16x32_bf16 v[32:35], v[180:183], v[8:11], v[32:35]
  s_waitcnt lgkmcnt(4)
  v_mfma_f32_16x16x32_bf16 v[36:39], v[180:183], v[12:15], v[36:39]
  s_waitcnt lgkmcnt(3)
  v_mfma_f32_16x16x32_bf16 v[32:35], v[184:187], v[16:19], v[32:35]
  s_waitcnt lgkmcnt(2)
  v_mfma_f32_16x16x32_bf16 v[36:39], v[184:187], v[20:23], v[36:39]
  s_waitcnt lgkmcnt(1)
  v_mfma_f32_16x16x32_bf16 v[32:35], v[188:191], v[24:27], v[32:35]
  s_waitcnt lgkmcnt(0)
  v_mfma_f32_16x16x32_bf16 v[36:39], v[188:191], v[28:31], v[36:39]
  v_mov_b32 v40, s71
  s_nop 6
  v_cvt_pk_bf16_f32 v41, v32, v33
  v_lshlrev_b32 v32, 16, v41
  v_and_b32 v33, 0xffff0000, v41
  v_cvt_pk_bf16_f32 v41, v34, v35
  v_lshlrev_b32 v34, 16, v41
  v_and_b32 v35, 0xffff0000, v41
  v_cvt_pk_bf16_f32 v41, v36, v37
  v_lshlrev_b32 v36, 16, v41
  v_and_b32 v37, 0xffff0000, v41
  v_cvt_pk_bf16_f32 v41, v38, v39
  v_lshlrev_b32 v38, 16, v41
  v_and_b32 v39, 0xffff0000, v41
  v_pk_add_f32 v[32:33], v[32:33], v[108:109]
  v_pk_add_f32 v[34:35], v[34:35], v[110:111]
  v_pk_add_f32 v[36:37], v[36:37], v[108:109]
  v_pk_add_f32 v[38:39], v[38:39], v[110:111]
  v_cvt_pk_bf16_f32 v41, v32, v33
  v_lshlrev_b32 v32, 16, v41
  v_and_b32 v33, 0xffff0000, v41
  v_cvt_pk_bf16_f32 v41, v34, v35
  v_lshlrev_b32 v34, 16, v41
  v_and_b32 v35, 0xffff0000, v41
  v_cvt_pk_bf16_f32 v41, v36, v37
  v_lshlrev_b32 v36, 16, v41
  v_and_b32 v37, 0xffff0000, v41
  v_cvt_pk_bf16_f32 v41, v38, v39
  v_lshlrev_b32 v38, 16, v41
  v_and_b32 v39, 0xffff0000, v41
  v_pk_mul_f32 v[0:1], v[32:33], v[32:33]
  v_pk_mul_f32 v[2:3], v[34:35], v[34:35]
  v_pk_mul_f32 v[4:5], v[36:37], v[36:37]
  v_pk_mul_f32 v[6:7], v[38:39], v[38:39]
  v_fma_f32 v0, v0, s70, v40
  v_fma_f32 v1, v1, s70, v40
  v_fma_f32 v2, v2, s70, v40
  v_fma_f32 v3, v3, s70, v40
  v_fma_f32 v4, v4, s70, v40
  v_fma_f32 v5, v5, s70, v40
  v_fma_f32 v6, v6, s70, v40
  v_fma_f32 v7, v7, s70, v40
  v_pk_mul_f32 v[0:1], v[0:1], v[32:33]
  v_pk_mul_f32 v[2:3], v[2:3], v[34:35]
  v_pk_mul_f32 v[4:5], v[4:5], v[36:37]
  v_pk_mul_f32 v[6:7], v[6:7], v[38:39]
  v_exp_f32 v0, v0
  v_exp_f32 v1, v1
  v_exp_f32 v2, v2
  v_exp_f32 v3, v3
  v_exp_f32 v4, v4
  v_exp_f32 v5, v5
  v_exp_f32 v6, v6
  v_exp_f32 v7, v7
  v_add_f32 v0, 1.0, v0
  v_add_f32 v1, 1.0, v1
  v_add_f32 v2, 1.0, v2
  v_add_f32 v3, 1.0, v3
  v_add_f32 v4, 1.0, v4
  v_add_f32 v5, 1.0, v5
  v_add_f32 v6, 1.0, v6
  v_add_f32 v7, 1.0, v7
  v_rcp_f32 v0, v0
  v_rcp_f32 v1, v1
  v_rcp_f32 v2, v2
  v_rcp_f32 v3, v3
  v_rcp_f32 v4, v4
  v_rcp_f32 v5, v5
  v_rcp_f32 v6, v6
  v_rcp_f32 v7, v7
  v_pk_mul_f32 v[32:33], v[32:33], v[0:1]
  v_cvt_pk_bf16_f32 v8, v32, v33
  v_pk_mul_f32 v[34:35], v[34:35], v[2:3]
  v_cvt_pk_bf16_f32 v9, v34, v35
  v_pk_mul_f32 v[36:37], v[36:37], v[4:5]
  v_cvt_pk_bf16_f32 v10, v36, v37
  v_pk_mul_f32 v[38:39], v[38:39], v[6:7]
  v_cvt_pk_bf16_f32 v11, v38, v39
  s_lshl_b32 s21, s17, 12
  s_add_u32 s75, s21, s35
  s_add_u32 s75, s75, 0x180000
  v_min_u32 v8, 0xfffffffe, v8
  v_min_u32 v9, 0xfffffffe, v9
  v_min_u32 v10, 0xfffffffe, v10
  v_min_u32 v11, 0xfffffffe, v11
  buffer_store_dwordx2 v[8:9], v123, s[4:7], s75 offen sc1
  buffer_store_dwordx2 v[10:11], v123, s[4:7], s75 offen offset:256 sc1
  s_barrier
  s_andn2_b32 s21, s17, 3
  s_add_u32 s21, s21, s18
  s_lshl_b32 s21, s21, 12
  s_add_u32 s23, s21, s35
  s_add_u32 s23, s23, 0x180000
  s_add_u32 s24, s23, 4096
  s_mul_i32 s21, s18, 4096
  v_add_u32 v41, s21, v113
  v_add_u32 v41, 32768, v41
  v_add_u32 v42, 32768, v113
  s_mov_b32 s33, 0
wk_pfg_68:
  buffer_load_dwordx4 v[0:3], v113, s[4:7], s23 offen offset:0 sc1
  buffer_load_dwordx4 v[4:7], v113, s[4:7], s23 offen offset:1024 sc1
  buffer_load_dwordx4 v[8:11], v113, s[4:7], s23 offen offset:2048 sc1
  buffer_load_dwordx4 v[12:15], v113, s[4:7], s23 offen offset:3072 sc1
  s_add_u32 s33, s33, 1
  s_cmp_gt_u32 s33, 4000000
  s_cbranch_scc1 wk_bail
  s_waitcnt vmcnt(0)
  v_max_u32 v40, v0, v1
  v_max3_u32 v40, v40, v2, v3
  v_max3_u32 v40, v40, v4, v5
  v_max3_u32 v40, v40, v6, v7
  v_max3_u32 v40, v40, v8, v9
  v_max3_u32 v40, v40, v10, v11
  v_max3_u32 v40, v40, v12, v13
  v_max3_u32 v40, v40, v14, v15
  v_cmp_eq_u32 vcc, -1, v40
  s_cbranch_vccnz wk_pfg_68
  ds_write_b128 v41, v[0:3] offset:32768
  ds_write_b128 v41, v[4:7] offset:33792
  ds_write_b128 v41, v[8:11] offset:34816
  ds_write_b128 v41, v[12:15] offset:35840
  s_waitcnt lgkmcnt(0)
  s_barrier
  ds_read_b128 v[0:3], v42 offset:32768
  ds_read_b128 v[4:7], v42 offset:33792
  ds_read_b128 v[8:11], v42 offset:34816
  ds_read_b128 v[12:15], v42 offset:35840
  ds_read_b128 v[16:19], v42 offset:36864
  ds_read_b128 v[20:23], v42 offset:37888
  ds_read_b128 v[24:27], v42 offset:38912
  ds_read_b128 v[28:31], v42 offset:39936
  s_waitcnt lgkmcnt(7)
  v_mfma_f32_32x32x16_bf16 v[48:63], v[0:3], v[192:195], 0
  ds_read_b128 v[0:3], v42 offset:40960
  s_waitcnt lgkmcnt(7)
  v_mfma_f32_32x32x16_bf16 v[48:63], v[4:7], v[196:199], v[48:63]
  ds_read_b128 v[4:7], v42 offset:41984
  s_waitcnt lgkmcnt(7)
  v_mfma_f32_32x32x16_bf16 v[48:63], v[8:11], v[200:203], v[48:63]
  ds_read_b128 v[8:11], v42 offset:43008
  s_waitcnt lgkmcnt(7)
  v_mfma_f32_32x32x16_bf16 v[48:63], v[12:15], v[204:207], v[48:63]
  ds_read_b128 v[12:15], v42 offset:44032
  s_waitcnt lgkmcnt(7)
  v_mfma_f32_32x32x16_bf16 v[48:63], v[16:19], v[208:211], v[48:63]
  ds_read_b128 v[16:19], v42 offset:45056
  s_waitcnt lgkmcnt(7)
  v_mfma_f32_32x32x16_bf16 v[48:63], v[20:23], v[212:215], v[48:63]
  ds_read_b128 v[20:23], v42 offset:46080
  s_waitcnt lgkmcnt(7)
  v_mfma_f32_32x32x16_bf16 v[48:63], v[24:27], v[216:219], v[48:63]
  ds_read_b128 v[24:27], v42 offset:47104
  s_waitcnt lgkmcnt(7)
  v_mfma_f32_32x32x16_bf16 v[48:63], v[28:31], v[220:223], v[48:63]
  ds_read_b128 v[28:31], v42 offset:48128
  s_waitcnt lgkmcnt(7)
  v_mfma_f32_32x32x16_bf16 v[48:63], v[0:3], v[224:227], v[48:63]
  s_waitcnt lgkmcnt(6)
  v_mfma_f32_32x32x16_bf16 v[48:63], v[4:7], v[228:231], v[48:63]
  s_waitcnt lgkmcnt(5)
  v_mfma_f32_32x32x16_bf16 v[48:63], v[8:11], v[232:235], v[48:63]
  s_waitcnt lgkmcnt(4)
  v_mfma_f32_32x32x16_bf16 v[48:63], v[12:15], v[236:239], v[48:63]
  s_waitcnt lgkmcnt(3)
  v_mfma_f32_32x32x16_bf16 v[48:63], v[16:19], v[240:243], v[48:63]
  s_waitcnt lgkmcnt(2)
  v_mfma_f32_32x32x16_bf16 v[48:63], v[20:23], v[244:247], v[48:63]
  s_waitcnt lgkmcnt(1)
  v_mfma_f32_32x32x16_bf16 v[48:63], v[24:27], v[248:251], v[48:63]
  s_waitcnt lgkmcnt(0)
  v_mfma_f32_32x32x16_bf16 v[48:63], v[28:31], v[252:255], v[48:63]
  s_nop 11
  s_add_u32 s21, s72, 524288
  buffer_store_dword v48, v117, s[4:7], s21 offen sc1
  s_add_u32 s21, s72, 540672
  buffer_store_dword v49, v117, s[4:7], s21 offen sc1
  s_add_u32 s21, s72, 557056
  buffer_store_dword v50, v117, s[4:7], s21 offen sc1
  s_add_u32 s21, s72, 573440
  buffer_store_dword v51, v117, s[4:7], s21 offen sc1
  s_add_u32 s21, s72, 655360
  buffer_store_dword v52, v117, s[4:7], s21 offen sc1
  s_add_u32 s21, s72, 671744
  buffer_store_dword v53, v117, s[4:7], s21 offen sc1
  s_add_u32 s21, s72, 688128
  buffer_store_dword v54, v117, s[4:7], s21 offen sc1
  s_add_u32 s21, s72, 704512
  buffer_store_dword v55, v117, s[4:7], s21 offen sc1
  s_add_u32 s21, s72, 786432
  buffer_store_dword v56, v117, s[4:7], s21 offen sc1
  s_add_u32 s21, s72, 802816
  buffer_store_dword v57, v117, s[4:7], s21 offen sc1
  s_add_u32 s21, s72, 819200
  buffer_store_dword v58, v117, s[4:7], s21 offen sc1
  s_add_u32 s21, s72, 835584
  buffer_store_dword v59, v117, s[4:7], s21 offen sc1
  s_add_u32 s21, s72, 917504
  buffer_store_dword v60, v117, s[4:7], s21 offen sc1
  s_add_u32 s21, s72, 933888
  buffer_store_dword v61, v117, s[4:7], s21 offen sc1
  s_add_u32 s21, s72, 950272
  buffer_store_dword v62, v117, s[4:7], s21 offen sc1
  s_add_u32 s21, s72, 966656
  buffer_store_dword v63, v117, s[4:7], s21 offen sc1
w3noffn_66:
  ds_read_b128 v[64:67], v126 offset:1024
  ds_read_b128 v[68:71], v126 offset:2048
  v_mov_b64 v[40:41], -1
  v_mov_b64 v[42:43], -1
  v_mov_b64 v[12:13], 0
  v_mov_b64 v[14:15], 0

  s_mov_b32 s33, 0
wk_prs_69:
  s_add_u32 s21, s73, 524288
  buffer_load_dwordx4 v[0:3], v114, s[4:7], s21 offen sc1
  s_add_u32 s21, s73, 528384
  buffer_load_dwordx4 v[4:7], v114, s[4:7], s21 offen sc1
  s_add_u32 s21, s73, 532480
  buffer_load_dwordx4 v[8:11], v114, s[4:7], s21 offen sc1
  s_add_u32 s21, s73, 536576
  s_mov_b64 exec, s[78:79]
  buffer_load_dwordx4 v[12:15], v114, s[4:7], s21 offen sc1
  s_mov_b64 exec, -1
  s_add_u32 s33, s33, 1
  s_cmp_gt_u32 s33, 4000000
  s_cbranch_scc1 wk_bail
  s_waitcnt vmcnt(0)
  v_max_u32 v36, v0, v1
  v_max3_u32 v36, v36, v2, v3
  v_max3_u32 v36, v36, v4, v5
  v_max3_u32 v36, v36, v6, v7
  v_max3_u32 v36, v36, v8, v9
  v_max3_u32 v36, v36, v10, v11
  v_max3_u32 v36, v36, v12, v13
  v_max3_u32 v36, v36, v14, v15
  v_cmp_eq_u32 vcc, -1, v36
  s_cbranch_vccnz wk_prs_69
  v_pk_add_f32 v[0:1], v[0:1], v[4:5]
  v_pk_add_f32 v[8:9], v[8:9], v[12:13]
  v_pk_add_f32 v[2:3], v[2:3], v[6:7]
  v_pk_add_f32 v[10:11], v[10:11], v[14:15]
  v_pk_add_f32 v[0:1], v[0:1], v[8:9]
  v_pk_add_f32 v[2:3], v[2:3], v[10:11]
  s_add_u32 s21, s73, 524288
  buffer_store_dwordx4 v[40:43], v114, s[4:7], s21 offen sc1
  s_add_u32 s21, s73, 528384
  buffer_store_dwordx4 v[40:43], v114, s[4:7], s21 offen sc1
  s_add_u32 s21, s73, 532480
  buffer_store_dwordx4 v[40:43], v114, s[4:7], s21 offen sc1
  s_add_u32 s21, s73, 536576
  s_mov_b64 exec, s[78:79]
  buffer_store_dwordx4 v[40:43], v114, s[4:7], s21 offen sc1
  s_mov_b64 exec, -1
  v_permlane32_swap_b32 v0, v2
  v_permlane32_swap_b32 v1, v3
  v_pk_add_f32 v[32:33], v[0:1], v[2:3]
  s_waitcnt lgkmcnt(0)
  v_cvt_pk_bf16_f32 v36, v32, v33
  v_lshlrev_b32 v32, 16, v36
  v_and_b32 v33, 0xffff0000, v36
  v_lshlrev_b32 v0, 16, v68
  v_and_b32 v1, 0xffff0000, v68
  v_pk_add_f32 v[32:33], v[32:33], v[0:1]
  v_lshlrev_b32 v2, 16, v67
  v_and_b32 v3, 0xffff0000, v67
  v_cvt_pk_bf16_f32 v36, v32, v33
  v_lshlrev_b32 v32, 16, v36
  v_and_b32 v33, 0xffff0000, v36
  v_pk_mul_f32 v[32:33], v[32:33], v[2:3]
  v_lshlrev_b32 v0, 16, v104
  v_and_b32 v1, 0xffff0000, v104
  v_cvt_pk_bf16_f32 v36, v32, v33
  v_lshlrev_b32 v32, 16, v36
  v_and_b32 v33, 0xffff0000, v36
  v_pk_add_f32 v[32:33], v[32:33], v[0:1]
  v_cvt_pk_bf16_f32 v36, v32, v33
  buffer_store_dword v36, v118, s[28:31], s76 offen
  s_xor_b32 s74, s74, 32768
  s_add_u32 s20, s20, 7
  s_cmp_lt_u32 s20, 64
  s_cbranch_scc1 w3_loop_s
wk_bail:
  s_waitcnt vmcnt(0) lgkmcnt(0)
k_exit:
  s_endpgm
.section .rodata,"a"
.p2align 6
.amdhsa_kernel adaLN_cond__memory_aug_recurrent_mem_tr__dense_activation_gelu__prompt_kernel
  .amdhsa_next_free_vgpr 512
  .amdhsa_next_free_sgpr 102
  .amdhsa_accum_offset 256
  .amdhsa_group_segment_fixed_size 0
  .amdhsa_kernarg_size 136
  .amdhsa_user_sgpr_count 2
  .amdhsa_user_sgpr_kernarg_segment_ptr 1
  .amdhsa_system_sgpr_workgroup_id_x 1
.end_amdhsa_kernel
```
